```python
import torch

def _softmax(x, axis=-1):
    return torch.softmax(x, dim=axis)
def _gelu(x):
    return torch.nn.functional.gelu(x, approximate="tanh")
def _silu(x):
    return torch.nn.functional.silu(x)
def _sigmoid(x):
    return torch.sigmoid(x)
def _layernorm(x, axis=-1, eps=1e-5):
    m = x.mean(dim=axis, keepdim=True)
    v = x.var(dim=axis, keepdim=True, unbiased=False)
    return (x - m) / torch.sqrt(v + eps)
def _scatter_add(tgt, idx, src, axis=0):
    return tgt.clone().index_add_(axis, idx, src)
def _segment_sum(src, seg, n):
    out = torch.zeros((n,) + src.shape[1:], dtype=src.dtype)
    return out.index_add_(0, seg, src)
def _pad(x, pw):
    flat = tuple(v for pair in reversed(pw) for v in pair)
    return torch.nn.functional.pad(x, flat)

kernel_name = 'interleave_layers__sliding_local_dilated__linear_kernel_hedgehog__prompt'

def setup_inputs():

    _w = (lambda a: (lambda t: t.to(torch.bfloat16) if t.is_floating_point() else t)(torch.as_tensor(a)))
    def _A_setup():
        B, S, D = 1, 2048, 640
        return {
            "x": _w((lambda *s: torch.randn(*s, dtype=torch.bfloat16) * 0.05)(B, S, D)),
            "wqkv": _w((lambda *s: torch.randn(*s, dtype=torch.bfloat16) * 0.05)(D, 3 * D)),
            "wo": _w((lambda *s: torch.randn(*s, dtype=torch.bfloat16) * 0.05)(D, D)),
        }
    _A_in = _A_setup()

    def _B_setup():
        B, S, D, H = 1, 2048, 640, 32
        Dh = D // H
        return {
            "x": _w((lambda *s: torch.randn(*s, dtype=torch.bfloat16) * 0.05)(B, S, D)),
            "wqkv": _w((lambda *s: torch.randn(*s, dtype=torch.bfloat16) * 0.4)(D, 3 * D)),
            "w_phi": _w((lambda *s: torch.randn(*s, dtype=torch.bfloat16) * 0.4)(H, Dh, Dh) * (Dh ** -0.5)),
            "wo": _w((lambda *s: torch.randn(*s, dtype=torch.bfloat16) * 0.1)(D, D)),
        }
    _B_in = _B_setup()

    return {
        "A_x": _A_in["x"],
        "A_wqkv": _A_in["wqkv"],
        "A_wo": _A_in["wo"],
        "B_x": _B_in["x"],
        "B_wqkv": _B_in["wqkv"],
        "B_w_phi": _B_in["w_phi"],
        "B_wo": _B_in["wo"],
    }

def reference(A_x, A_wqkv, A_wo, B_x, B_wqkv, B_w_phi, B_wo):
    def _A_ref(x, wqkv, wo):
        B, S, D = x.shape
        H = 32; Dh = D // H
        W, dil = 8, 2
        qkv = (lambda x, *d: x.permute(*d))((x @ wqkv).reshape(B, S, 3, H, Dh), 2, 0, 3, 1, 4)
        q, k, v = qkv[0], qkv[1], qkv[2]
        scale = Dh ** -0.5
        pos = torch.arange(S)
        off = torch.arange(W) * dil
        idx = pos[:, None] - off[None, :]
        mask = idx >= 0
        idx_c = torch.where(mask, idx, 0).reshape(-1)
        kg = k[:, :, idx_c, :].reshape(B, H, S, W, Dh)
        vg = v[:, :, idx_c, :].reshape(B, H, S, W, Dh)
        logits = torch.einsum("bhsd,bhswd->bhsw", q, kg) * scale
        logits = torch.where(mask[None, None, :, :], logits, -1e9)
        attn = _softmax(logits, axis=-1)
        o = torch.einsum("bhsw,bhswd->bhsd", attn, vg)
        return (lambda x, *d: x.permute(*d))(o, 0, 2, 1, 3).reshape(B, S, D) @ wo

    def _B_ref(x, wqkv, w_phi, wo):
        B, S, D = x.shape
        H = 32; Dh = D // H
        qkv = (lambda x, *d: x.permute(*d))((x @ wqkv).reshape(B, S, 3, H, Dh), 2, 0, 3, 1, 4)
        q, k, v = qkv[0], qkv[1], qkv[2]
        pq = torch.einsum("bhsd,hdf->bhsf", q, w_phi)
        pk = torch.einsum("bhsd,hdf->bhsf", k, w_phi)
        phi_q = torch.concatenate([_softmax(pq, axis=-1), _softmax(-pq, axis=-1)], axis=-1)
        phi_k = torch.concatenate([_softmax(pk, axis=-1), _softmax(-pk, axis=-1)], axis=-1)
        kv = torch.einsum("bhsf,bhsd->bhfd", phi_k, v)
        z  = torch.einsum("bhsf->bhf", phi_k)
        num = torch.einsum("bhqf,bhfd->bhqd", phi_q, kv)
        den = torch.einsum("bhqf,bhf->bhq", phi_q, z)[..., None] + 1e-6
        o = num / den
        return (lambda x, *d: x.permute(*d))(o, 0, 2, 1, 3).reshape(B, S, D) @ wo

    x = A_x
    x = x + _A_ref(_layernorm(x, axis=-1), A_wqkv, A_wo)
    x = x + _B_ref(_layernorm(x, axis=-1), B_wqkv, B_w_phi, B_wo)
    x = x + _A_ref(_layernorm(x, axis=-1), A_wqkv, A_wo)
    x = x + _B_ref(_layernorm(x, axis=-1), B_wqkv, B_w_phi, B_wo)
    return x
```

```asm
; @launch kernel=main_kernel grid=(256,1,1) block=(256,1,1) lds=163840
.amdgcn_target "amdgcn-amd-amdhsa--gfx950"
.text
.globl main_kernel
.p2align 8
.type main_kernel,@function
main_kernel:
  s_cmp_ge_u32 s2, 256
  s_cbranch_scc1 main_exit
  s_load_dwordx2 s[4:5], s[0:1], 72
  s_load_dwordx16 s[28:43], s[0:1], 0
  s_load_dwordx2 s[88:89], s[0:1], 64
  s_memrealtime s[92:93]
  v_lshrrev_b32 v5, 6, v0
  v_and_b32 v1, 63, v0
  v_readfirstlane_b32 s12, v5
  v_lshlrev_b32 v2, 4, v1
  v_and_b32 v3, 15, v1
  v_lshrrev_b32 v4, 4, v1
  s_mov_b32 s6, 34488320
  s_mov_b32 s7, 0x20000
  s_and_b32 s24, s2, 7
  s_lshr_b32 s25, s2, 3
  s_and_b32 s14, s25, 7
  s_lshr_b32 s25, s25, 3
  s_and_b32 s3, s24, 1
  s_lshl_b32 s3, s3, 3
  s_add_u32 s14, s14, s3
  s_lshr_b32 s24, s24, 1
  s_lshl_b32 s24, s24, 2
  s_add_u32 s13, s24, s25
  s_getpc_b64 s[82:83]
  s_lshr_b32 s84, s2, 3
  s_lshl_b32 s84, s84, 2
  s_add_u32 s84, s84, s12
  s_min_u32 s84, s84, 43
  s_lshl_b32 s84, s84, 10
  v_add_u32 v236, s84, v2
  v_mul_u32_u24 v240, 1280, v3
  v_lshl_add_u32 v240, v4, 4, v240
  v_add_u32 v241, 20480, v240
  s_lshl_b32 s86, s13, 3
  s_lshl_b32 s85, s12, 1
  s_add_u32 s85, s85, s86
  s_mul_i32 s85, s85, 20480
  s_mul_i32 s86, s86, 20480
  s_sub_u32 s86, s86, 20480
  s_lshl_b32 s87, s12, 6
  s_add_u32 s86, s86, s87
  s_cmp_eq_u32 s13, 0
  s_cselect_b32 s86, 1879048192, s86
  s_mov_b32 s26, 2621440
  s_mov_b32 s27, 0x20000
  s_waitcnt lgkmcnt(0)
  s_and_b32 s5, s5, 0xffff
  s_mov_b32 s24, s28
  s_and_b32 s25, s29, 0xffff
  s_mov_b64 s[34:35], s[40:41]
  s_mov_b64 s[100:101], s[42:43]
  s_and_b32 s89, s89, 0xffff
  s_mov_b32 s90, 256
  s_mov_b32 s91, 0x20000
  s_or_b32 s40, s2, s12
  s_cmp_eq_u32 s40, 0
  s_cbranch_scc0 prep_nn
  s_or_b32 s92, s92, 1
  v_mov_b32 v16, 0
  v_mov_b32 v17, s92
  s_mov_b64 exec, 1
  buffer_store_dword v17, v16, s[88:91], 0 offen sc1
  s_mov_b64 exec, -1
prep_nn:
  s_mov_b32 s95, 1879048192
  s_cmp_ge_u32 s2, 232
  s_cbranch_scc1 prep_z
  s_cmp_ge_u32 s2, 200
  s_cbranch_scc1 prep_x
  s_sub_u32 s40, s2, 160
  s_cmp_lt_u32 s40, 40
  s_cbranch_scc1 prep_o
  s_cmp_ge_u32 s2, 80
  s_cselect_b32 s40, 1, 0
  s_cselect_b32 s8, s36, s30
  s_cselect_b32 s9, s37, s31
  s_cselect_b32 s41, 80, 0
  s_and_b32 s9, s9, 0xffff
  s_mov_b32 s10, 2457600
  s_mov_b32 s11, 0x20000
  s_sub_u32 s41, s2, s41
  s_mul_i32 s42, s41, 205
  s_lshr_b32 s42, s42, 10
  s_mul_i32 s43, s42, 5
  s_sub_u32 s43, s41, s43
  s_lshl_b32 s44, s43, 2
  s_add_u32 s44, s44, s12
  s_mul_i32 s45, s44, 122880
  s_mul_i32 s46, s42, 80
  s_add_u32 s45, s45, s46
  s_add_u32 s46, s45, 15360
  v_lshrrev_b32 v6, 2, v3
  v_lshlrev_b32 v6, 3, v6
  v_and_b32 v7, 3, v3
  v_add_u32 v6, v6, v7
  v_mul_u32_u24 v6, 3840, v6
  v_min_u32 v7, 2, v4
  v_lshl_add_u32 v6, v7, 4, v6
  buffer_load_dwordx4 v[64:67], v6, s[8:11], s45 offen offset:0
  buffer_load_dwordx4 v[68:71], v6, s[8:11], s46 offen offset:0
  buffer_load_dwordx4 v[72:75], v6, s[8:11], s45 offen offset:40
  buffer_load_dwordx4 v[76:79], v6, s[8:11], s46 offen offset:40
  buffer_load_dwordx4 v[80:83], v6, s[8:11], s45 offen offset:1280
  buffer_load_dwordx4 v[84:87], v6, s[8:11], s46 offen offset:1280
  buffer_load_dwordx4 v[88:91], v6, s[8:11], s45 offen offset:1320
  buffer_load_dwordx4 v[92:95], v6, s[8:11], s46 offen offset:1320
  buffer_load_dwordx4 v[96:99], v6, s[8:11], s45 offen offset:2560
  buffer_load_dwordx4 v[100:103], v6, s[8:11], s46 offen offset:2560
  buffer_load_dwordx4 v[104:107], v6, s[8:11], s45 offen offset:2600
  buffer_load_dwordx4 v[108:111], v6, s[8:11], s46 offen offset:2600
  s_cmp_eq_u32 s40, 0
  s_cbranch_scc1 prep_w_id
  s_mov_b32 s48, s38
  s_and_b32 s49, s39, 0xffff
  s_mov_b32 s50, 25600
  s_mov_b32 s51, 0x20000
  s_mul_i32 s52, s42, 1600
  s_add_u32 s53, s52, 800
  v_lshrrev_b32 v16, 2, v3
  v_lshlrev_b32 v16, 3, v16
  v_and_b32 v17, 3, v3
  v_add_u32 v16, v16, v17
  v_mul_u32_u24 v36, 40, v16
  v_lshl_add_u32 v36, v7, 4, v36
  v_mov_b32 v17, 1879048192
  v_add_u32 v37, 160, v36
  v_cmp_gt_u32 vcc, 20, v16
  s_nop 1
  v_cndmask_b32 v36, v17, v36, vcc
  v_cmp_gt_u32 vcc, 16, v16
  s_nop 1
  v_cndmask_b32 v37, v17, v37, vcc
  buffer_load_dwordx4 v[192:195], v36, s[48:51], s52 offen
  buffer_load_dwordx4 v[196:199], v37, s[48:51], s52 offen
  buffer_load_dwordx4 v[200:203], v36, s[48:51], s53 offen
  buffer_load_dwordx4 v[204:207], v37, s[48:51], s53 offen
  v_add_u32 v16, 0, v3
  v_cmp_le_u32 vcc, 10, v16
  s_nop 1
  v_cndmask_b32 v17, 0, 10, vcc
  v_sub_u32 v16, v16, v17
  v_cndmask_b32 v17, 0, 64, vcc
  v_and_b32 v18, 3, v16
  v_lshl_add_u32 v17, v18, 4, v17
  v_lshrrev_b32 v18, 2, v16
  v_lshl_add_u32 v208, v18, 10, v17
  v_cmp_gt_u32 s[62:63], 2, v18
  v_add_u32 v17, 32, v208
  s_nop 0
  v_cndmask_b32 v40, v17, v208, s[62:63]
  v_mov_b32 v42, 128
  v_add_u32 v16, 16, v3
  v_cmp_le_u32 vcc, 10, v16
  s_nop 1
  v_cndmask_b32 v17, 0, 10, vcc
  v_sub_u32 v16, v16, v17
  v_cndmask_b32 v17, 0, 64, vcc
  v_and_b32 v18, 3, v16
  v_lshl_add_u32 v17, v18, 4, v17
  v_lshrrev_b32 v18, 2, v16
  v_lshl_add_u32 v209, v18, 10, v17
  v_cmp_gt_u32 s[64:65], 2, v18
  v_add_u32 v17, 32, v209
  s_nop 0
  v_cndmask_b32 v41, v17, v209, s[64:65]
  v_mov_b32 v43, 128
  s_mov_b32 s66, 5120
  s_mov_b32 s67, 3072
  s_mov_b32 s68, 4096
  s_mov_b32 s69, 107520
  s_mov_b32 s70, 5120
  s_mov_b32 s71, 512
  v_mov_b32 v242, 0
  buffer_load_dword v243, v242, s[88:91], 0 offen sc1
  global_load_dwordx4 v[232:235], v236, s[82:83]
  v_and_b32 v18, 7, v3
  v_lshrrev_b32 v19, 3, v3
  v_and_b32 v16, 1, v18
  v_lshlrev_b32 v16, 4, v16
  v_mov_b32 v17, 0x3f80
  v_lshlrev_b32 v16, v16, v17
  v_cmp_eq_u32 vcc, v19, v4
  s_nop 1
  v_cndmask_b32 v16, 0, v16, vcc
  v_lshrrev_b32 v17, 1, v18
  v_cmp_eq_u32 vcc, 0, v17
  s_nop 1
  v_cndmask_b32 v8, 0, v16, vcc
  v_cmp_eq_u32 vcc, 1, v17
  s_nop 1
  v_cndmask_b32 v9, 0, v16, vcc
  v_cmp_eq_u32 vcc, 2, v17
  s_nop 1
  v_cndmask_b32 v10, 0, v16, vcc
  v_cmp_eq_u32 vcc, 3, v17
  s_nop 1
  v_cndmask_b32 v11, 0, v16, vcc
  v_add_u32 v19, 2, v19
  v_and_b32 v16, 1, v18
  v_lshlrev_b32 v16, 4, v16
  v_mov_b32 v17, 0x3f80
  v_lshlrev_b32 v16, v16, v17
  v_cmp_eq_u32 vcc, v19, v4
  s_nop 1
  v_cndmask_b32 v16, 0, v16, vcc
  v_lshrrev_b32 v17, 1, v18
  v_cmp_eq_u32 vcc, 0, v17
  s_nop 1
  v_cndmask_b32 v12, 0, v16, vcc
  v_cmp_eq_u32 vcc, 1, v17
  s_nop 1
  v_cndmask_b32 v13, 0, v16, vcc
  v_cmp_eq_u32 vcc, 2, v17
  s_nop 1
  v_cndmask_b32 v14, 0, v16, vcc
  v_cmp_eq_u32 vcc, 3, v17
  s_nop 1
  v_cndmask_b32 v15, 0, v16, vcc
  s_waitcnt vmcnt(2)
  v_mfma_f32_16x16x32_bf16 v[128:131], v[192:195], v[8:11], 0
  v_mfma_f32_16x16x32_bf16 v[132:135], v[196:199], v[8:11], 0
  v_mfma_f32_16x16x32_bf16 v[136:139], v[192:195], v[12:15], 0
  v_mfma_f32_16x16x32_bf16 v[140:143], v[196:199], v[12:15], 0
  v_mfma_f32_16x16x32_bf16 v[144:147], v[200:203], v[8:11], 0
  v_mfma_f32_16x16x32_bf16 v[148:151], v[204:207], v[8:11], 0
  v_mfma_f32_16x16x32_bf16 v[152:155], v[200:203], v[12:15], 0
  v_mfma_f32_16x16x32_bf16 v[156:159], v[204:207], v[12:15], 0
  s_nop 0
  v_cvt_pk_bf16_f32 v20, v128, v129
  v_cvt_pk_bf16_f32 v21, v130, v131
  v_cvt_pk_bf16_f32 v22, v132, v133
  v_cvt_pk_bf16_f32 v23, v134, v135
  v_cvt_pk_bf16_f32 v24, v136, v137
  v_cvt_pk_bf16_f32 v25, v138, v139
  v_cvt_pk_bf16_f32 v26, v140, v141
  v_cvt_pk_bf16_f32 v27, v142, v143
  v_cvt_pk_bf16_f32 v28, v144, v145
  v_cvt_pk_bf16_f32 v29, v146, v147
  v_cvt_pk_bf16_f32 v30, v148, v149
  v_cvt_pk_bf16_f32 v31, v150, v151
  v_cvt_pk_bf16_f32 v32, v152, v153
  v_cvt_pk_bf16_f32 v33, v154, v155
  v_cvt_pk_bf16_f32 v34, v156, v157
  v_cvt_pk_bf16_f32 v35, v158, v159
  s_branch prep_w_go
prep_w_id:
  v_mov_b32 v242, 0
  buffer_load_dword v243, v242, s[88:91], 0 offen sc1
  global_load_dwordx4 v[232:235], v236, s[82:83]
  v_and_b32 v18, 7, v3
  v_lshrrev_b32 v19, 3, v3
  v_and_b32 v16, 1, v18
  v_lshlrev_b32 v16, 4, v16
  v_mov_b32 v17, 0x3f80
  v_lshlrev_b32 v16, v16, v17
  v_cmp_eq_u32 vcc, v19, v4
  s_nop 1
  v_cndmask_b32 v16, 0, v16, vcc
  v_lshrrev_b32 v17, 1, v18
  v_cmp_eq_u32 vcc, 0, v17
  s_nop 1
  v_cndmask_b32 v8, 0, v16, vcc
  v_cmp_eq_u32 vcc, 1, v17
  s_nop 1
  v_cndmask_b32 v9, 0, v16, vcc
  v_cmp_eq_u32 vcc, 2, v17
  s_nop 1
  v_cndmask_b32 v10, 0, v16, vcc
  v_cmp_eq_u32 vcc, 3, v17
  s_nop 1
  v_cndmask_b32 v11, 0, v16, vcc
  v_add_u32 v19, 2, v19
  v_and_b32 v16, 1, v18
  v_lshlrev_b32 v16, 4, v16
  v_mov_b32 v17, 0x3f80
  v_lshlrev_b32 v16, v16, v17
  v_cmp_eq_u32 vcc, v19, v4
  s_nop 1
  v_cndmask_b32 v16, 0, v16, vcc
  v_lshrrev_b32 v17, 1, v18
  v_cmp_eq_u32 vcc, 0, v17
  s_nop 1
  v_cndmask_b32 v12, 0, v16, vcc
  v_cmp_eq_u32 vcc, 1, v17
  s_nop 1
  v_cndmask_b32 v13, 0, v16, vcc
  v_cmp_eq_u32 vcc, 2, v17
  s_nop 1
  v_cndmask_b32 v14, 0, v16, vcc
  v_cmp_eq_u32 vcc, 3, v17
  s_nop 1
  v_cndmask_b32 v15, 0, v16, vcc
  v_mov_b32 v20, v8
  v_mov_b32 v24, v12
  v_mov_b32 v21, v9
  v_mov_b32 v25, v13
  v_mov_b32 v22, v10
  v_mov_b32 v26, v14
  v_mov_b32 v23, v11
  v_mov_b32 v27, v15
  v_mov_b32 v28, v8
  v_mov_b32 v32, v12
  v_mov_b32 v29, v9
  v_mov_b32 v33, v13
  v_mov_b32 v30, v10
  v_mov_b32 v34, v14
  v_mov_b32 v31, v11
  v_mov_b32 v35, v15
  v_add_u32 v16, 0, v3
  v_mul_u32_u24 v17, 13, v16
  v_lshrrev_b32 v17, 6, v17
  v_mul_u32_u24 v18, 5, v17
  v_sub_u32 v18, v16, v18
  v_lshlrev_b32 v17, 6, v17
  v_lshl_add_u32 v16, v18, 4, v17
  v_add_u32 v17, 4096, v17
  v_cmp_gt_u32 vcc, 4, v18
  s_nop 1
  v_cndmask_b32 v40, v17, v16, vcc
  v_mov_b32 v16, 1024
  v_cndmask_b32 v42, 16, v16, vcc
  v_lshl_add_u32 v208, v42, 1, v40
  s_mov_b64 s[62:63], 0
  v_add_u32 v16, 16, v3
  v_mul_u32_u24 v17, 13, v16
  v_lshrrev_b32 v17, 6, v17
  v_mul_u32_u24 v18, 5, v17
  v_sub_u32 v18, v16, v18
  v_lshlrev_b32 v17, 6, v17
  v_lshl_add_u32 v16, v18, 4, v17
  v_add_u32 v17, 4096, v17
  v_cmp_gt_u32 vcc, 4, v18
  s_nop 1
  v_cndmask_b32 v41, v17, v16, vcc
  v_mov_b32 v16, 1024
  v_cndmask_b32 v43, 16, v16, vcc
  v_lshl_add_u32 v209, v43, 1, v41
  s_mov_b64 s[64:65], 0
  s_mov_b32 s66, 5120
  s_mov_b32 s67, 107520
  s_mov_b32 s68, 108544
  s_mov_b32 s69, 109568
  s_mov_b32 s70, 2560
  s_mov_b32 s71, 2560
prep_w_go:
  v_mov_b32 v17, 1879048192
  v_cmp_gt_u32 vcc, 4, v3
  s_nop 1
  v_cndmask_b32 v41, v17, v41, vcc
  v_cndmask_b32 v209, v17, v209, vcc
  v_lshlrev_b32 v44, 4, v3
  v_cndmask_b32 v45, v17, v44, vcc
  v_lshlrev_b32 v46, 8, v4
  v_lshlrev_b32 v47, 7, v4
  s_lshl_b32 s54, s40, 4
  s_add_u32 s54, s54, s42
  s_mul_i32 s54, s54, 164864
  s_mul_i32 s72, s66, s44
  s_mul_i32 s73, s44, 2048
  s_add_u32 s73, s73, 118272
  s_mul_i32 s74, s70, s44
  s_add_u32 s75, s74, s68
  s_add_u32 s74, s74, s67
  s_mul_i32 s76, s71, s44
  s_add_u32 s76, s76, s69
  s_mul_i32 s80, s66, 20
  s_mov_b32 s81, 40960
  s_add_u32 s81, s81, 118272
  s_mul_i32 s82, s70, 20
  s_add_u32 s83, s82, s68
  s_add_u32 s82, s82, s67
  s_mul_i32 s84, s71, 20
  s_add_u32 s84, s84, s69
  v_mov_b32 v16, s72
  v_mov_b32 v17, s73
  v_cndmask_b32 v210, v16, v17, s[62:63]
  v_mov_b32 v16, s72
  v_mov_b32 v17, s73
  v_cndmask_b32 v211, v16, v17, s[64:65]
  s_lshl_b32 s95, s40, 4
  s_add_u32 s95, s95, s42
  s_lshl_b32 s95, s95, 6
  s_add_u32 s95, s95, s43
  s_lshl_b32 s95, s95, 2
  s_add_u32 s95, s95, 32374784
  s_cmp_eq_u32 s40, 0
  s_cselect_b32 s77, s74, s73
  s_cmp_eq_u32 s43, 0
  s_cselect_b32 s78, 40960, 0
  s_mov_b32 s60, 0x000f000f
  s_mov_b32 s61, 0x000f000f
  s_mov_b32 s56, 1065369472
  s_lshl_b32 s57, s12, 2
  v_add_u32 v48, s57, v4
  v_mul_u32_u24 v48, 768, v48
  v_lshl_add_u32 v48, v3, 2, v48
  v_add_u32 v48, s78, v48
  s_waitcnt vmcnt(2)
  v_mfma_f32_16x16x32_bf16 v[112:115], v[64:67], v[20:23], 0
  v_mfma_f32_16x16x32_bf16 v[116:119], v[68:71], v[20:23], 0
  v_mfma_f32_16x16x32_bf16 v[120:123], v[64:67], v[24:27], 0
  v_mfma_f32_16x16x32_bf16 v[124:127], v[68:71], v[24:27], 0
  v_mad_u32_u24 v50, v42, 0, v40
  v_add3_u32 v50, v50, v46, v210
  v_mad_u32_u24 v51, v43, 0, v41
  v_add3_u32 v51, v51, v46, v211
  s_nop 0
  v_cvt_pk_bf16_f32 v128, v112, v113
  v_cvt_pk_bf16_f32 v129, v114, v115
  v_cvt_pk_bf16_f32 v130, v116, v117
  v_cvt_pk_bf16_f32 v131, v118, v119
  ds_write_b128 v50, v[128:131]
  v_dot2_f32_bf16 v52, v128, s56, 0
  v_dot2_f32_bf16 v52, v129, s56, v52
  v_dot2_f32_bf16 v52, v130, s56, v52
  v_dot2_f32_bf16 v52, v131, s56, v52
  v_cvt_pk_bf16_f32 v132, v120, v121
  v_cvt_pk_bf16_f32 v133, v122, v123
  v_cvt_pk_bf16_f32 v134, v124, v125
  v_cvt_pk_bf16_f32 v135, v126, v127
  s_mov_b64 exec, s[60:61]
  ds_write_b128 v51, v[132:135]
  s_mov_b64 exec, -1
  v_dot2_f32_bf16 v53, v132, s56, 0
  v_dot2_f32_bf16 v53, v133, s56, v53
  v_dot2_f32_bf16 v53, v134, s56, v53
  v_dot2_f32_bf16 v53, v135, s56, v53
  s_nop 2
  ds_write_b32 v48, v52 offset:0
  ds_write_b32 v48, v53 offset:64
  v_mfma_f32_16x16x32_bf16 v[176:179], v[72:75], v[28:31], 0
  v_mfma_f32_16x16x32_bf16 v[180:183], v[76:79], v[28:31], 0
  v_mfma_f32_16x16x32_bf16 v[184:187], v[72:75], v[32:35], 0
  v_mfma_f32_16x16x32_bf16 v[188:191], v[76:79], v[32:35], 0
  v_mad_u32_u24 v54, v42, 1, v40
  v_add3_u32 v54, v54, v46, v210
  v_mad_u32_u24 v55, v43, 1, v41
  v_add3_u32 v55, v55, v46, v211
  s_nop 0
  v_cvt_pk_bf16_f32 v136, v176, v177
  v_cvt_pk_bf16_f32 v137, v178, v179
  v_cvt_pk_bf16_f32 v138, v180, v181
  v_cvt_pk_bf16_f32 v139, v182, v183
  ds_write_b128 v54, v[136:139]
  v_dot2_f32_bf16 v56, v136, s56, 0
  v_dot2_f32_bf16 v56, v137, s56, v56
  v_dot2_f32_bf16 v56, v138, s56, v56
  v_dot2_f32_bf16 v56, v139, s56, v56
  v_cvt_pk_bf16_f32 v140, v184, v185
  v_cvt_pk_bf16_f32 v141, v186, v187
  v_cvt_pk_bf16_f32 v142, v188, v189
  v_cvt_pk_bf16_f32 v143, v190, v191
  s_mov_b64 exec, s[60:61]
  ds_write_b128 v55, v[140:143]
  s_mov_b64 exec, -1
  v_dot2_f32_bf16 v57, v140, s56, 0
  v_dot2_f32_bf16 v57, v141, s56, v57
  v_dot2_f32_bf16 v57, v142, s56, v57
  v_dot2_f32_bf16 v57, v143, s56, v57
  s_nop 2
  ds_write_b32 v48, v56 offset:128
  ds_write_b32 v48, v57 offset:192
  v_mfma_f32_16x16x32_bf16 v[112:115], v[80:83], v[20:23], 0
  v_mfma_f32_16x16x32_bf16 v[116:119], v[84:87], v[20:23], 0
  v_mfma_f32_16x16x32_bf16 v[120:123], v[80:83], v[24:27], 0
  v_mfma_f32_16x16x32_bf16 v[124:127], v[84:87], v[24:27], 0
  v_mad_u32_u24 v50, v42, 0, v208
  v_add3_u32 v50, v50, v46, s72
  v_mad_u32_u24 v51, v43, 0, v209
  v_add3_u32 v51, v51, v46, s72
  s_nop 0
  v_cvt_pk_bf16_f32 v144, v112, v113
  v_cvt_pk_bf16_f32 v145, v114, v115
  v_cvt_pk_bf16_f32 v146, v116, v117
  v_cvt_pk_bf16_f32 v147, v118, v119
  ds_write_b128 v50, v[144:147]
  v_dot2_f32_bf16 v52, v144, s56, 0
  v_dot2_f32_bf16 v52, v145, s56, v52
  v_dot2_f32_bf16 v52, v146, s56, v52
  v_dot2_f32_bf16 v52, v147, s56, v52
  v_cvt_pk_bf16_f32 v148, v120, v121
  v_cvt_pk_bf16_f32 v149, v122, v123
  v_cvt_pk_bf16_f32 v150, v124, v125
  v_cvt_pk_bf16_f32 v151, v126, v127
  s_mov_b64 exec, s[60:61]
  ds_write_b128 v51, v[148:151]
  s_mov_b64 exec, -1
  v_dot2_f32_bf16 v53, v148, s56, 0
  v_dot2_f32_bf16 v53, v149, s56, v53
  v_dot2_f32_bf16 v53, v150, s56, v53
  v_dot2_f32_bf16 v53, v151, s56, v53
  s_nop 2
  ds_write_b32 v48, v52 offset:256
  ds_write_b32 v48, v53 offset:320
  v_mfma_f32_16x16x32_bf16 v[176:179], v[88:91], v[28:31], 0
  v_mfma_f32_16x16x32_bf16 v[180:183], v[92:95], v[28:31], 0
  v_mfma_f32_16x16x32_bf16 v[184:187], v[88:91], v[32:35], 0
  v_mfma_f32_16x16x32_bf16 v[188:191], v[92:95], v[32:35], 0
  v_mad_u32_u24 v54, v42, 1, v208
  v_add3_u32 v54, v54, v46, s72
  v_mad_u32_u24 v55, v43, 1, v209
  v_add3_u32 v55, v55, v46, s72
  s_nop 0
  v_cvt_pk_bf16_f32 v152, v176, v177
  v_cvt_pk_bf16_f32 v153, v178, v179
  v_cvt_pk_bf16_f32 v154, v180, v181
  v_cvt_pk_bf16_f32 v155, v182, v183
  ds_write_b128 v54, v[152:155]
  v_dot2_f32_bf16 v56, v152, s56, 0
  v_dot2_f32_bf16 v56, v153, s56, v56
  v_dot2_f32_bf16 v56, v154, s56, v56
  v_dot2_f32_bf16 v56, v155, s56, v56
  v_cvt_pk_bf16_f32 v156, v184, v185
  v_cvt_pk_bf16_f32 v157, v186, v187
  v_cvt_pk_bf16_f32 v158, v188, v189
  v_cvt_pk_bf16_f32 v159, v190, v191
  s_mov_b64 exec, s[60:61]
  ds_write_b128 v55, v[156:159]
  s_mov_b64 exec, -1
  v_dot2_f32_bf16 v57, v156, s56, 0
  v_dot2_f32_bf16 v57, v157, s56, v57
  v_dot2_f32_bf16 v57, v158, s56, v57
  v_dot2_f32_bf16 v57, v159, s56, v57
  s_nop 2
  ds_write_b32 v48, v56 offset:384
  ds_write_b32 v48, v57 offset:448
  v_mfma_f32_16x16x32_bf16 v[112:115], v[96:99], v[8:11], 0
  v_mfma_f32_16x16x32_bf16 v[116:119], v[100:103], v[8:11], 0
  v_mfma_f32_16x16x32_bf16 v[120:123], v[96:99], v[12:15], 0
  v_mfma_f32_16x16x32_bf16 v[124:127], v[100:103], v[12:15], 0
  v_add3_u32 v50, v44, v46, s74
  v_add3_u32 v51, v45, v47, s76
  s_nop 2
  v_cvt_pk_bf16_f32 v160, v112, v113
  v_cvt_pk_bf16_f32 v161, v114, v115
  v_cvt_pk_bf16_f32 v162, v116, v117
  v_cvt_pk_bf16_f32 v163, v118, v119
  ds_write_b128 v50, v[160:163]
  v_dot2_f32_bf16 v52, v160, s56, 0
  v_dot2_f32_bf16 v52, v161, s56, v52
  v_dot2_f32_bf16 v52, v162, s56, v52
  v_dot2_f32_bf16 v52, v163, s56, v52
  v_cvt_pk_bf16_f32 v164, v120, v121
  v_cvt_pk_bf16_f32 v165, v122, v123
  v_cvt_pk_bf16_f32 v166, v124, v125
  v_cvt_pk_bf16_f32 v167, v126, v127
  s_mov_b64 exec, s[60:61]
  ds_write_b128 v51, v[164:167]
  s_mov_b64 exec, -1
  v_dot2_f32_bf16 v53, v164, s56, 0
  v_dot2_f32_bf16 v53, v165, s56, v53
  v_dot2_f32_bf16 v53, v166, s56, v53
  v_dot2_f32_bf16 v53, v167, s56, v53
  s_nop 2
  ds_write_b32 v48, v52 offset:512
  ds_write_b32 v48, v53 offset:576
  v_mfma_f32_16x16x32_bf16 v[176:179], v[104:107], v[8:11], 0
  v_mfma_f32_16x16x32_bf16 v[180:183], v[108:111], v[8:11], 0
  v_mfma_f32_16x16x32_bf16 v[184:187], v[104:107], v[12:15], 0
  v_mfma_f32_16x16x32_bf16 v[188:191], v[108:111], v[12:15], 0
  v_add3_u32 v54, v44, v46, s75
  v_add3_u32 v55, v45, v47, s76
  v_add_u32 v55, 64, v55
  s_nop 1
  v_cvt_pk_bf16_f32 v168, v176, v177
  v_cvt_pk_bf16_f32 v169, v178, v179
  v_cvt_pk_bf16_f32 v170, v180, v181
  v_cvt_pk_bf16_f32 v171, v182, v183
  ds_write_b128 v54, v[168:171]
  v_dot2_f32_bf16 v56, v168, s56, 0
  v_dot2_f32_bf16 v56, v169, s56, v56
  v_dot2_f32_bf16 v56, v170, s56, v56
  v_dot2_f32_bf16 v56, v171, s56, v56
  v_cvt_pk_bf16_f32 v172, v184, v185
  v_cvt_pk_bf16_f32 v173, v186, v187
  v_cvt_pk_bf16_f32 v174, v188, v189
  v_cvt_pk_bf16_f32 v175, v190, v191
  s_mov_b64 exec, s[60:61]
  ds_write_b128 v55, v[172:175]
  s_mov_b64 exec, -1
  v_dot2_f32_bf16 v57, v172, s56, 0
  v_dot2_f32_bf16 v57, v173, s56, v57
  v_dot2_f32_bf16 v57, v174, s56, v57
  v_dot2_f32_bf16 v57, v175, s56, v57
  s_nop 2
  ds_write_b32 v48, v56 offset:640
  ds_write_b32 v48, v57 offset:704
  v_add_u32 v50, s72, v2
  v_add_u32 v51, s77, v2
  v_add_u32 v52, s76, v2
  v_add_u32 v53, 4096, v50
  s_waitcnt lgkmcnt(0)
  ds_read_b128 v[64:67], v50 offset:0
  ds_read_b128 v[68:71], v50 offset:1024
  ds_read_b128 v[72:75], v50 offset:2048
  ds_read_b128 v[76:79], v50 offset:3072
  ds_read_b128 v[80:83], v53 offset:0
  ds_read_b128 v[84:87], v51 offset:0
  ds_read_b128 v[88:91], v51 offset:1024
  ds_read_b128 v[92:95], v52 offset:0
  s_barrier
  s_waitcnt lgkmcnt(7)
  buffer_store_dwordx4 v[64:67], v50, s[4:7], s54 offen offset:0 sc1
  s_waitcnt lgkmcnt(6)
  buffer_store_dwordx4 v[68:71], v50, s[4:7], s54 offen offset:1024 sc1
  s_waitcnt lgkmcnt(5)
  buffer_store_dwordx4 v[72:75], v50, s[4:7], s54 offen offset:2048 sc1
  s_waitcnt lgkmcnt(4)
  buffer_store_dwordx4 v[76:79], v50, s[4:7], s54 offen offset:3072 sc1
  s_waitcnt lgkmcnt(3)
  buffer_store_dwordx4 v[80:83], v53, s[4:7], s54 offen offset:0 sc1
  s_waitcnt lgkmcnt(2)
  buffer_store_dwordx4 v[84:87], v51, s[4:7], s54 offen offset:0 sc1
  s_waitcnt lgkmcnt(1)
  buffer_store_dwordx4 v[88:91], v51, s[4:7], s54 offen offset:1024 sc1
  s_waitcnt lgkmcnt(0)
  s_mov_b32 exec_hi, 0
  buffer_store_dwordx4 v[92:95], v52, s[4:7], s54 offen offset:0 sc1
  s_mov_b32 exec_hi, -1
  s_cmp_eq_u32 s12, 3
  s_cbranch_scc1 prep_done
  v_lshlrev_b32 v54, 2, v0
  v_add_u32 v54, s78, v54
  ds_read_b32 v128, v54 offset:0
  ds_read_b32 v129, v54 offset:768
  ds_read_b32 v130, v54 offset:1536
  ds_read_b32 v131, v54 offset:2304
  ds_read_b32 v132, v54 offset:3072
  ds_read_b32 v133, v54 offset:3840
  ds_read_b32 v134, v54 offset:4608
  ds_read_b32 v135, v54 offset:5376
  ds_read_b32 v136, v54 offset:6144
  ds_read_b32 v137, v54 offset:6912
  ds_read_b32 v138, v54 offset:7680
  ds_read_b32 v139, v54 offset:8448
  ds_read_b32 v140, v54 offset:9216
  ds_read_b32 v141, v54 offset:9984
  ds_read_b32 v142, v54 offset:10752
  ds_read_b32 v143, v54 offset:11520
  v_lshrrev_b32 v55, 5, v0
  v_and_b32 v60, 1, v4
  v_cmp_eq_u32 vcc, 1, v60
  s_nop 1
  v_cndmask_b32 v40, v40, v41, vcc
  v_cndmask_b32 v42, v42, v43, vcc
  v_cndmask_b32 v56, v208, v209, vcc
  s_and_b64 s[64:65], s[64:65], vcc
  s_andn2_b64 s[62:63], s[62:63], vcc
  s_or_b64 s[62:63], s[62:63], s[64:65]
  v_mov_b32 v16, s80
  v_mov_b32 v17, s81
  v_cndmask_b32 v17, v16, v17, s[62:63]
  v_add_u32 v40, v40, v17
  v_add_u32 v56, v56, v16
  v_cmp_le_u32 s[60:61], 2, v55
  s_nop 1
  v_cndmask_b32 v40, v40, v56, s[60:61]
  v_and_b32 v60, 1, v55
  v_mad_u32_u24 v57, v42, v60, v40
  v_mov_b32 v16, s82
  v_mov_b32 v17, s83
  v_cmp_eq_u32 s[60:61], 1, v60
  s_nop 1
  v_cndmask_b32 v16, v16, v17, s[60:61]
  v_add_u32 v16, v16, v44
  v_lshl_add_u32 v17, v60, 6, v45
  v_add_u32 v17, s84, v17
  v_cndmask_b32 v58, v16, v17, vcc
  v_cmp_le_u32 s[60:61], 4, v55
  s_nop 1
  v_cndmask_b32 v57, v57, v58, s[60:61]
  s_and_b64 s[60:61], s[60:61], vcc
  v_mov_b32 v59, 256
  v_mov_b32 v58, 128
  v_cndmask_b32 v59, v59, v58, s[60:61]
  s_lshr_b32 s58, s43, 1
  v_mad_u32_u24 v62, v59, s58, v57
  s_and_b32 s59, s43, 1
  s_lshl_b32 s59, s59, 3
  s_add_u32 s59, s59, s54
  s_waitcnt lgkmcnt(0)
  v_add_f32 v128, v128, v136
  v_add_f32 v129, v129, v137
  v_add_f32 v130, v130, v138
  v_add_f32 v131, v131, v139
  v_add_f32 v132, v132, v140
  v_add_f32 v133, v133, v141
  v_add_f32 v134, v134, v142
  v_add_f32 v135, v135, v143
  v_add_f32 v128, v128, v132
  v_add_f32 v129, v129, v133
  v_add_f32 v130, v130, v134
  v_add_f32 v131, v131, v135
  v_add_f32 v128, v128, v130
  v_add_f32 v129, v129, v131
  v_add_f32 v144, v128, v129
  v_cvt_pk_bf16_f32 v146, v144, v144
  v_and_b32 v147, 0xffff0000, v146
  v_sub_f32 v144, v144, v147
  v_cvt_pk_bf16_f32 v148, v144, v144
  v_and_b32 v147, 0xffff0000, v148
  v_sub_f32 v144, v144, v147
  v_cvt_pk_bf16_f32 v151, v144, 0
  v_and_b32 v146, 0xffff, v146
  v_or_b32 v150, v146, v147
  buffer_store_dwordx2 v[150:151], v62, s[4:7], s59 offen sc1
  s_cmp_eq_u32 s43, 4
  s_cbranch_scc0 prep_done
  v_mov_b32 v152, 0
  v_mov_b32 v153, 0
  v_mov_b32 v154, 0
  v_mov_b32 v155, 0
  buffer_store_dwordx2 v[152:153], v62, s[4:7], s59 offen offset:8 sc1
  v_add_u32 v62, v62, v59
  buffer_store_dwordx4 v[152:155], v62, s[4:7], s59 offen sc1
  s_branch prep_done
prep_o:
  s_sleep 80
  s_cmp_ge_u32 s40, 20
  s_cselect_b32 s95, 44, 0
  s_add_u32 s95, s95, s40
  s_lshl_b32 s95, s95, 2
  s_add_u32 s95, s95, 32382976
  s_lshl_b32 s40, s40, 2
  s_add_u32 s40, s40, s12
  s_cmp_ge_u32 s40, 80
  s_cselect_b32 s41, 1, 0
  s_cselect_b32 s8, s34, s32
  s_cselect_b32 s9, s35, s33
  s_and_b32 s9, s9, 0xffff
  s_mov_b32 s10, 819200
  s_mov_b32 s11, 0x20000
  s_mul_i32 s42, s41, 80
  s_sub_u32 s42, s40, s42
  s_and_b32 s43, s42, 3
  s_lshr_b32 s42, s42, 2
  v_lshrrev_b32 v6, 2, v3
  v_mul_u32_u24 v6, 40, v6
  v_and_b32 v7, 3, v3
  v_add3_u32 v6, v6, v7, 16
  s_mul_i32 s44, s42, 40
  s_sub_u32 s45, s42, 16
  s_mul_i32 s45, s45, 160
  s_cmp_lt_u32 s42, 16
  s_cselect_b32 s44, s44, s45
  s_cselect_b64 vcc, -1, 0
  v_cndmask_b32 v6, v6, v3, vcc
  v_mul_u32_u24 v6, 1280, v6
  v_lshl_add_u32 v6, v4, 4, v6
  s_mul_i32 s44, s44, 1280
  s_mul_i32 s45, s43, 320
  s_add_u32 s44, s44, s45
  s_add_u32 s45, s44, 25600
  buffer_load_dwordx4 v[64:67], v6, s[8:11], s44 offen offset:0
  buffer_load_dwordx4 v[68:71], v6, s[8:11], s45 offen offset:0
  buffer_load_dwordx4 v[72:75], v6, s[8:11], s44 offen offset:64
  buffer_load_dwordx4 v[76:79], v6, s[8:11], s45 offen offset:64
  buffer_load_dwordx4 v[80:83], v6, s[8:11], s44 offen offset:128
  buffer_load_dwordx4 v[84:87], v6, s[8:11], s45 offen offset:128
  buffer_load_dwordx4 v[88:91], v6, s[8:11], s44 offen offset:192
  buffer_load_dwordx4 v[92:95], v6, s[8:11], s45 offen offset:192
  buffer_load_dwordx4 v[96:99], v6, s[8:11], s44 offen offset:256
  buffer_load_dwordx4 v[100:103], v6, s[8:11], s45 offen offset:256
  v_mov_b32 v242, 0
  buffer_load_dword v243, v242, s[88:91], 0 offen sc1
  global_load_dwordx4 v[232:235], v236, s[82:83]
  v_and_b32 v18, 7, v3
  v_lshrrev_b32 v19, 3, v3
  v_and_b32 v16, 1, v18
  v_lshlrev_b32 v16, 4, v16
  v_mov_b32 v17, 0x3f80
  v_lshlrev_b32 v16, v16, v17
  v_cmp_eq_u32 vcc, v19, v4
  s_nop 1
  v_cndmask_b32 v16, 0, v16, vcc
  v_lshrrev_b32 v17, 1, v18
  v_cmp_eq_u32 vcc, 0, v17
  s_nop 1
  v_cndmask_b32 v8, 0, v16, vcc
  v_cmp_eq_u32 vcc, 1, v17
  s_nop 1
  v_cndmask_b32 v9, 0, v16, vcc
  v_cmp_eq_u32 vcc, 2, v17
  s_nop 1
  v_cndmask_b32 v10, 0, v16, vcc
  v_cmp_eq_u32 vcc, 3, v17
  s_nop 1
  v_cndmask_b32 v11, 0, v16, vcc
  v_add_u32 v19, 2, v19
  v_and_b32 v16, 1, v18
  v_lshlrev_b32 v16, 4, v16
  v_mov_b32 v17, 0x3f80
  v_lshlrev_b32 v16, v16, v17
  v_cmp_eq_u32 vcc, v19, v4
  s_nop 1
  v_cndmask_b32 v16, 0, v16, vcc
  v_lshrrev_b32 v17, 1, v18
  v_cmp_eq_u32 vcc, 0, v17
  s_nop 1
  v_cndmask_b32 v12, 0, v16, vcc
  v_cmp_eq_u32 vcc, 1, v17
  s_nop 1
  v_cndmask_b32 v13, 0, v16, vcc
  v_cmp_eq_u32 vcc, 2, v17
  s_nop 1
  v_cndmask_b32 v14, 0, v16, vcc
  v_cmp_eq_u32 vcc, 3, v17
  s_nop 1
  v_cndmask_b32 v15, 0, v16, vcc
  v_bfe_u32 v16, v3, 2, 1
  v_lshlrev_b32 v16, 10, v16
  v_lshrrev_b32 v17, 3, v3
  v_lshl_add_u32 v16, v17, 6, v16
  v_lshl_add_u32 v16, v7, 4, v16
  v_lshl_add_u32 v16, v4, 8, v16
  s_mul_i32 s46, s41, 827392
  s_mul_i32 s47, s42, 5120
  s_add_u32 s46, s46, s47
  s_mul_i32 s47, s43, 206848
  s_add_u32 s46, s46, s47
  s_add_u32 s46, s46, 5275648
  s_add_u32 s47, s46, 103424
  s_add_u32 s50, s46, 4096
  s_add_u32 s51, s47, 4096
  s_waitcnt vmcnt(10)
  v_mfma_f32_16x16x32_bf16 v[160:163], v[64:67], v[8:11], 0
  v_mfma_f32_16x16x32_bf16 v[164:167], v[68:71], v[8:11], 0
  v_mfma_f32_16x16x32_bf16 v[168:171], v[64:67], v[12:15], 0
  v_mfma_f32_16x16x32_bf16 v[172:175], v[68:71], v[12:15], 0
  s_nop 4
  v_cvt_pk_bf16_f32 v192, v160, v161
  v_cvt_pk_bf16_f32 v193, v162, v163
  v_cvt_pk_bf16_f32 v194, v164, v165
  v_cvt_pk_bf16_f32 v195, v166, v167
  buffer_store_dwordx4 v[192:195], v16, s[4:7], s46 offen offset:0 sc1
  v_cvt_pk_bf16_f32 v196, v168, v169
  v_cvt_pk_bf16_f32 v197, v170, v171
  v_cvt_pk_bf16_f32 v198, v172, v173
  v_cvt_pk_bf16_f32 v199, v174, v175
  buffer_store_dwordx4 v[196:199], v16, s[4:7], s46 offen offset:128 sc1
  s_waitcnt vmcnt(10)
  v_mfma_f32_16x16x32_bf16 v[176:179], v[72:75], v[8:11], 0
  v_mfma_f32_16x16x32_bf16 v[180:183], v[76:79], v[8:11], 0
  v_mfma_f32_16x16x32_bf16 v[184:187], v[72:75], v[12:15], 0
  v_mfma_f32_16x16x32_bf16 v[188:191], v[76:79], v[12:15], 0
  s_nop 4
  v_cvt_pk_bf16_f32 v200, v176, v177
  v_cvt_pk_bf16_f32 v201, v178, v179
  v_cvt_pk_bf16_f32 v202, v180, v181
  v_cvt_pk_bf16_f32 v203, v182, v183
  buffer_store_dwordx4 v[200:203], v16, s[4:7], s46 offen offset:2048 sc1
  v_cvt_pk_bf16_f32 v204, v184, v185
  v_cvt_pk_bf16_f32 v205, v186, v187
  v_cvt_pk_bf16_f32 v206, v188, v189
  v_cvt_pk_bf16_f32 v207, v190, v191
  buffer_store_dwordx4 v[204:207], v16, s[4:7], s46 offen offset:2176 sc1
  s_waitcnt vmcnt(10)
  v_mfma_f32_16x16x32_bf16 v[160:163], v[80:83], v[8:11], 0
  v_mfma_f32_16x16x32_bf16 v[164:167], v[84:87], v[8:11], 0
  v_mfma_f32_16x16x32_bf16 v[168:171], v[80:83], v[12:15], 0
  v_mfma_f32_16x16x32_bf16 v[172:175], v[84:87], v[12:15], 0
  s_nop 4
  v_cvt_pk_bf16_f32 v192, v160, v161
  v_cvt_pk_bf16_f32 v193, v162, v163
  v_cvt_pk_bf16_f32 v194, v164, v165
  v_cvt_pk_bf16_f32 v195, v166, v167
  buffer_store_dwordx4 v[192:195], v2, s[4:7], s50 offen sc1
  v_cvt_pk_bf16_f32 v196, v168, v169
  v_cvt_pk_bf16_f32 v197, v170, v171
  v_cvt_pk_bf16_f32 v198, v172, v173
  v_cvt_pk_bf16_f32 v199, v174, v175
  buffer_store_dwordx4 v[196:199], v2, s[4:7], s51 offen sc1
  s_waitcnt vmcnt(10)
  v_mfma_f32_16x16x32_bf16 v[176:179], v[88:91], v[8:11], 0
  v_mfma_f32_16x16x32_bf16 v[180:183], v[92:95], v[8:11], 0
  v_mfma_f32_16x16x32_bf16 v[184:187], v[88:91], v[12:15], 0
  v_mfma_f32_16x16x32_bf16 v[188:191], v[92:95], v[12:15], 0
  s_nop 4
  v_cvt_pk_bf16_f32 v200, v176, v177
  v_cvt_pk_bf16_f32 v201, v178, v179
  v_cvt_pk_bf16_f32 v202, v180, v181
  v_cvt_pk_bf16_f32 v203, v182, v183
  buffer_store_dwordx4 v[200:203], v16, s[4:7], s47 offen offset:0 sc1
  v_cvt_pk_bf16_f32 v204, v184, v185
  v_cvt_pk_bf16_f32 v205, v186, v187
  v_cvt_pk_bf16_f32 v206, v188, v189
  v_cvt_pk_bf16_f32 v207, v190, v191
  buffer_store_dwordx4 v[204:207], v16, s[4:7], s47 offen offset:128 sc1
  s_waitcnt vmcnt(10)
  v_mfma_f32_16x16x32_bf16 v[160:163], v[96:99], v[8:11], 0
  v_mfma_f32_16x16x32_bf16 v[164:167], v[100:103], v[8:11], 0
  v_mfma_f32_16x16x32_bf16 v[168:171], v[96:99], v[12:15], 0
  v_mfma_f32_16x16x32_bf16 v[172:175], v[100:103], v[12:15], 0
  s_nop 4
  v_cvt_pk_bf16_f32 v192, v160, v161
  v_cvt_pk_bf16_f32 v193, v162, v163
  v_cvt_pk_bf16_f32 v194, v164, v165
  v_cvt_pk_bf16_f32 v195, v166, v167
  buffer_store_dwordx4 v[192:195], v16, s[4:7], s47 offen offset:2048 sc1
  v_cvt_pk_bf16_f32 v196, v168, v169
  v_cvt_pk_bf16_f32 v197, v170, v171
  v_cvt_pk_bf16_f32 v198, v172, v173
  v_cvt_pk_bf16_f32 v199, v174, v175
  buffer_store_dwordx4 v[196:199], v16, s[4:7], s47 offen offset:2176 sc1
  s_branch prep_done
prep_x:
  s_sub_u32 s41, s2, 200
  s_lshr_b32 s95, s41, 1
  s_lshl_b32 s95, s95, 8
  s_and_b32 s42, s41, 1
  s_lshl_b32 s42, s42, 2
  s_add_u32 s95, s95, s42
  s_add_u32 s95, s95, 32383488
  s_lshl_b32 s41, s41, 2
  s_add_u32 s41, s41, s12
  s_mul_i32 s44, s41, 20480
  buffer_load_dwordx4 v[64:67], v240, s[24:27], s44 offen offset:0
  buffer_load_dwordx4 v[68:71], v240, s[24:27], s44 offen offset:64
  buffer_load_dwordx4 v[72:75], v240, s[24:27], s44 offen offset:128
  buffer_load_dwordx4 v[76:79], v240, s[24:27], s44 offen offset:192
  buffer_load_dwordx4 v[80:83], v240, s[24:27], s44 offen offset:256
  buffer_load_dwordx4 v[84:87], v240, s[24:27], s44 offen offset:320
  buffer_load_dwordx4 v[88:91], v240, s[24:27], s44 offen offset:384
  buffer_load_dwordx4 v[92:95], v240, s[24:27], s44 offen offset:448
  buffer_load_dwordx4 v[96:99], v240, s[24:27], s44 offen offset:512
  buffer_load_dwordx4 v[100:103], v240, s[24:27], s44 offen offset:576
  buffer_load_dwordx4 v[104:107], v240, s[24:27], s44 offen offset:640
  buffer_load_dwordx4 v[108:111], v240, s[24:27], s44 offen offset:704
  buffer_load_dwordx4 v[112:115], v240, s[24:27], s44 offen offset:768
  buffer_load_dwordx4 v[116:119], v240, s[24:27], s44 offen offset:832
  buffer_load_dwordx4 v[120:123], v240, s[24:27], s44 offen offset:896
  buffer_load_dwordx4 v[124:127], v240, s[24:27], s44 offen offset:960
  buffer_load_dwordx4 v[128:131], v240, s[24:27], s44 offen offset:1024
  buffer_load_dwordx4 v[132:135], v240, s[24:27], s44 offen offset:1088
  buffer_load_dwordx4 v[136:139], v240, s[24:27], s44 offen offset:1152
  buffer_load_dwordx4 v[140:143], v240, s[24:27], s44 offen offset:1216
  v_mov_b32 v242, 0
  buffer_load_dword v243, v242, s[88:91], 0 offen sc1
  global_load_dwordx4 v[232:235], v236, s[82:83]
  s_mov_b32 s56, 1065369472
  s_mul_i32 s45, s41, 21504
  s_add_u32 s45, s45, 7340032
  s_waitcnt vmcnt(21)
  buffer_store_dwordx4 v[64:67], v2, s[4:7], s45 offen offset:0 sc1
  s_waitcnt vmcnt(21)
  buffer_store_dwordx4 v[68:71], v2, s[4:7], s45 offen offset:1024 sc1
  s_waitcnt vmcnt(21)
  buffer_store_dwordx4 v[72:75], v2, s[4:7], s45 offen offset:2048 sc1
  s_waitcnt vmcnt(21)
  buffer_store_dwordx4 v[76:79], v2, s[4:7], s45 offen offset:3072 sc1
  s_waitcnt vmcnt(21)
  s_add_u32 s45, s45, 4096
  buffer_store_dwordx4 v[80:83], v2, s[4:7], s45 offen offset:0 sc1
  s_waitcnt vmcnt(21)
  buffer_store_dwordx4 v[84:87], v2, s[4:7], s45 offen offset:1024 sc1
  s_waitcnt vmcnt(21)
  buffer_store_dwordx4 v[88:91], v2, s[4:7], s45 offen offset:2048 sc1
  s_waitcnt vmcnt(21)
  buffer_store_dwordx4 v[92:95], v2, s[4:7], s45 offen offset:3072 sc1
  s_waitcnt vmcnt(21)
  s_add_u32 s45, s45, 4096
  buffer_store_dwordx4 v[96:99], v2, s[4:7], s45 offen offset:0 sc1
  s_waitcnt vmcnt(21)
  buffer_store_dwordx4 v[100:103], v2, s[4:7], s45 offen offset:1024 sc1
  s_waitcnt vmcnt(21)
  buffer_store_dwordx4 v[104:107], v2, s[4:7], s45 offen offset:2048 sc1
  s_waitcnt vmcnt(21)
  buffer_store_dwordx4 v[108:111], v2, s[4:7], s45 offen offset:3072 sc1
  s_waitcnt vmcnt(21)
  s_add_u32 s45, s45, 4096
  buffer_store_dwordx4 v[112:115], v2, s[4:7], s45 offen offset:0 sc1
  s_waitcnt vmcnt(21)
  buffer_store_dwordx4 v[116:119], v2, s[4:7], s45 offen offset:1024 sc1
  s_waitcnt vmcnt(21)
  buffer_store_dwordx4 v[120:123], v2, s[4:7], s45 offen offset:2048 sc1
  s_waitcnt vmcnt(21)
  buffer_store_dwordx4 v[124:127], v2, s[4:7], s45 offen offset:3072 sc1
  s_waitcnt vmcnt(21)
  s_add_u32 s45, s45, 4096
  buffer_store_dwordx4 v[128:131], v2, s[4:7], s45 offen offset:0 sc1
  s_waitcnt vmcnt(21)
  buffer_store_dwordx4 v[132:135], v2, s[4:7], s45 offen offset:1024 sc1
  s_waitcnt vmcnt(21)
  buffer_store_dwordx4 v[136:139], v2, s[4:7], s45 offen offset:2048 sc1
  s_waitcnt vmcnt(21)
  buffer_store_dwordx4 v[140:143], v2, s[4:7], s45 offen offset:3072 sc1
  v_dot2_f32_bf16 v16, v64, s56, 0
  v_dot2_f32_bf16 v20, v64, v64, 0
  v_dot2_f32_bf16 v17, v65, s56, 0
  v_dot2_f32_bf16 v21, v65, v65, 0
  v_dot2_f32_bf16 v16, v66, s56, v16
  v_dot2_f32_bf16 v20, v66, v66, v20
  v_dot2_f32_bf16 v17, v67, s56, v17
  v_dot2_f32_bf16 v21, v67, v67, v21
  v_dot2_f32_bf16 v16, v68, s56, v16
  v_dot2_f32_bf16 v20, v68, v68, v20
  v_dot2_f32_bf16 v17, v69, s56, v17
  v_dot2_f32_bf16 v21, v69, v69, v21
  v_dot2_f32_bf16 v16, v70, s56, v16
  v_dot2_f32_bf16 v20, v70, v70, v20
  v_dot2_f32_bf16 v17, v71, s56, v17
  v_dot2_f32_bf16 v21, v71, v71, v21
  v_dot2_f32_bf16 v16, v72, s56, v16
  v_dot2_f32_bf16 v20, v72, v72, v20
  v_dot2_f32_bf16 v17, v73, s56, v17
  v_dot2_f32_bf16 v21, v73, v73, v21
  v_dot2_f32_bf16 v16, v74, s56, v16
  v_dot2_f32_bf16 v20, v74, v74, v20
  v_dot2_f32_bf16 v17, v75, s56, v17
  v_dot2_f32_bf16 v21, v75, v75, v21
  v_dot2_f32_bf16 v16, v76, s56, v16
  v_dot2_f32_bf16 v20, v76, v76, v20
  v_dot2_f32_bf16 v17, v77, s56, v17
  v_dot2_f32_bf16 v21, v77, v77, v21
  v_dot2_f32_bf16 v16, v78, s56, v16
  v_dot2_f32_bf16 v20, v78, v78, v20
  v_dot2_f32_bf16 v17, v79, s56, v17
  v_dot2_f32_bf16 v21, v79, v79, v21
  v_dot2_f32_bf16 v16, v80, s56, v16
  v_dot2_f32_bf16 v20, v80, v80, v20
  v_dot2_f32_bf16 v17, v81, s56, v17
  v_dot2_f32_bf16 v21, v81, v81, v21
  v_dot2_f32_bf16 v16, v82, s56, v16
  v_dot2_f32_bf16 v20, v82, v82, v20
  v_dot2_f32_bf16 v17, v83, s56, v17
  v_dot2_f32_bf16 v21, v83, v83, v21
  v_dot2_f32_bf16 v16, v84, s56, v16
  v_dot2_f32_bf16 v20, v84, v84, v20
  v_dot2_f32_bf16 v17, v85, s56, v17
  v_dot2_f32_bf16 v21, v85, v85, v21
  v_dot2_f32_bf16 v16, v86, s56, v16
  v_dot2_f32_bf16 v20, v86, v86, v20
  v_dot2_f32_bf16 v17, v87, s56, v17
  v_dot2_f32_bf16 v21, v87, v87, v21
  v_dot2_f32_bf16 v16, v88, s56, v16
  v_dot2_f32_bf16 v20, v88, v88, v20
  v_dot2_f32_bf16 v17, v89, s56, v17
  v_dot2_f32_bf16 v21, v89, v89, v21
  v_dot2_f32_bf16 v16, v90, s56, v16
  v_dot2_f32_bf16 v20, v90, v90, v20
  v_dot2_f32_bf16 v17, v91, s56, v17
  v_dot2_f32_bf16 v21, v91, v91, v21
  v_dot2_f32_bf16 v16, v92, s56, v16
  v_dot2_f32_bf16 v20, v92, v92, v20
  v_dot2_f32_bf16 v17, v93, s56, v17
  v_dot2_f32_bf16 v21, v93, v93, v21
  v_dot2_f32_bf16 v16, v94, s56, v16
  v_dot2_f32_bf16 v20, v94, v94, v20
  v_dot2_f32_bf16 v17, v95, s56, v17
  v_dot2_f32_bf16 v21, v95, v95, v21
  v_dot2_f32_bf16 v16, v96, s56, v16
  v_dot2_f32_bf16 v20, v96, v96, v20
  v_dot2_f32_bf16 v17, v97, s56, v17
  v_dot2_f32_bf16 v21, v97, v97, v21
  v_dot2_f32_bf16 v16, v98, s56, v16
  v_dot2_f32_bf16 v20, v98, v98, v20
  v_dot2_f32_bf16 v17, v99, s56, v17
  v_dot2_f32_bf16 v21, v99, v99, v21
  v_dot2_f32_bf16 v16, v100, s56, v16
  v_dot2_f32_bf16 v20, v100, v100, v20
  v_dot2_f32_bf16 v17, v101, s56, v17
  v_dot2_f32_bf16 v21, v101, v101, v21
  v_dot2_f32_bf16 v16, v102, s56, v16
  v_dot2_f32_bf16 v20, v102, v102, v20
  v_dot2_f32_bf16 v17, v103, s56, v17
  v_dot2_f32_bf16 v21, v103, v103, v21
  v_dot2_f32_bf16 v16, v104, s56, v16
  v_dot2_f32_bf16 v20, v104, v104, v20
  v_dot2_f32_bf16 v17, v105, s56, v17
  v_dot2_f32_bf16 v21, v105, v105, v21
  v_dot2_f32_bf16 v16, v106, s56, v16
  v_dot2_f32_bf16 v20, v106, v106, v20
  v_dot2_f32_bf16 v17, v107, s56, v17
  v_dot2_f32_bf16 v21, v107, v107, v21
  v_dot2_f32_bf16 v16, v108, s56, v16
  v_dot2_f32_bf16 v20, v108, v108, v20
  v_dot2_f32_bf16 v17, v109, s56, v17
  v_dot2_f32_bf16 v21, v109, v109, v21
  v_dot2_f32_bf16 v16, v110, s56, v16
  v_dot2_f32_bf16 v20, v110, v110, v20
  v_dot2_f32_bf16 v17, v111, s56, v17
  v_dot2_f32_bf16 v21, v111, v111, v21
  v_dot2_f32_bf16 v16, v112, s56, v16
  v_dot2_f32_bf16 v20, v112, v112, v20
  v_dot2_f32_bf16 v17, v113, s56, v17
  v_dot2_f32_bf16 v21, v113, v113, v21
  v_dot2_f32_bf16 v16, v114, s56, v16
  v_dot2_f32_bf16 v20, v114, v114, v20
  v_dot2_f32_bf16 v17, v115, s56, v17
  v_dot2_f32_bf16 v21, v115, v115, v21
  v_dot2_f32_bf16 v16, v116, s56, v16
  v_dot2_f32_bf16 v20, v116, v116, v20
  v_dot2_f32_bf16 v17, v117, s56, v17
  v_dot2_f32_bf16 v21, v117, v117, v21
  v_dot2_f32_bf16 v16, v118, s56, v16
  v_dot2_f32_bf16 v20, v118, v118, v20
  v_dot2_f32_bf16 v17, v119, s56, v17
  v_dot2_f32_bf16 v21, v119, v119, v21
  v_dot2_f32_bf16 v16, v120, s56, v16
  v_dot2_f32_bf16 v20, v120, v120, v20
  v_dot2_f32_bf16 v17, v121, s56, v17
  v_dot2_f32_bf16 v21, v121, v121, v21
  v_dot2_f32_bf16 v16, v122, s56, v16
  v_dot2_f32_bf16 v20, v122, v122, v20
  v_dot2_f32_bf16 v17, v123, s56, v17
  v_dot2_f32_bf16 v21, v123, v123, v21
  v_dot2_f32_bf16 v16, v124, s56, v16
  v_dot2_f32_bf16 v20, v124, v124, v20
  v_dot2_f32_bf16 v17, v125, s56, v17
  v_dot2_f32_bf16 v21, v125, v125, v21
  v_dot2_f32_bf16 v16, v126, s56, v16
  v_dot2_f32_bf16 v20, v126, v126, v20
  v_dot2_f32_bf16 v17, v127, s56, v17
  v_dot2_f32_bf16 v21, v127, v127, v21
  v_dot2_f32_bf16 v16, v128, s56, v16
  v_dot2_f32_bf16 v20, v128, v128, v20
  v_dot2_f32_bf16 v17, v129, s56, v17
  v_dot2_f32_bf16 v21, v129, v129, v21
  v_dot2_f32_bf16 v16, v130, s56, v16
  v_dot2_f32_bf16 v20, v130, v130, v20
  v_dot2_f32_bf16 v17, v131, s56, v17
  v_dot2_f32_bf16 v21, v131, v131, v21
  v_dot2_f32_bf16 v16, v132, s56, v16
  v_dot2_f32_bf16 v20, v132, v132, v20
  v_dot2_f32_bf16 v17, v133, s56, v17
  v_dot2_f32_bf16 v21, v133, v133, v21
  v_dot2_f32_bf16 v16, v134, s56, v16
  v_dot2_f32_bf16 v20, v134, v134, v20
  v_dot2_f32_bf16 v17, v135, s56, v17
  v_dot2_f32_bf16 v21, v135, v135, v21
  v_dot2_f32_bf16 v16, v136, s56, v16
  v_dot2_f32_bf16 v20, v136, v136, v20
  v_dot2_f32_bf16 v17, v137, s56, v17
  v_dot2_f32_bf16 v21, v137, v137, v21
  v_dot2_f32_bf16 v16, v138, s56, v16
  v_dot2_f32_bf16 v20, v138, v138, v20
  v_dot2_f32_bf16 v17, v139, s56, v17
  v_dot2_f32_bf16 v21, v139, v139, v21
  v_dot2_f32_bf16 v16, v140, s56, v16
  v_dot2_f32_bf16 v20, v140, v140, v20
  v_dot2_f32_bf16 v17, v141, s56, v17
  v_dot2_f32_bf16 v21, v141, v141, v21
  v_dot2_f32_bf16 v16, v142, s56, v16
  v_dot2_f32_bf16 v20, v142, v142, v20
  v_dot2_f32_bf16 v17, v143, s56, v17
  v_dot2_f32_bf16 v21, v143, v143, v21
  s_nop 2
  v_add_f32 v16, v16, v17
  v_add_f32 v20, v20, v21
  v_mov_b32 v17, v16
  s_nop 1
  v_permlane32_swap_b32 v16, v17
  v_add_f32 v16, v16, v17
  v_mov_b32 v17, v16
  s_nop 1
  v_permlane16_swap_b32 v16, v17
  v_add_f32 v16, v16, v17
  v_mov_b32 v21, v20
  s_nop 1
  v_permlane32_swap_b32 v20, v21
  v_add_f32 v20, v20, v21
  v_mov_b32 v21, v20
  s_nop 1
  v_permlane16_swap_b32 v20, v21
  v_add_f32 v20, v20, v21
  v_mul_f32 v22, 1040187392, v16
  v_mul_f32 v23, 1040187392, v20
  v_lshrrev_b32 v6, 1, v4
  v_lshlrev_b32 v6, 8, v6
  v_lshl_add_u32 v6, v3, 4, v6
  v_and_b32 v7, 1, v4
  v_lshl_add_u32 v6, v7, 3, v6
  s_lshl_b32 s48, s41, 10
  s_add_u32 s48, s48, 29360128
  buffer_store_dwordx2 v[22:23], v6, s[4:7], s48 offen sc1
  buffer_store_dwordx2 v[22:23], v6, s[4:7], s48 offen offset:512 sc1
  s_branch prep_done
prep_z:
  s_cmp_eq_u32 s2, 232
  s_cbranch_scc0 prep_nojob
  s_mov_b32 s40, 31719424
  s_mov_b32 s95, 32387584
  v_lshlrev_b32 v6, 8, v0
  v_mov_b32 v8, 0
  buffer_store_dword v8, v6, s[4:7], s40 offen sc1
  s_add_u32 s40, s40, 65536
  buffer_store_dword v8, v6, s[4:7], s40 offen sc1
  s_add_u32 s40, s40, 65536
  buffer_store_dword v8, v6, s[4:7], s40 offen sc1
  s_add_u32 s40, s40, 65536
  buffer_store_dword v8, v6, s[4:7], s40 offen sc1
  s_add_u32 s40, s40, 65536
  buffer_store_dword v8, v6, s[4:7], s40 offen sc1
  s_add_u32 s40, s40, 65536
  buffer_store_dword v8, v6, s[4:7], s40 offen sc1
  s_add_u32 s40, s40, 65536
  buffer_store_dword v8, v6, s[4:7], s40 offen sc1
  s_add_u32 s40, s40, 65536
  buffer_store_dword v8, v6, s[4:7], s40 offen sc1
  s_add_u32 s40, s40, 65536
  buffer_store_dword v8, v6, s[4:7], s40 offen sc1
  s_add_u32 s40, s40, 65536
  buffer_store_dword v8, v6, s[4:7], s40 offen sc1
  s_add_u32 s40, s40, 65536
prep_nojob:
  v_mov_b32 v242, 0
  buffer_load_dword v243, v242, s[88:91], 0 offen sc1
  global_load_dwordx4 v[232:235], v236, s[82:83]
prep_done:
  v_mov_b32 v12, 0
  s_mov_b32 s62, 0
  s_sub_u32 s40, s2, 80
  s_cmp_lt_u32 s40, 120
  s_cselect_b32 s96, s95, 1879048192
  s_cselect_b32 s95, 1879048192, s95
  s_cbranch_scc1 prep_late
  s_waitcnt vmcnt(0)
prep_late:
  s_waitcnt vmcnt(8)
prep_rn:
  s_add_u32 s62, s62, 1
  v_cmp_ne_u32 vcc, 0, v243
  s_cmp_lt_u32 s62, 0x8000
  s_cselect_b64 vcc, vcc, -1
  s_nop 4
  s_cbranch_vccnz prep_hn
  buffer_load_dword v243, v12, s[88:91], 0 offen sc1
  s_waitcnt vmcnt(0)
  s_branch prep_rn
prep_hn:
  s_cmp_eq_u32 s12, 0
  s_waitcnt lgkmcnt(0)
  s_barrier
  s_cbranch_scc0 prep_join
  s_mov_b64 exec, 1
  buffer_store_dword v243, v12, s[4:7], s95 offen sc1
  s_mov_b64 exec, -1
prep_join:
  s_mov_b32 s15, 0
  s_mov_b32 s16, 7340032
  s_mov_b32 s17, 29360128
  s_mov_b32 s18, 18350080
  s_mov_b32 s19, 0
  s_mov_b32 s20, 2637824
  s_mov_b32 s21, 5275648
  s_mov_b32 s22, 29884416
  s_mov_b64 s[44:45], s[24:25]
  s_mov_b32 s46, 2621440
  s_mov_b32 s47, 0x20000
  s_and_b32 s26, s14, 1
  s_lshr_b32 s63, s14, 1
  s_lshl_b32 s28, s13, 1
  s_add_u32 s28, s28, s26
  s_lshl_b32 s28, s28, 2
  s_lshr_b32 s35, s63, 1
  s_mul_i32 s35, s35, 5
  s_and_b32 s36, s63, 1
  s_mul_i32 s37, s36, 3
  s_add_u32 s37, s37, s35
  s_add_u32 s35, s35, 2
  s_add_u32 s38, s28, s12
  s_mul_i32 s39, s38, 21504
  s_lshl_b32 s40, s37, 10
  s_add_u32 s40, s40, s39
  s_lshl_b32 s41, s35, 10
  s_add_u32 s41, s41, s39
  s_lshl_b32 s42, s36, 9
  s_add_u32 s41, s41, s42
  v_lshrrev_b32 v16, 1, v4
  v_lshlrev_b32 v16, 8, v16
  v_lshl_add_u32 v16, v3, 4, v16
  v_and_b32 v17, 1, v4
  v_lshl_add_u32 v16, v17, 3, v16
  s_mul_i32 s39, s38, 20480
  v_mul_u32_u24 v17, 1280, v3
  v_lshl_add_u32 v18, v4, 4, v17
  v_lshl_add_u32 v19, v4, 3, v17
  s_lshl_b32 s42, s37, 6
  s_add_u32 s42, s42, s39
  s_lshl_b32 s43, s35, 6
  s_add_u32 s43, s43, s39
  s_lshl_b32 s36, s36, 5
  s_add_u32 s43, s43, s36
  buffer_load_dwordx4 v[246:249], v18, s[44:47], s42 offen
  buffer_load_dwordx4 v[250:253], v18, s[44:47], s42 offen offset:64
  buffer_load_dwordx2 v[254:255], v19, s[44:47], s43 offen
  s_mul_i32 s26, s14, 164864
  s_add_u32 s27, s26, s20
  s_add_u32 s26, s26, s19
  s_lshl_b32 s29, s13, 3
  s_lshl_b32 s30, s12, 1
  s_add_u32 s28, s30, s29
  s_mul_i32 s30, s28, 21504
  s_add_u32 s30, s30, s16
  v_add_u32 v5, 21504, v2
  v_mov_b32 v6, v2
  v_add_u32 v7, 107520, v2
  v_lshrrev_b32 v12, 2, v3
  v_lshlrev_b32 v12, 1, v12
  v_and_b32 v13, 1, v3
  v_add_u32 v12, v12, v13
  v_lshl_add_u32 v12, v4, 3, v12
  v_lshlrev_b32 v12, 4, v12
  v_add_u32 v8, 109568, v12
  s_lshl_b32 s37, s28, 10
  s_add_u32 s37, s37, s17
  v_lshrrev_b32 v12, 2, v3
  v_lshlrev_b32 v48, 10, v12
  v_lshl_add_u32 v48, v4, 6, v48
  v_and_b32 v13, 3, v3
  v_lshl_add_u32 v48, v13, 4, v48
  v_lshlrev_b32 v35, 6, v12
  v_lshl_add_u32 v35, v13, 2, v35
  v_add_u32 v49, 4096, v0
  s_lshl_b32 s38, s15, 4
  s_add_u32 s38, s38, s13
  s_lshl_b32 s38, s38, 12
  s_add_u32 s38, s38, 31977472
  s_mul_i32 s31, s29, 21504
  s_add_u32 s31, s31, s16
  s_sub_u32 s31, s31, 21504
  s_lshl_b32 s32, s12, 10
  s_add_u32 s31, s31, s32
  s_cmp_eq_u32 s13, 0
  s_cselect_b32 s31, 1879048192, s31
  s_cselect_b64 s[40:41], 0, -1
  s_lshl_b32 s32, s12, 11
  s_add_u32 s32, s32, 3072
  s_sub_u32 s37, s37, s32
  v_add_u32 v12, s32, v48
  v_mov_b32 v13, 1879048192
  s_and_b32 s58, s41, 0x0f000f00
  s_mov_b32 s59, s58
  v_cndmask_b32 v13, v13, v48, s[58:59]
  v_cmp_gt_u32 vcc, 8, v3
  s_nop 1
  v_cndmask_b32 v48, v13, v12, vcc
  s_mov_b32 s40, 0
  v_cndmask_b32 v49, v49, v0, s[40:41]
  s_mul_i32 s32, s12, 5120
  s_add_u32 s32, s32, 2048
  v_add_u32 v9, s32, v2
  s_mul_i32 s32, s12, 2560
  v_add_u32 v10, s32, v7
  v_add_u32 v11, s32, v8
  s_lshr_b32 s60, s14, 1
  s_mul_i32 s60, s60, 103424
  s_mul_i32 s61, s12, 25600
  s_add_u32 s61, s61, s60
  s_add_u32 s61, s61, s21
  v_add_u32 v50, 4096, v2
  v_mov_b32 v51, 1065369472
  s_mul_i32 s44, s28, 21504
  s_add_u32 s44, s44, s18
  s_lshr_b32 s46, s14, 2
  s_add_u32 s46, s46, 16
  s_lshl_b32 s46, s46, 10
  s_and_b32 s47, s14, 3
  s_lshl_b32 s47, s47, 8
  s_add_u32 s46, s46, s47
  s_add_u32 s46, s46, s44
  s_add_u32 s47, s46, 21504
  s_lshl_b32 s45, s14, 10
  s_add_u32 s44, s44, s45
  s_add_u32 s45, s44, 21504
  v_lshlrev_b32 v14, 4, v3
  v_lshl_add_u32 v14, v4, 2, v14
  s_mov_b32 s48, -1
  s_mov_b32 s49, 0
  s_mov_b32 s50, 0x33333333
  s_mov_b32 s51, 0x33333333
  s_lshl_b32 s42, s15, 4
  s_add_u32 s42, s42, s13
  s_lshl_b32 s42, s42, 12
  s_add_u32 s99, s42, 31719424
  v_and_b32 v12, 7, v3
  v_lshrrev_b32 v13, 3, v3
  v_and_b32 v52, 1, v12
  v_lshlrev_b32 v52, 4, v52
  v_mov_b32 v53, 0x3f80
  v_lshlrev_b32 v52, v52, v53
  v_cmp_eq_u32 vcc, v13, v4
  s_nop 1
  v_cndmask_b32 v52, 0, v52, vcc
  v_lshrrev_b32 v53, 1, v12
  v_cmp_eq_u32 vcc, 0, v53
  s_nop 1
  v_cndmask_b32 v16, 0, v52, vcc
  v_cmp_eq_u32 vcc, 1, v53
  s_nop 1
  v_cndmask_b32 v17, 0, v52, vcc
  v_cmp_eq_u32 vcc, 2, v53
  s_nop 1
  v_cndmask_b32 v18, 0, v52, vcc
  v_cmp_eq_u32 vcc, 3, v53
  s_nop 1
  v_cndmask_b32 v19, 0, v52, vcc
  v_accvgpr_write_b32 a192, v16
  v_accvgpr_write_b32 a193, v17
  v_accvgpr_write_b32 a194, v18
  v_accvgpr_write_b32 a195, v19
  v_and_b32 v12, 7, v3
  v_lshrrev_b32 v13, 3, v3
  v_add_u32 v13, 2, v13
  v_and_b32 v52, 1, v12
  v_lshlrev_b32 v52, 4, v52
  v_mov_b32 v53, 0x3f80
  v_lshlrev_b32 v52, v52, v53
  v_cmp_eq_u32 vcc, v13, v4
  s_nop 1
  v_cndmask_b32 v52, 0, v52, vcc
  v_lshrrev_b32 v53, 1, v12
  v_cmp_eq_u32 vcc, 0, v53
  s_nop 1
  v_cndmask_b32 v16, 0, v52, vcc
  v_cmp_eq_u32 vcc, 1, v53
  s_nop 1
  v_cndmask_b32 v17, 0, v52, vcc
  v_cmp_eq_u32 vcc, 2, v53
  s_nop 1
  v_cndmask_b32 v18, 0, v52, vcc
  v_cmp_eq_u32 vcc, 3, v53
  s_nop 1
  v_cndmask_b32 v19, 0, v52, vcc
  v_accvgpr_write_b32 a196, v16
  v_accvgpr_write_b32 a197, v17
  v_accvgpr_write_b32 a198, v18
  v_accvgpr_write_b32 a199, v19
  v_and_b32 v12, 3, v3
  v_lshrrev_b32 v13, 2, v3
  v_and_b32 v52, 1, v12
  v_lshlrev_b32 v52, 4, v52
  v_mov_b32 v53, 0x3f80
  v_lshlrev_b32 v52, v52, v53
  v_cmp_eq_u32 vcc, v13, v4
  s_nop 1
  v_cndmask_b32 v52, 0, v52, vcc
  v_lshrrev_b32 v53, 1, v12
  v_cmp_eq_u32 vcc, 0, v53
  s_nop 1
  v_cndmask_b32 v16, 0, v52, vcc
  v_cmp_eq_u32 vcc, 1, v53
  s_nop 1
  v_cndmask_b32 v17, 0, v52, vcc
  v_cmp_eq_u32 vcc, 2, v53
  s_nop 1
  v_cndmask_b32 v18, 0, v52, vcc
  v_cmp_eq_u32 vcc, 3, v53
  s_nop 1
  v_cndmask_b32 v19, 0, v52, vcc
  v_accvgpr_write_b32 a200, v16
  v_accvgpr_write_b32 a201, v17
  v_accvgpr_write_b32 a202, v18
  v_accvgpr_write_b32 a203, v19
  v_and_b32 v12, 1, v4
  v_cmp_eq_u32 s[52:53], 1, v12
  v_lshrrev_b32 v13, 1, v4
  v_lshl_add_u32 v13, v13, 4, v3
  v_and_b32 v12, 0xc0, v0
  v_add_u32 v13, v13, v12
  v_mov_b32 v52, 160
  v_cmp_le_u32 s[56:57], v52, v13
  v_mov_b32 v52, 210
  v_cmp_gt_u32 s[58:59], v52, v13
  v_subrev_u32 v52, 160, v13
  v_cndmask_b32 v12, v13, v52, s[56:57]
  v_cndmask_b32 v12, 0, v12, s[58:59]
  v_mov_b32 v52, 160
  v_cndmask_b32 v52, v52, 50, s[56:57]
  v_cndmask_b32 v52, 0, v52, s[52:53]
  v_add_u32 v12, v52, v12
  v_lshrrev_b32 v56, 6, v12
  v_bfe_u32 v57, v12, 4, 2
  v_and_b32 v58, 15, v12
  v_mul_u32_u24 v60, 205, v12
  v_lshrrev_b32 v60, 12, v60
  v_cndmask_b32 v56, v56, v60, s[56:57]
  v_mul_u32_u24 v60, 20, v60
  v_sub_u32 v60, v12, v60
  v_mul_u32_u24 v61, 13, v60
  v_lshrrev_b32 v61, 6, v61
  v_cndmask_b32 v57, v57, v61, s[56:57]
  v_mul_u32_u24 v61, 5, v61
  v_sub_u32 v60, v60, v61
  v_cmp_gt_u32 vcc, 4, v56
  v_lshrrev_b32 v61, 1, v57
  v_and_b32 v59, 1, v56
  v_cndmask_b32 v59, v61, v59, vcc
  v_lshrrev_b32 v61, 1, v56
  v_lshlrev_b32 v61, 5, v61
  v_and_b32 v62, 1, v57
  v_cndmask_b32 v62, v62, v57, vcc
  v_lshl_add_u32 v61, v62, 3, v61
  v_subrev_u32 v62, 1, v60
  v_lshrrev_b32 v63, 1, v62
  v_and_b32 v62, 1, v62
  v_lshl_add_u32 v62, v63, 2, v62
  v_lshl_add_u32 v62, v59, 3, v62
  v_add_u32 v62, 2, v62
  v_add_u32 v63, 15, v60
  v_cmp_eq_u32 vcc, 0, v60
  s_nop 1
  v_cndmask_b32 v62, v62, 0, vcc
  v_cndmask_b32 v63, v63, 20, vcc
  v_cndmask_b32 v62, v58, v62, s[56:57]
  v_cndmask_b32 v63, v58, v63, s[56:57]
  v_add_u32 v60, 5, v56
  v_cndmask_b32 v56, v56, v60, s[56:57]
  v_lshl_add_u32 v56, v56, 2, v57
  v_lshl_add_u32 v56, v56, 4, v62
  v_lshlrev_b32 v53, 4, v56
  v_mul_u32_u24 v59, 21, v59
  v_add_u32 v59, v59, v63
  v_mul_u32_u24 v59, 80, v59
  v_add_u32 v18, v59, v61
  v_mov_b32 v12, 3456
  v_cndmask_b32 v18, v12, v18, s[58:59]
  v_add_u32 v18, 122880, v18
  v_add_u32 v13, 32, v13
  v_mov_b32 v52, 160
  v_cmp_le_u32 s[56:57], v52, v13
  v_mov_b32 v52, 210
  v_cmp_gt_u32 s[58:59], v52, v13
  v_subrev_u32 v52, 160, v13
  v_cndmask_b32 v12, v13, v52, s[56:57]
  v_cndmask_b32 v12, 0, v12, s[58:59]
  v_mov_b32 v52, 160
  v_cndmask_b32 v52, v52, 50, s[56:57]
  v_cndmask_b32 v52, 0, v52, s[52:53]
  v_add_u32 v12, v52, v12
  v_lshrrev_b32 v56, 6, v12
  v_bfe_u32 v57, v12, 4, 2
  v_and_b32 v58, 15, v12
  v_mul_u32_u24 v60, 205, v12
  v_lshrrev_b32 v60, 12, v60
  v_cndmask_b32 v56, v56, v60, s[56:57]
  v_mul_u32_u24 v60, 20, v60
  v_sub_u32 v60, v12, v60
  v_mul_u32_u24 v61, 13, v60
  v_lshrrev_b32 v61, 6, v61
  v_cndmask_b32 v57, v57, v61, s[56:57]
  v_mul_u32_u24 v61, 5, v61
  v_sub_u32 v60, v60, v61
  v_cmp_gt_u32 vcc, 4, v56
  v_lshrrev_b32 v61, 1, v57
  v_and_b32 v59, 1, v56
  v_cndmask_b32 v59, v61, v59, vcc
  v_lshrrev_b32 v61, 1, v56
  v_lshlrev_b32 v61, 5, v61
  v_and_b32 v62, 1, v57
  v_cndmask_b32 v62, v62, v57, vcc
  v_lshl_add_u32 v61, v62, 3, v61
  v_subrev_u32 v62, 1, v60
  v_lshrrev_b32 v63, 1, v62
  v_and_b32 v62, 1, v62
  v_lshl_add_u32 v62, v63, 2, v62
  v_lshl_add_u32 v62, v59, 3, v62
  v_add_u32 v62, 2, v62
  v_add_u32 v63, 15, v60
  v_cmp_eq_u32 vcc, 0, v60
  s_nop 1
  v_cndmask_b32 v62, v62, 0, vcc
  v_cndmask_b32 v63, v63, 20, vcc
  v_cndmask_b32 v62, v58, v62, s[56:57]
  v_cndmask_b32 v63, v58, v63, s[56:57]
  v_add_u32 v60, 5, v56
  v_cndmask_b32 v56, v56, v60, s[56:57]
  v_lshl_add_u32 v56, v56, 2, v57
  v_lshl_add_u32 v56, v56, 4, v62
  v_lshlrev_b32 v53, 4, v56
  v_mul_u32_u24 v59, 21, v59
  v_add_u32 v59, v59, v63
  v_mul_u32_u24 v59, 80, v59
  v_add_u32 v19, v59, v61
  v_mov_b32 v12, 3456
  v_cndmask_b32 v19, v12, v19, s[58:59]
  v_add_u32 v19, 122880, v19
  v_mov_b32 v52, 160
  v_cmp_le_u32 s[56:57], v52, v0
  v_mov_b32 v52, 210
  v_cmp_gt_u32 s[58:59], v52, v0
  v_subrev_u32 v52, 160, v0
  v_cndmask_b32 v12, v0, v52, s[56:57]
  v_cndmask_b32 v12, 0, v12, s[58:59]
  v_lshrrev_b32 v56, 6, v12
  v_bfe_u32 v57, v12, 4, 2
  v_and_b32 v58, 15, v12
  v_mul_u32_u24 v60, 205, v12
  v_lshrrev_b32 v60, 12, v60
  v_cndmask_b32 v56, v56, v60, s[56:57]
  v_mul_u32_u24 v60, 20, v60
  v_sub_u32 v60, v12, v60
  v_mul_u32_u24 v61, 13, v60
  v_lshrrev_b32 v61, 6, v61
  v_cndmask_b32 v57, v57, v61, s[56:57]
  v_mul_u32_u24 v61, 5, v61
  v_sub_u32 v60, v60, v61
  v_cmp_gt_u32 vcc, 4, v56
  v_lshrrev_b32 v61, 1, v57
  v_and_b32 v59, 1, v56
  v_cndmask_b32 v59, v61, v59, vcc
  v_lshrrev_b32 v61, 1, v56
  v_lshlrev_b32 v61, 5, v61
  v_and_b32 v62, 1, v57
  v_cndmask_b32 v62, v62, v57, vcc
  v_lshl_add_u32 v61, v62, 3, v61
  v_subrev_u32 v62, 1, v60
  v_lshrrev_b32 v63, 1, v62
  v_and_b32 v62, 1, v62
  v_lshl_add_u32 v62, v63, 2, v62
  v_lshl_add_u32 v62, v59, 3, v62
  v_add_u32 v62, 2, v62
  v_add_u32 v63, 15, v60
  v_cmp_eq_u32 vcc, 0, v60
  s_nop 1
  v_cndmask_b32 v62, v62, 0, vcc
  v_cndmask_b32 v63, v63, 20, vcc
  v_cndmask_b32 v62, v58, v62, s[56:57]
  v_cndmask_b32 v63, v58, v63, s[56:57]
  v_add_u32 v60, 5, v56
  v_cndmask_b32 v56, v56, v60, s[56:57]
  v_lshl_add_u32 v56, v56, 2, v57
  v_lshl_add_u32 v56, v56, 4, v62
  v_lshlrev_b32 v16, 4, v56
  v_mul_u32_u24 v59, 21, v59
  v_add_u32 v59, v59, v63
  v_mul_u32_u24 v59, 80, v59
  v_add_u32 v53, v59, v61
  v_add_u32 v16, 45056, v16
  v_mov_b32 v52, 160
  v_cmp_le_u32 s[56:57], v52, v0
  v_mov_b32 v52, 210
  v_cmp_gt_u32 s[58:59], v52, v0
  v_subrev_u32 v52, 160, v0
  v_cndmask_b32 v12, v0, v52, s[56:57]
  v_cndmask_b32 v12, 0, v12, s[58:59]
  v_mov_b32 v52, 160
  v_cndmask_b32 v52, v52, 50, s[56:57]
  v_add_u32 v12, v52, v12
  v_lshrrev_b32 v56, 6, v12
  v_bfe_u32 v57, v12, 4, 2
  v_and_b32 v58, 15, v12
  v_mul_u32_u24 v60, 205, v12
  v_lshrrev_b32 v60, 12, v60
  v_cndmask_b32 v56, v56, v60, s[56:57]
  v_mul_u32_u24 v60, 20, v60
  v_sub_u32 v60, v12, v60
  v_mul_u32_u24 v61, 13, v60
  v_lshrrev_b32 v61, 6, v61
  v_cndmask_b32 v57, v57, v61, s[56:57]
  v_mul_u32_u24 v61, 5, v61
  v_sub_u32 v60, v60, v61
  v_cmp_gt_u32 vcc, 4, v56
  v_lshrrev_b32 v61, 1, v57
  v_and_b32 v59, 1, v56
  v_cndmask_b32 v59, v61, v59, vcc
  v_lshrrev_b32 v61, 1, v56
  v_lshlrev_b32 v61, 5, v61
  v_and_b32 v62, 1, v57
  v_cndmask_b32 v62, v62, v57, vcc
  v_lshl_add_u32 v61, v62, 3, v61
  v_subrev_u32 v62, 1, v60
  v_lshrrev_b32 v63, 1, v62
  v_and_b32 v62, 1, v62
  v_lshl_add_u32 v62, v63, 2, v62
  v_lshl_add_u32 v62, v59, 3, v62
  v_add_u32 v62, 2, v62
  v_add_u32 v63, 15, v60
  v_cmp_eq_u32 vcc, 0, v60
  s_nop 1
  v_cndmask_b32 v62, v62, 0, vcc
  v_cndmask_b32 v63, v63, 20, vcc
  v_cndmask_b32 v62, v58, v62, s[56:57]
  v_cndmask_b32 v63, v58, v63, s[56:57]
  v_add_u32 v60, 5, v56
  v_cndmask_b32 v56, v56, v60, s[56:57]
  v_lshl_add_u32 v56, v56, 2, v57
  v_lshl_add_u32 v56, v56, 4, v62
  v_lshlrev_b32 v17, 4, v56
  v_mul_u32_u24 v59, 21, v59
  v_add_u32 v59, v59, v63
  v_mul_u32_u24 v59, 80, v59
  v_add_u32 v53, v59, v61
  v_add_u32 v17, 45056, v17
  v_lshlrev_b32 v20, 4, v0
  v_mov_b32 v12, 1879048192
  v_cndmask_b32 v20, v12, v20, s[58:59]
  v_mov_b32 v60, 3360
  v_and_b32 v56, 1, v4
  v_lshlrev_b32 v56, 4, v56
  v_lshrrev_b32 v62, 1, v4
  v_mul_u32_u24 v61, 80, v3
  v_add_u32 v61, v61, v56
  v_cmp_eq_u32 vcc, 0, v62
  s_nop 1
  v_cndmask_b32 v21, v60, v61, vcc
  v_add_u32 v61, 1680, v61
  v_cndmask_b32 v22, v61, v60, vcc
  v_and_b32 v57, 3, v3
  v_lshrrev_b32 v58, 2, v3
  v_lshl_add_u32 v58, v58, 1, v57
  v_subrev_u32 v58, 2, v58
  v_lshrrev_b32 v59, 2, v58
  v_and_b32 v58, 3, v58
  v_add_u32 v58, 16, v58
  v_cmp_gt_u32 vcc, 2, v57
  s_nop 1
  v_cndmask_b32 v59, v59, v57, vcc
  v_cndmask_b32 v58, v58, 20, vcc
  v_mul_u32_u24 v61, 21, v59
  v_add_u32 v61, v61, v58
  v_mul_u32_u24 v61, 80, v61
  v_add_u32 v61, v61, v56
  v_cmp_eq_u32 vcc, v59, v62
  s_nop 1
  v_cndmask_b32 v23, v60, v61, vcc
  v_add_u32 v21, 122880, v21
  v_add_u32 v22, 122880, v22
  v_add_u32 v23, 122880, v23
  v_accvgpr_write_b32 a204, v16
  v_accvgpr_write_b32 a205, v17
  v_accvgpr_write_b32 a206, v18
  v_accvgpr_write_b32 a207, v19
  v_accvgpr_write_b32 a208, v20
  v_accvgpr_write_b32 a209, v21
  v_accvgpr_write_b32 a210, v22
  v_accvgpr_write_b32 a211, v23
  v_and_b32 v0, 7, v1
  v_lshlrev_b32 v0, 8, v0
  v_readfirstlane_b32 s87, v243
  s_lshl_b32 s58, s14, 8
  s_lshl_b32 s59, s13, 8
  s_add_u32 s59, s59, 8704
  v_min_u32 v15, 7, v1
  v_lshl_add_u32 v12, v15, 2, s58
  v_and_b32 v13, 1, v15
  v_lshl_add_u32 v13, v13, 2, s59
  s_cmp_eq_u32 s13, 0
  s_cselect_b32 s59, 0, 256
  v_cmp_eq_u32 vcc, 5, v15
  v_subrev_u32 v49, s59, v13
  s_nop 0
  v_cndmask_b32 v13, v13, v49, vcc
  v_cmp_gt_u32 vcc, 5, v15
  s_nop 1
  v_cndmask_b32 v12, v13, v12, vcc
  v_add_u32 v13, 44, v1
  v_cmp_gt_u32 vcc, 20, v1
  s_nop 1
  v_cndmask_b32 v13, v13, v1, vcc
  v_lshlrev_b32 v49, 2, v13
  v_add_u32 v49, 8192, v49
  v_subrev_u32 v13, 40, v1
  s_add_u32 s58, s58, 4096
  v_lshl_add_u32 v15, v13, 2, s58
  v_cmp_gt_u32 vcc, 5, v13
  s_nop 1
  v_cndmask_b32 v49, v49, v15, vcc
  v_mov_b32 v15, 12800
  v_cmp_lt_u32 vcc, 44, v1
  s_nop 1
  v_cndmask_b32 v49, v49, v15, vcc
  s_mov_b32 s62, 0
  s_cmp_eq_u32 s12, 0
  s_cbranch_scc0 bo_2
  s_mov_b32 s63, 32374784
bp_1:
  buffer_load_dword v15, v12, s[4:7], s63 offen sc1
  s_add_u32 s62, s62, 1
  s_waitcnt vmcnt(0)
  v_cmp_ne_u32 vcc, v243, v15
  s_cmp_lt_u32 s62, 0x8000
  s_cselect_b64 vcc, vcc, 0
  s_nop 4
  s_cbranch_vccz bo_2
  s_sleep 8
  s_branch bp_1
bo_2:
  s_barrier
  s_mul_i32 s94, s12, 5120
  s_add_u32 s95, s94, s26
  s_add_u32 m0, s94, 0
  s_add_u32 s93, s95, 0
  buffer_load_dwordx4 v2, s[4:7], s93 offen offset:0 sc1 lds
  buffer_load_dwordx4 v2, s[4:7], s93 offen offset:1024 sc1 lds
  buffer_load_dwordx4 v2, s[4:7], s93 offen offset:2048 sc1 lds
  buffer_load_dwordx4 v2, s[4:7], s93 offen offset:3072 sc1 lds
  s_add_u32 m0, s94, 4096
  s_add_u32 s93, s95, 4096
  buffer_load_dwordx4 v2, s[4:7], s93 offen offset:0 sc1 lds
  s_add_u32 s34, s30, 0
  buffer_load_dwordx4 a[0:3], v2, s[4:7], s34 offen offset:0 sc1
  buffer_load_dwordx4 a[4:7], v5, s[4:7], s34 offen offset:0 sc1
  buffer_load_dwordx4 a[8:11], v2, s[4:7], s34 offen offset:1024 sc1
  buffer_load_dwordx4 a[12:15], v5, s[4:7], s34 offen offset:1024 sc1
  s_add_u32 s35, s31, 0
  buffer_load_dwordx4 a[160:163], v2, s[4:7], s35 offen sc1
  buffer_load_dwordx4 a[16:19], v2, s[4:7], s34 offen offset:2048 sc1
  buffer_load_dwordx4 a[20:23], v5, s[4:7], s34 offen offset:2048 sc1
  buffer_load_dwordx4 a[24:27], v2, s[4:7], s34 offen offset:3072 sc1
  buffer_load_dwordx4 a[28:31], v5, s[4:7], s34 offen offset:3072 sc1
  s_mul_i32 s94, s12, 5120
  s_add_u32 s95, s94, s26
  s_add_u32 m0, s94, 20480
  s_add_u32 s93, s95, 20480
  buffer_load_dwordx4 v2, s[4:7], s93 offen offset:0 sc1 lds
  buffer_load_dwordx4 v2, s[4:7], s93 offen offset:1024 sc1 lds
  buffer_load_dwordx4 v2, s[4:7], s93 offen offset:2048 sc1 lds
  buffer_load_dwordx4 v2, s[4:7], s93 offen offset:3072 sc1 lds
  s_add_u32 m0, s94, 24576
  s_add_u32 s93, s95, 24576
  buffer_load_dwordx4 v2, s[4:7], s93 offen offset:0 sc1 lds
  s_add_u32 s34, s30, 4096
  buffer_load_dwordx4 a[32:35], v2, s[4:7], s34 offen offset:0 sc1
  buffer_load_dwordx4 a[36:39], v5, s[4:7], s34 offen offset:0 sc1
  buffer_load_dwordx4 a[40:43], v2, s[4:7], s34 offen offset:1024 sc1
  buffer_load_dwordx4 a[44:47], v5, s[4:7], s34 offen offset:1024 sc1
  s_add_u32 s35, s31, 4096
  buffer_load_dwordx4 a[164:167], v2, s[4:7], s35 offen sc1
  buffer_load_dwordx4 a[48:51], v2, s[4:7], s34 offen offset:2048 sc1
  buffer_load_dwordx4 a[52:55], v5, s[4:7], s34 offen offset:2048 sc1
  buffer_load_dwordx4 a[56:59], v2, s[4:7], s34 offen offset:3072 sc1
  buffer_load_dwordx4 a[60:63], v5, s[4:7], s34 offen offset:3072 sc1
  buffer_load_dwordx4 v[224:227], v48, s[4:7], s37 offen offset:0 sc1
  buffer_load_dwordx4 v[228:231], v48, s[4:7], s37 offen offset:256 sc1
  buffer_load_dwordx4 v[232:235], v48, s[4:7], s37 offen offset:512 sc1
  buffer_load_dwordx4 v[236:239], v48, s[4:7], s37 offen offset:768 sc1
  v_lshlrev_b32 v12, 2, v4
  v_sub_u32 v12, v3, v12
  v_mov_b32 v15, 4048155338
  s_or_b32 s52, s13, s12
  s_cmp_eq_u32 s52, 0
  s_cselect_b64 s[52:53], -1, 0
  v_add_u32 v52, 0, v12
  v_alignbit_b32 v52, v52, v52, 1
  v_cmp_ge_u32 vcc, 7, v52
  v_add_u32 v53, 16, v12
  v_alignbit_b32 v53, v53, v53, 1
  v_cmp_ge_u32 s[56:57], 7, v53
  v_cndmask_b32 v20, v15, 0, vcc
  s_nop 0
  v_cndmask_b32 v16, v15, 0, s[56:57]
  v_cndmask_b32 v24, v16, v15, s[52:53]
  v_add_u32 v52, -1, v12
  v_alignbit_b32 v52, v52, v52, 1
  v_cmp_ge_u32 vcc, 7, v52
  v_add_u32 v53, 15, v12
  v_alignbit_b32 v53, v53, v53, 1
  v_cmp_ge_u32 s[56:57], 7, v53
  v_cndmask_b32 v21, v15, 0, vcc
  s_nop 0
  v_cndmask_b32 v17, v15, 0, s[56:57]
  v_cndmask_b32 v25, v17, v15, s[52:53]
  v_add_u32 v52, -2, v12
  v_alignbit_b32 v52, v52, v52, 1
  v_cmp_ge_u32 vcc, 7, v52
  v_add_u32 v53, 14, v12
  v_alignbit_b32 v53, v53, v53, 1
  v_cmp_ge_u32 s[56:57], 7, v53
  v_cndmask_b32 v22, v15, 0, vcc
  s_nop 0
  v_cndmask_b32 v18, v15, 0, s[56:57]
  v_cndmask_b32 v26, v18, v15, s[52:53]
  v_add_u32 v52, -3, v12
  v_alignbit_b32 v52, v52, v52, 1
  v_cmp_ge_u32 vcc, 7, v52
  v_add_u32 v53, 13, v12
  v_alignbit_b32 v53, v53, v53, 1
  v_cmp_ge_u32 s[56:57], 7, v53
  v_cndmask_b32 v23, v15, 0, vcc
  s_nop 0
  v_cndmask_b32 v19, v15, 0, s[56:57]
  v_cndmask_b32 v27, v19, v15, s[52:53]
  s_mov_b32 s54, 1051011932
  s_mov_b32 s55, 1051011932
  s_cmp_eq_u32 s12, 0
  s_cselect_b64 s[56:57], 0, -1
  s_waitcnt vmcnt(27)
  s_barrier
  s_cmp_eq_u32 s12, 0
  s_cbranch_scc0 lf_3
  s_mov_b64 exec, 1
  buffer_store_dword v243, v242, s[4:7], s96 offen sc1
  s_mov_b64 exec, -1
lf_3:
  ds_read_b128 v[140:143], v6 offset:0
  ds_read_b128 v[144:147], v6 offset:1024
  ds_read_b128 v[148:151], v6 offset:2048
  ds_read_b128 v[152:155], v6 offset:3072
  ds_read_b128 v[156:159], v6 offset:4096
  ds_read_b128 v[160:163], v6 offset:5120
  ds_read_b128 v[164:167], v6 offset:6144
  ds_read_b128 v[168:171], v6 offset:7168
  ds_read_b128 v[172:175], v6 offset:8192
  ds_read_b128 v[176:179], v6 offset:9216
  s_waitcnt vmcnt(25) lgkmcnt(5)
  v_mfma_f32_16x16x32_bf16 v[64:67], v[140:143], a[0:3], 0
  ds_read_b128 v[180:183], v6 offset:10240
  v_mfma_f32_16x16x32_bf16 v[68:71], v[140:143], a[4:7], 0
  ds_read_b128 v[184:187], v6 offset:11264
  v_mfma_f32_16x16x32_bf16 v[72:75], v[144:147], a[0:3], 0
  ds_read_b128 v[188:191], v6 offset:12288
  v_mfma_f32_16x16x32_bf16 v[76:79], v[144:147], a[4:7], 0
  ds_read_b128 v[192:195], v6 offset:13312
  v_mfma_f32_16x16x32_bf16 v[80:83], v[148:151], a[0:3], 0
  ds_read_b128 v[196:199], v6 offset:14336
  v_mfma_f32_16x16x32_bf16 v[84:87], v[148:151], a[4:7], 0
  s_mul_i32 s94, s12, 5120
  s_add_u32 s95, s94, s26
  s_add_u32 m0, s94, 40960
  s_add_u32 s93, s95, 40960
  buffer_load_dwordx4 v2, s[4:7], s93 offen offset:0 sc1 lds
  v_mfma_f32_16x16x32_bf16 v[88:91], v[152:155], a[0:3], 0
  buffer_load_dwordx4 v2, s[4:7], s93 offen offset:1024 sc1 lds
  v_mfma_f32_16x16x32_bf16 v[92:95], v[152:155], a[4:7], 0
  buffer_load_dwordx4 v2, s[4:7], s93 offen offset:2048 sc1 lds
  v_mfma_f32_16x16x32_bf16 v[96:99], v[156:159], a[0:3], 0
  buffer_load_dwordx4 v2, s[4:7], s93 offen offset:3072 sc1 lds
  v_mfma_f32_16x16x32_bf16 v[100:103], v[156:159], a[4:7], 0
  s_waitcnt vmcnt(26) lgkmcnt(5)
  v_mfma_f32_16x16x32_bf16 v[64:67], v[160:163], a[8:11], v[64:67]
  ds_read_b128 v[140:143], v6 offset:15360
  v_mfma_f32_16x16x32_bf16 v[68:71], v[160:163], a[12:15], v[68:71]
  ds_read_b128 v[144:147], v6 offset:16384
  v_mfma_f32_16x16x32_bf16 v[72:75], v[164:167], a[8:11], v[72:75]
  ds_read_b128 v[148:151], v6 offset:17408
  v_mfma_f32_16x16x32_bf16 v[76:79], v[164:167], a[12:15], v[76:79]
  ds_read_b128 v[152:155], v6 offset:18432
  v_mfma_f32_16x16x32_bf16 v[80:83], v[168:171], a[8:11], v[80:83]
  ds_read_b128 v[156:159], v6 offset:19456
  v_mfma_f32_16x16x32_bf16 v[84:87], v[168:171], a[12:15], v[84:87]
  s_add_u32 m0, s94, 45056
  s_add_u32 s93, s95, 45056
  buffer_load_dwordx4 v2, s[4:7], s93 offen offset:0 sc1 lds
  v_mfma_f32_16x16x32_bf16 v[88:91], v[172:175], a[8:11], v[88:91]
  s_add_u32 s34, s30, 8192
  buffer_load_dwordx4 a[64:67], v2, s[4:7], s34 offen offset:0 sc1
  v_mfma_f32_16x16x32_bf16 v[92:95], v[172:175], a[12:15], v[92:95]
  buffer_load_dwordx4 a[68:71], v5, s[4:7], s34 offen offset:0 sc1
  v_mfma_f32_16x16x32_bf16 v[96:99], v[176:179], a[8:11], v[96:99]
  v_mfma_f32_16x16x32_bf16 v[100:103], v[176:179], a[12:15], v[100:103]
  s_waitcnt vmcnt(20) lgkmcnt(5)
  s_barrier
  s_waitcnt vmcnt(27)
  v_mfma_f32_16x16x32_bf16 v[64:67], v[180:183], a[16:19], v[64:67]
  ds_read_b128 v[160:163], v6 offset:20480
  ds_read_b128 v[164:167], v6 offset:21504
  v_mfma_f32_16x16x32_bf16 v[68:71], v[180:183], a[20:23], v[68:71]
  ds_read_b128 v[168:171], v6 offset:22528
  ds_read_b128 v[172:175], v6 offset:23552
  v_mfma_f32_16x16x32_bf16 v[72:75], v[184:187], a[16:19], v[72:75]
  ds_read_b128 v[176:179], v6 offset:24576
  v_mfma_f32_16x16x32_bf16 v[76:79], v[184:187], a[20:23], v[76:79]
  ds_read_b128 v[200:203], v9 offset:0
  v_mfma_f32_16x16x32_bf16 v[80:83], v[188:191], a[16:19], v[80:83]
  ds_read_b128 v[204:207], v9 offset:1024
  v_mfma_f32_16x16x32_bf16 v[84:87], v[188:191], a[20:23], v[84:87]
  ds_read_b128 v[208:211], v9 offset:2048
  v_mfma_f32_16x16x32_bf16 v[88:91], v[192:195], a[16:19], v[88:91]
  buffer_load_dwordx4 a[72:75], v2, s[4:7], s34 offen offset:1024 sc1
  v_mfma_f32_16x16x32_bf16 v[92:95], v[192:195], a[20:23], v[92:95]
  buffer_load_dwordx4 a[76:79], v5, s[4:7], s34 offen offset:1024 sc1
  v_mfma_f32_16x16x32_bf16 v[96:99], v[196:199], a[16:19], v[96:99]
  s_add_u32 s35, s31, 8192
  buffer_load_dwordx4 a[168:171], v2, s[4:7], s35 offen sc1
  v_mfma_f32_16x16x32_bf16 v[100:103], v[196:199], a[20:23], v[100:103]
  buffer_load_dwordx4 a[80:83], v2, s[4:7], s34 offen offset:2048 sc1
  s_waitcnt vmcnt(29) lgkmcnt(8)
  s_waitcnt lgkmcnt(0)
  v_mfma_f32_16x16x32_bf16 v[128:131], v[200:203], a[160:163], 0
  v_mfma_f32_16x16x32_bf16 v[132:135], v[204:207], a[160:163], 0
  v_mfma_f32_16x16x32_bf16 v[136:139], v[208:211], a[160:163], 0
  v_mfma_f32_16x16x32_bf16 v[64:67], v[140:143], a[24:27], v[64:67]
  ds_read_b128 v[180:183], v6 offset:25600
  v_mfma_f32_16x16x32_bf16 v[68:71], v[140:143], a[28:31], v[68:71]
  ds_read_b128 v[184:187], v6 offset:26624
  v_mfma_f32_16x16x32_bf16 v[72:75], v[144:147], a[24:27], v[72:75]
  ds_read_b128 v[188:191], v6 offset:27648
  v_mfma_f32_16x16x32_bf16 v[76:79], v[144:147], a[28:31], v[76:79]
  ds_read_b128 v[192:195], v6 offset:28672
  v_mfma_f32_16x16x32_bf16 v[80:83], v[148:151], a[24:27], v[80:83]
  ds_read_b128 v[196:199], v6 offset:29696
  v_mfma_f32_16x16x32_bf16 v[84:87], v[148:151], a[28:31], v[84:87]
  buffer_load_dwordx4 a[84:87], v5, s[4:7], s34 offen offset:2048 sc1
  v_mfma_f32_16x16x32_bf16 v[88:91], v[152:155], a[24:27], v[88:91]
  buffer_load_dwordx4 a[88:91], v2, s[4:7], s34 offen offset:3072 sc1
  v_mfma_f32_16x16x32_bf16 v[92:95], v[152:155], a[28:31], v[92:95]
  buffer_load_dwordx4 a[92:95], v5, s[4:7], s34 offen offset:3072 sc1
  v_mfma_f32_16x16x32_bf16 v[96:99], v[156:159], a[24:27], v[96:99]
  v_mfma_f32_16x16x32_bf16 v[100:103], v[156:159], a[28:31], v[100:103]
  s_waitcnt vmcnt(25)
  v_mfma_f32_16x16x32_bf16 v[64:67], v[160:163], a[32:35], v[64:67]
  ds_read_b128 v[140:143], v6 offset:30720
  ds_read_b128 v[144:147], v6 offset:31744
  v_mfma_f32_16x16x32_bf16 v[68:71], v[160:163], a[36:39], v[68:71]
  ds_read_b128 v[148:151], v6 offset:32768
  v_mfma_f32_16x16x32_bf16 v[72:75], v[164:167], a[32:35], v[72:75]
  ds_read_b128 v[152:155], v6 offset:33792
  v_mfma_f32_16x16x32_bf16 v[76:79], v[164:167], a[36:39], v[76:79]
  ds_read_b128 v[156:159], v6 offset:34816
  v_mfma_f32_16x16x32_bf16 v[80:83], v[168:171], a[32:35], v[80:83]
  s_mul_i32 s94, s12, 5120
  s_add_u32 s95, s94, s26
  s_add_u32 m0, s94, 61440
  s_add_u32 s93, s95, 61440
  buffer_load_dwordx4 v2, s[4:7], s93 offen offset:0 sc1 lds
  v_mfma_f32_16x16x32_bf16 v[84:87], v[168:171], a[36:39], v[84:87]
  buffer_load_dwordx4 v2, s[4:7], s93 offen offset:1024 sc1 lds
  v_mfma_f32_16x16x32_bf16 v[88:91], v[172:175], a[32:35], v[88:91]
  buffer_load_dwordx4 v2, s[4:7], s93 offen offset:2048 sc1 lds
  v_mfma_f32_16x16x32_bf16 v[92:95], v[172:175], a[36:39], v[92:95]
  buffer_load_dwordx4 v2, s[4:7], s93 offen offset:3072 sc1 lds
  v_mfma_f32_16x16x32_bf16 v[96:99], v[176:179], a[32:35], v[96:99]
  s_add_u32 m0, s94, 65536
  s_add_u32 s93, s95, 65536
  buffer_load_dwordx4 v2, s[4:7], s93 offen offset:0 sc1 lds
  v_mfma_f32_16x16x32_bf16 v[100:103], v[176:179], a[36:39], v[100:103]
  s_add_u32 s34, s30, 12288
  buffer_load_dwordx4 a[96:99], v2, s[4:7], s34 offen offset:0 sc1
  s_waitcnt vmcnt(28) lgkmcnt(5)
  v_mfma_f32_16x16x32_bf16 v[64:67], v[180:183], a[40:43], v[64:67]
  ds_read_b128 v[160:163], v6 offset:35840
  v_mfma_f32_16x16x32_bf16 v[68:71], v[180:183], a[44:47], v[68:71]
  ds_read_b128 v[164:167], v6 offset:36864
  v_mfma_f32_16x16x32_bf16 v[72:75], v[184:187], a[40:43], v[72:75]
  ds_read_b128 v[168:171], v6 offset:37888
  v_mfma_f32_16x16x32_bf16 v[76:79], v[184:187], a[44:47], v[76:79]
  ds_read_b128 v[172:175], v6 offset:38912
  v_mfma_f32_16x16x32_bf16 v[80:83], v[188:191], a[40:43], v[80:83]
  ds_read_b128 v[176:179], v6 offset:39936
  v_mfma_f32_16x16x32_bf16 v[84:87], v[188:191], a[44:47], v[84:87]
  buffer_load_dwordx4 a[100:103], v5, s[4:7], s34 offen offset:0 sc1
  v_mfma_f32_16x16x32_bf16 v[88:91], v[192:195], a[40:43], v[88:91]
  buffer_load_dwordx4 a[104:107], v2, s[4:7], s34 offen offset:1024 sc1
  v_mfma_f32_16x16x32_bf16 v[92:95], v[192:195], a[44:47], v[92:95]
  buffer_load_dwordx4 a[108:111], v5, s[4:7], s34 offen offset:1024 sc1
  v_mfma_f32_16x16x32_bf16 v[96:99], v[196:199], a[40:43], v[96:99]
  s_add_u32 s35, s31, 12288
  buffer_load_dwordx4 a[172:175], v2, s[4:7], s35 offen sc1
  v_mfma_f32_16x16x32_bf16 v[100:103], v[196:199], a[44:47], v[100:103]
  buffer_load_dwordx4 a[112:115], v2, s[4:7], s34 offen offset:2048 sc1
  s_waitcnt vmcnt(20) lgkmcnt(5)
  s_barrier
  s_waitcnt vmcnt(31)
  v_mfma_f32_16x16x32_bf16 v[64:67], v[140:143], a[48:51], v[64:67]
  ds_read_b128 v[180:183], v6 offset:40960
  ds_read_b128 v[184:187], v6 offset:41984
  v_mfma_f32_16x16x32_bf16 v[68:71], v[140:143], a[52:55], v[68:71]
  ds_read_b128 v[188:191], v6 offset:43008
  ds_read_b128 v[192:195], v6 offset:44032
  v_mfma_f32_16x16x32_bf16 v[72:75], v[144:147], a[48:51], v[72:75]
  ds_read_b128 v[196:199], v6 offset:45056
  ds_read_b128 v[200:203], v9 offset:20480
  v_mfma_f32_16x16x32_bf16 v[76:79], v[144:147], a[52:55], v[76:79]
  ds_read_b128 v[204:207], v9 offset:21504
  ds_read_b128 v[208:211], v9 offset:22528
  v_mfma_f32_16x16x32_bf16 v[80:83], v[148:151], a[48:51], v[80:83]
  buffer_load_dwordx4 a[116:119], v5, s[4:7], s34 offen offset:2048 sc1
  v_mfma_f32_16x16x32_bf16 v[84:87], v[148:151], a[52:55], v[84:87]
  buffer_load_dwordx4 a[120:123], v2, s[4:7], s34 offen offset:3072 sc1
  v_mfma_f32_16x16x32_bf16 v[88:91], v[152:155], a[48:51], v[88:91]
  buffer_load_dwordx4 a[124:127], v5, s[4:7], s34 offen offset:3072 sc1
  v_mfma_f32_16x16x32_bf16 v[92:95], v[152:155], a[52:55], v[92:95]
  s_mul_i32 s91, s12, 15360
  s_add_u32 s92, s91, s26
  s_add_u32 m0, s91, 102400
  s_add_u32 s90, s92, 102400
  buffer_load_dwordx4 v2, s[4:7], s90 offen offset:0 sc1 lds
  v_mfma_f32_16x16x32_bf16 v[96:99], v[156:159], a[48:51], v[96:99]
  buffer_load_dwordx4 v2, s[4:7], s90 offen offset:1024 sc1 lds
  v_mfma_f32_16x16x32_bf16 v[100:103], v[156:159], a[52:55], v[100:103]
  buffer_load_dwordx4 v2, s[4:7], s90 offen offset:2048 sc1 lds
  s_waitcnt vmcnt(35) lgkmcnt(8)
  s_waitcnt lgkmcnt(0)
  v_mfma_f32_16x16x32_bf16 v[128:131], v[200:203], a[164:167], v[128:131]
  v_mfma_f32_16x16x32_bf16 v[132:135], v[204:207], a[164:167], v[132:135]
  v_mfma_f32_16x16x32_bf16 v[136:139], v[208:211], a[164:167], v[136:139]
  v_mfma_f32_16x16x32_bf16 v[64:67], v[160:163], a[56:59], v[64:67]
  ds_read_b128 v[140:143], v6 offset:46080
  v_mfma_f32_16x16x32_bf16 v[68:71], v[160:163], a[60:63], v[68:71]
  ds_read_b128 v[144:147], v6 offset:47104
  v_mfma_f32_16x16x32_bf16 v[72:75], v[164:167], a[56:59], v[72:75]
  ds_read_b128 v[148:151], v6 offset:48128
  v_mfma_f32_16x16x32_bf16 v[76:79], v[164:167], a[60:63], v[76:79]
  ds_read_b128 v[152:155], v6 offset:49152
  v_mfma_f32_16x16x32_bf16 v[80:83], v[168:171], a[56:59], v[80:83]
  ds_read_b128 v[156:159], v6 offset:50176
  v_mfma_f32_16x16x32_bf16 v[84:87], v[168:171], a[60:63], v[84:87]
  buffer_load_dwordx4 v2, s[4:7], s90 offen offset:3072 sc1 lds
  v_mfma_f32_16x16x32_bf16 v[88:91], v[172:175], a[56:59], v[88:91]
  s_add_u32 m0, s91, 106496
  s_add_u32 s90, s92, 106496
  buffer_load_dwordx4 v2, s[4:7], s90 offen offset:0 sc1 lds
  v_mfma_f32_16x16x32_bf16 v[92:95], v[172:175], a[60:63], v[92:95]
  buffer_load_dwordx4 v2, s[4:7], s90 offen offset:1024 sc1 lds
  v_mfma_f32_16x16x32_bf16 v[96:99], v[176:179], a[56:59], v[96:99]
  buffer_load_dwordx4 v2, s[4:7], s90 offen offset:2048 sc1 lds
  v_mfma_f32_16x16x32_bf16 v[100:103], v[176:179], a[60:63], v[100:103]
  buffer_load_dwordx4 v2, s[4:7], s90 offen offset:3072 sc1 lds
  s_waitcnt vmcnt(29)
  v_mfma_f32_16x16x32_bf16 v[64:67], v[180:183], a[64:67], v[64:67]
  ds_read_b128 v[160:163], v6 offset:51200
  ds_read_b128 v[164:167], v6 offset:52224
  v_mfma_f32_16x16x32_bf16 v[68:71], v[180:183], a[68:71], v[68:71]
  ds_read_b128 v[168:171], v6 offset:53248
  v_mfma_f32_16x16x32_bf16 v[72:75], v[184:187], a[64:67], v[72:75]
  ds_read_b128 v[172:175], v6 offset:54272
  v_mfma_f32_16x16x32_bf16 v[76:79], v[184:187], a[68:71], v[76:79]
  s_waitcnt vmcnt(36)
  v_add_f32 v12, v224, v226
  v_add_f32 v13, v225, v227
  v_add_f32 v15, v228, v230
  ds_read_b128 v[176:179], v6 offset:55296
  v_mfma_f32_16x16x32_bf16 v[80:83], v[188:191], a[64:67], v[80:83]
  v_add_f32 v34, v229, v231
  s_mul_i32 s94, s12, 5120
  s_add_u32 s95, s94, s26
  s_add_u32 m0, s94, 81920
  s_add_u32 s93, s95, 81920
  buffer_load_dwordx4 v2, s[4:7], s93 offen offset:0 sc1 lds
  v_mfma_f32_16x16x32_bf16 v[84:87], v[188:191], a[68:71], v[84:87]
  buffer_load_dwordx4 v2, s[4:7], s93 offen offset:1024 sc1 lds
  v_mfma_f32_16x16x32_bf16 v[88:91], v[192:195], a[64:67], v[88:91]
  buffer_load_dwordx4 v2, s[4:7], s93 offen offset:2048 sc1 lds
  v_mfma_f32_16x16x32_bf16 v[92:95], v[192:195], a[68:71], v[92:95]
  buffer_load_dwordx4 v2, s[4:7], s93 offen offset:3072 sc1 lds
  v_mfma_f32_16x16x32_bf16 v[96:99], v[196:199], a[64:67], v[96:99]
  s_add_u32 m0, s94, 86016
  s_add_u32 s93, s95, 86016
  buffer_load_dwordx4 v2, s[4:7], s93 offen offset:0 sc1 lds
  v_mfma_f32_16x16x32_bf16 v[100:103], v[196:199], a[68:71], v[100:103]
  s_add_u32 s34, s30, 16384
  buffer_load_dwordx4 a[128:131], v2, s[4:7], s34 offen offset:0 sc1
  s_waitcnt vmcnt(32) lgkmcnt(5)
  v_mfma_f32_16x16x32_bf16 v[64:67], v[140:143], a[72:75], v[64:67]
  ds_read_b128 v[180:183], v6 offset:56320
  v_mfma_f32_16x16x32_bf16 v[68:71], v[140:143], a[76:79], v[68:71]
  ds_read_b128 v[184:187], v6 offset:57344
  v_mfma_f32_16x16x32_bf16 v[72:75], v[144:147], a[72:75], v[72:75]
  v_add_f32 v12, v12, v232
  ds_read_b128 v[188:191], v6 offset:58368
  v_mfma_f32_16x16x32_bf16 v[76:79], v[144:147], a[76:79], v[76:79]
  v_add_f32 v13, v13, v233
  ds_read_b128 v[192:195], v6 offset:59392
  v_mfma_f32_16x16x32_bf16 v[80:83], v[148:151], a[72:75], v[80:83]
  v_add_f32 v15, v15, v234
  ds_read_b128 v[196:199], v6 offset:60416
  v_mfma_f32_16x16x32_bf16 v[84:87], v[148:151], a[76:79], v[84:87]
  v_add_f32 v34, v34, v235
  buffer_load_dwordx4 a[132:135], v5, s[4:7], s34 offen offset:0 sc1
  v_mfma_f32_16x16x32_bf16 v[88:91], v[152:155], a[72:75], v[88:91]
  v_add_f32 v12, v12, v236
  buffer_load_dwordx4 a[136:139], v2, s[4:7], s34 offen offset:1024 sc1
  v_mfma_f32_16x16x32_bf16 v[92:95], v[152:155], a[76:79], v[92:95]
  v_add_f32 v13, v13, v237
  buffer_load_dwordx4 a[140:143], v5, s[4:7], s34 offen offset:1024 sc1
  v_mfma_f32_16x16x32_bf16 v[96:99], v[156:159], a[72:75], v[96:99]
  v_add_f32 v15, v15, v238
  s_add_u32 s35, s31, 16384
  buffer_load_dwordx4 a[176:179], v2, s[4:7], s35 offen sc1
  v_mfma_f32_16x16x32_bf16 v[100:103], v[156:159], a[76:79], v[100:103]
  buffer_load_dwordx4 a[144:147], v2, s[4:7], s34 offen offset:2048 sc1
  s_waitcnt vmcnt(28) lgkmcnt(5)
  s_barrier
  s_waitcnt vmcnt(35)
  v_mfma_f32_16x16x32_bf16 v[64:67], v[160:163], a[80:83], v[64:67]
  v_add_u32 v6, 61440, v6
  ds_read_b128 v[140:143], v6 offset:0
  v_mfma_f32_16x16x32_bf16 v[68:71], v[160:163], a[84:87], v[68:71]
  ds_read_b128 v[144:147], v6 offset:1024
  ds_read_b128 v[148:151], v6 offset:2048
  v_mfma_f32_16x16x32_bf16 v[72:75], v[164:167], a[80:83], v[72:75]
  ds_read_b128 v[152:155], v6 offset:3072
  ds_read_b128 v[156:159], v6 offset:4096
  v_mfma_f32_16x16x32_bf16 v[76:79], v[164:167], a[84:87], v[76:79]
  ds_read_b128 v[200:203], v9 offset:40960
  ds_read_b128 v[204:207], v9 offset:41984
  v_mfma_f32_16x16x32_bf16 v[80:83], v[168:171], a[80:83], v[80:83]
  ds_read_b128 v[208:211], v9 offset:43008
  v_mfma_f32_16x16x32_bf16 v[84:87], v[168:171], a[84:87], v[84:87]
  v_add_f32 v34, v34, v239
  buffer_load_dwordx4 a[148:151], v5, s[4:7], s34 offen offset:2048 sc1
  v_mfma_f32_16x16x32_bf16 v[88:91], v[172:175], a[80:83], v[88:91]
  v_add_f32 v12, v12, v15
  buffer_load_dwordx4 a[152:155], v2, s[4:7], s34 offen offset:3072 sc1
  v_mfma_f32_16x16x32_bf16 v[92:95], v[172:175], a[84:87], v[92:95]
  v_add_f32 v13, v13, v34
  buffer_load_dwordx4 a[156:159], v5, s[4:7], s34 offen offset:3072 sc1
  v_mfma_f32_16x16x32_bf16 v[96:99], v[176:179], a[80:83], v[96:99]
  v_mul_f32 v12, 986500301, v12
  s_add_u32 m0, s91, 110592
  s_add_u32 s90, s92, 110592
  buffer_load_dwordx4 v2, s[4:7], s90 offen offset:0 sc1 lds
  v_mfma_f32_16x16x32_bf16 v[100:103], v[176:179], a[84:87], v[100:103]
  buffer_load_dwordx4 v2, s[4:7], s90 offen offset:1024 sc1 lds
  s_waitcnt vmcnt(38) lgkmcnt(8)
  s_waitcnt lgkmcnt(0)
  v_mfma_f32_16x16x32_bf16 v[128:131], v[200:203], a[168:171], v[128:131]
  v_mfma_f32_16x16x32_bf16 v[132:135], v[204:207], a[168:171], v[132:135]
  v_mul_f32 v13, 986500301, v13
  v_fma_f32 v13, -v12, v12, v13
  v_mfma_f32_16x16x32_bf16 v[136:139], v[208:211], a[168:171], v[136:139]
  v_cvt_pk_bf16_f32 v12, -v12, -v12
  v_max_f32 v13, 0, v13
  v_mfma_f32_16x16x32_bf16 v[64:67], v[180:183], a[88:91], v[64:67]
  ds_bpermute_b32 v36, v35, v12 offset:0
  ds_bpermute_b32 v40, v35, v12 offset:16
  ds_read_b128 v[160:163], v6 offset:5120
  v_mfma_f32_16x16x32_bf16 v[68:71], v[180:183], a[92:95], v[68:71]
  ds_bpermute_b32 v44, v35, v12 offset:32
  ds_read_b128 v[164:167], v6 offset:6144
  v_mfma_f32_16x16x32_bf16 v[72:75], v[184:187], a[88:91], v[72:75]
  v_cvt_pk_bf16_f32 v13, 0, v13
  ds_read_b128 v[168:171], v6 offset:7168
  v_mfma_f32_16x16x32_bf16 v[76:79], v[184:187], a[92:95], v[76:79]
  v_add_f32 v13, 925353388, v13
  ds_read_b128 v[172:175], v6 offset:8192
  v_mfma_f32_16x16x32_bf16 v[80:83], v[188:191], a[88:91], v[80:83]
  v_cvt_pk_bf16_f32 v13, 0, v13
  ds_read_b128 v[176:179], v6 offset:9216
  v_mfma_f32_16x16x32_bf16 v[84:87], v[188:191], a[92:95], v[84:87]
  v_sqrt_f32 v13, v13
  buffer_load_dwordx4 v2, s[4:7], s90 offen offset:2048 sc1 lds
  v_mfma_f32_16x16x32_bf16 v[88:91], v[192:195], a[88:91], v[88:91]
  buffer_load_dwordx4 v2, s[4:7], s90 offen offset:3072 sc1 lds
  v_mfma_f32_16x16x32_bf16 v[92:95], v[192:195], a[92:95], v[92:95]
  v_cvt_pk_bf16_f32 v13, 0, v13
  s_add_u32 m0, s91, 114688
  s_add_u32 s90, s92, 114688
  buffer_load_dwordx4 v2, s[4:7], s90 offen offset:0 sc1 lds
  v_mfma_f32_16x16x32_bf16 v[96:99], v[196:199], a[88:91], v[96:99]
  buffer_load_dwordx4 v2, s[4:7], s90 offen offset:1024 sc1 lds
  v_mfma_f32_16x16x32_bf16 v[100:103], v[196:199], a[92:95], v[100:103]
  buffer_load_dwordx4 v2, s[4:7], s90 offen offset:2048 sc1 lds
  s_waitcnt vmcnt(36)
  v_mfma_f32_16x16x32_bf16 v[64:67], v[140:143], a[96:99], v[64:67]
  v_rcp_f32 v34, v13
  ds_read_b128 v[180:183], v6 offset:10240
  v_mfma_f32_16x16x32_bf16 v[68:71], v[140:143], a[100:103], v[68:71]
  ds_read_b128 v[184:187], v6 offset:11264
  v_mfma_f32_16x16x32_bf16 v[72:75], v[144:147], a[96:99], v[72:75]
  ds_bpermute_b32 v28, v35, v34 offset:0
  ds_read_b128 v[188:191], v6 offset:12288
  v_mfma_f32_16x16x32_bf16 v[76:79], v[144:147], a[100:103], v[76:79]
  ds_bpermute_b32 v30, v35, v34 offset:16
  ds_read_b128 v[192:195], v6 offset:13312
  v_mfma_f32_16x16x32_bf16 v[80:83], v[148:151], a[96:99], v[80:83]
  ds_bpermute_b32 v32, v35, v34 offset:32
  ds_read_b128 v[196:199], v6 offset:14336
  v_mfma_f32_16x16x32_bf16 v[84:87], v[148:151], a[100:103], v[84:87]
  v_mfma_f32_16x16x32_bf16 v[88:91], v[152:155], a[96:99], v[88:91]
  v_mfma_f32_16x16x32_bf16 v[92:95], v[152:155], a[100:103], v[92:95]
  v_mfma_f32_16x16x32_bf16 v[96:99], v[156:159], a[96:99], v[96:99]
  v_mfma_f32_16x16x32_bf16 v[100:103], v[156:159], a[100:103], v[100:103]
  s_waitcnt vmcnt(33) lgkmcnt(8)
  v_mfma_f32_16x16x32_bf16 v[64:67], v[160:163], a[104:107], v[64:67]
  s_waitcnt lgkmcnt(1)
  s_cmp_eq_u32 s12, 0
  s_cselect_b64 s[40:41], -1, 0
  v_cndmask_b32 v44, 0, v44, s[40:41]
  ds_read_b128 v[140:143], v6 offset:15360
  v_mfma_f32_16x16x32_bf16 v[68:71], v[160:163], a[108:111], v[68:71]
  v_mov_b32 v37, v36
  ds_read_b128 v[144:147], v6 offset:16384
  v_mfma_f32_16x16x32_bf16 v[72:75], v[164:167], a[104:107], v[72:75]
  v_mov_b32 v41, v40
  ds_read_b128 v[148:151], v6 offset:17408
  v_mfma_f32_16x16x32_bf16 v[76:79], v[164:167], a[108:111], v[76:79]
  v_mov_b32 v45, v44
  ds_read_b128 v[152:155], v6 offset:18432
  v_mfma_f32_16x16x32_bf16 v[80:83], v[168:171], a[104:107], v[80:83]
  v_mov_b64 v[38:39], v[36:37]
  ds_read_b128 v[156:159], v6 offset:19456
  v_mfma_f32_16x16x32_bf16 v[84:87], v[168:171], a[108:111], v[84:87]
  v_mov_b64 v[42:43], v[40:41]
  v_mfma_f32_16x16x32_bf16 v[88:91], v[172:175], a[104:107], v[88:91]
  v_mov_b64 v[46:47], v[44:45]
  v_mfma_f32_16x16x32_bf16 v[92:95], v[172:175], a[108:111], v[92:95]
  v_mfma_f32_16x16x32_bf16 v[96:99], v[176:179], a[104:107], v[96:99]
  v_mfma_f32_16x16x32_bf16 v[100:103], v[176:179], a[108:111], v[100:103]
  s_waitcnt vmcnt(0) lgkmcnt(5)
  s_barrier
  s_waitcnt vmcnt(31)
  v_mfma_f32_16x16x32_bf16 v[64:67], v[180:183], a[112:115], v[64:67]
  ds_read_b128 v[160:163], v6 offset:20480
  ds_read_b128 v[164:167], v6 offset:21504
  v_mfma_f32_16x16x32_bf16 v[68:71], v[180:183], a[116:119], v[68:71]
  ds_read_b128 v[168:171], v6 offset:22528
  ds_read_b128 v[172:175], v6 offset:23552
  v_mfma_f32_16x16x32_bf16 v[72:75], v[184:187], a[112:115], v[72:75]
  ds_read_b128 v[176:179], v6 offset:24576
  v_mfma_f32_16x16x32_bf16 v[76:79], v[184:187], a[116:119], v[76:79]
  v_add_u32 v9, 61440, v9
  v_mfma_f32_16x16x32_bf16 v[80:83], v[188:191], a[112:115], v[80:83]
  ds_read_b128 v[200:203], v9 offset:0
  v_mfma_f32_16x16x32_bf16 v[84:87], v[188:191], a[116:119], v[84:87]
  ds_read_b128 v[204:207], v9 offset:1024
  v_mfma_f32_16x16x32_bf16 v[88:91], v[192:195], a[112:115], v[88:91]
  ds_read_b128 v[208:211], v9 offset:2048
  v_mfma_f32_16x16x32_bf16 v[92:95], v[192:195], a[116:119], v[92:95]
  ds_read_b128 v[212:215], v10 offset:0
  v_mfma_f32_16x16x32_bf16 v[96:99], v[196:199], a[112:115], v[96:99]
  ds_read_b128 v[216:219], v10 offset:1024
  v_mfma_f32_16x16x32_bf16 v[100:103], v[196:199], a[116:119], v[100:103]
  ds_read_b128 v[220:223], v11 offset:0
  s_waitcnt vmcnt(29) lgkmcnt(11)
  s_waitcnt lgkmcnt(0)
  v_mfma_f32_16x16x32_bf16 v[52:55], a[160:163], v[212:215], 0
  v_mfma_f32_16x16x32_bf16 v[56:59], a[160:163], v[216:219], 0
  v_mfma_f32_16x16x32_bf16 v[60:63], a[160:163], v[220:223], 0
  v_mfma_f32_16x16x32_bf16 v[128:131], v[200:203], a[172:175], v[128:131]
  v_mfma_f32_16x16x32_bf16 v[132:135], v[204:207], a[172:175], v[132:135]
  v_mfma_f32_16x16x32_bf16 v[136:139], v[208:211], a[172:175], v[136:139]
  v_mfma_f32_16x16x32_bf16 v[64:67], v[140:143], a[120:123], v[64:67]
  ds_read_b128 v[180:183], v6 offset:25600
  v_mfma_f32_16x16x32_bf16 v[68:71], v[140:143], a[124:127], v[68:71]
  ds_read_b128 v[184:187], v6 offset:26624
  v_mfma_f32_16x16x32_bf16 v[72:75], v[144:147], a[120:123], v[72:75]
  ds_read_b128 v[188:191], v6 offset:27648
  v_mfma_f32_16x16x32_bf16 v[76:79], v[144:147], a[124:127], v[76:79]
  ds_read_b128 v[192:195], v6 offset:28672
  v_mfma_f32_16x16x32_bf16 v[80:83], v[148:151], a[120:123], v[80:83]
  ds_read_b128 v[196:199], v6 offset:29696
  v_mfma_f32_16x16x32_bf16 v[84:87], v[148:151], a[124:127], v[84:87]
  ds_read_b128 v[212:215], v10 offset:10240
  v_mfma_f32_16x16x32_bf16 v[88:91], v[152:155], a[120:123], v[88:91]
  ds_read_b128 v[216:219], v10 offset:11264
  v_mfma_f32_16x16x32_bf16 v[92:95], v[152:155], a[124:127], v[92:95]
  ds_read_b128 v[220:223], v11 offset:10240
  v_mfma_f32_16x16x32_bf16 v[96:99], v[156:159], a[120:123], v[96:99]
  v_mfma_f32_16x16x32_bf16 v[100:103], v[156:159], a[124:127], v[100:103]
  s_waitcnt vmcnt(14)
  s_waitcnt lgkmcnt(0)
  v_mfma_f32_16x16x32_bf16 v[52:55], a[164:167], v[212:215], v[52:55]
  v_mfma_f32_16x16x32_bf16 v[56:59], a[164:167], v[216:219], v[56:59]
  v_mfma_f32_16x16x32_bf16 v[60:63], a[164:167], v[220:223], v[60:63]
  v_mfma_f32_16x16x32_bf16 v[64:67], v[160:163], a[128:131], v[64:67]
  ds_read_b128 v[140:143], v6 offset:30720
  v_mfma_f32_16x16x32_bf16 v[68:71], v[160:163], a[132:135], v[68:71]
  ds_read_b128 v[144:147], v6 offset:31744
  v_mfma_f32_16x16x32_bf16 v[72:75], v[164:167], a[128:131], v[72:75]
  ds_read_b128 v[148:151], v6 offset:32768
  v_mfma_f32_16x16x32_bf16 v[76:79], v[164:167], a[132:135], v[76:79]
  ds_read_b128 v[152:155], v6 offset:33792
  v_mfma_f32_16x16x32_bf16 v[80:83], v[168:171], a[128:131], v[80:83]
  ds_read_b128 v[156:159], v6 offset:34816
  v_mfma_f32_16x16x32_bf16 v[84:87], v[168:171], a[132:135], v[84:87]
  ds_read_b128 v[212:215], v10 offset:20480
  v_mfma_f32_16x16x32_bf16 v[88:91], v[172:175], a[128:131], v[88:91]
  ds_read_b128 v[216:219], v10 offset:21504
  v_mfma_f32_16x16x32_bf16 v[92:95], v[172:175], a[132:135], v[92:95]
  ds_read_b128 v[220:223], v11 offset:20480
  v_mfma_f32_16x16x32_bf16 v[96:99], v[176:179], a[128:131], v[96:99]
  v_mfma_f32_16x16x32_bf16 v[100:103], v[176:179], a[132:135], v[100:103]
  s_waitcnt vmcnt(11)
  s_waitcnt lgkmcnt(0)
  v_mfma_f32_16x16x32_bf16 v[52:55], a[168:171], v[212:215], v[52:55]
  v_mfma_f32_16x16x32_bf16 v[56:59], a[168:171], v[216:219], v[56:59]
  v_mfma_f32_16x16x32_bf16 v[60:63], a[168:171], v[220:223], v[60:63]
  v_mfma_f32_16x16x32_bf16 v[64:67], v[180:183], a[136:139], v[64:67]
  ds_read_b128 v[160:163], v6 offset:35840
  v_mfma_f32_16x16x32_bf16 v[68:71], v[180:183], a[140:143], v[68:71]
  ds_read_b128 v[164:167], v6 offset:36864
  v_mfma_f32_16x16x32_bf16 v[72:75], v[184:187], a[136:139], v[72:75]
  ds_read_b128 v[168:171], v6 offset:37888
  v_mfma_f32_16x16x32_bf16 v[76:79], v[184:187], a[140:143], v[76:79]
  ds_read_b128 v[172:175], v6 offset:38912
  v_mfma_f32_16x16x32_bf16 v[80:83], v[188:191], a[136:139], v[80:83]
  ds_read_b128 v[176:179], v6 offset:39936
  v_mfma_f32_16x16x32_bf16 v[84:87], v[188:191], a[140:143], v[84:87]
  ds_read_b128 v[212:215], v10 offset:30720
  v_mfma_f32_16x16x32_bf16 v[88:91], v[192:195], a[136:139], v[88:91]
  ds_read_b128 v[216:219], v10 offset:31744
  v_mfma_f32_16x16x32_bf16 v[92:95], v[192:195], a[140:143], v[92:95]
  ds_read_b128 v[220:223], v11 offset:30720
  v_mfma_f32_16x16x32_bf16 v[96:99], v[196:199], a[136:139], v[96:99]
  v_mfma_f32_16x16x32_bf16 v[100:103], v[196:199], a[140:143], v[100:103]
  s_waitcnt vmcnt(9)
  s_waitcnt lgkmcnt(0)
  v_mfma_f32_16x16x32_bf16 v[52:55], a[172:175], v[212:215], v[52:55]
  v_mfma_f32_16x16x32_bf16 v[56:59], a[172:175], v[216:219], v[56:59]
  v_mfma_f32_16x16x32_bf16 v[60:63], a[172:175], v[220:223], v[60:63]
  v_mfma_f32_16x16x32_bf16 v[64:67], v[140:143], a[144:147], v[64:67]
  ds_read_b128 v[180:183], v6 offset:40960
  ds_read_b128 v[184:187], v6 offset:41984
  v_mfma_f32_16x16x32_bf16 v[68:71], v[140:143], a[148:151], v[68:71]
  ds_read_b128 v[188:191], v6 offset:43008
  v_mfma_f32_16x16x32_bf16 v[72:75], v[144:147], a[144:147], v[72:75]
  ds_read_b128 v[192:195], v6 offset:44032
  v_mfma_f32_16x16x32_bf16 v[76:79], v[144:147], a[148:151], v[76:79]
  ds_read_b128 v[196:199], v6 offset:45056
  v_mfma_f32_16x16x32_bf16 v[80:83], v[148:151], a[144:147], v[80:83]
  ds_read_b128 v[200:203], v9 offset:20480
  v_mfma_f32_16x16x32_bf16 v[84:87], v[148:151], a[148:151], v[84:87]
  ds_read_b128 v[204:207], v9 offset:21504
  v_mfma_f32_16x16x32_bf16 v[88:91], v[152:155], a[144:147], v[88:91]
  ds_read_b128 v[208:211], v9 offset:22528
  v_mfma_f32_16x16x32_bf16 v[92:95], v[152:155], a[148:151], v[92:95]
  ds_read_b128 v[212:215], v10 offset:40960
  v_mfma_f32_16x16x32_bf16 v[96:99], v[156:159], a[144:147], v[96:99]
  ds_read_b128 v[216:219], v10 offset:41984
  v_mfma_f32_16x16x32_bf16 v[100:103], v[156:159], a[148:151], v[100:103]
  ds_read_b128 v[220:223], v11 offset:40960
  s_waitcnt vmcnt(7)
  s_waitcnt lgkmcnt(0)
  v_mfma_f32_16x16x32_bf16 v[52:55], a[176:179], v[212:215], v[52:55]
  v_mfma_f32_16x16x32_bf16 v[56:59], a[176:179], v[216:219], v[56:59]
  v_mfma_f32_16x16x32_bf16 v[60:63], a[176:179], v[220:223], v[60:63]
  v_mfma_f32_16x16x32_bf16 v[128:131], v[200:203], a[176:179], v[128:131]
  v_mfma_f32_16x16x32_bf16 v[132:135], v[204:207], a[176:179], v[132:135]
  v_mfma_f32_16x16x32_bf16 v[136:139], v[208:211], a[176:179], v[136:139]
  v_mfma_f32_16x16x32_bf16 v[64:67], v[160:163], a[152:155], v[64:67]
  ds_read_b128 v[212:215], v7 offset:51200
  v_mfma_f32_16x16x32_bf16 v[68:71], v[160:163], a[156:159], v[68:71]
  ds_read_b128 v[216:219], v7 offset:52224
  v_mfma_f32_16x16x32_bf16 v[72:75], v[164:167], a[152:155], v[72:75]
  ds_read_b128 v[220:223], v8 offset:51200
  v_mfma_f32_16x16x32_bf16 v[76:79], v[164:167], a[156:159], v[76:79]
  v_mfma_f32_16x16x32_bf16 v[80:83], v[168:171], a[152:155], v[80:83]
  v_mfma_f32_16x16x32_bf16 v[84:87], v[168:171], a[156:159], v[84:87]
  v_mfma_f32_16x16x32_bf16 v[88:91], v[172:175], a[152:155], v[88:91]
  v_mfma_f32_16x16x32_bf16 v[92:95], v[172:175], a[156:159], v[92:95]
  v_mfma_f32_16x16x32_bf16 v[96:99], v[176:179], a[152:155], v[96:99]
  v_mfma_f32_16x16x32_bf16 v[100:103], v[176:179], a[156:159], v[100:103]
  s_mov_b32 s62, 0
  s_cmp_eq_u32 s12, 0
  s_cbranch_scc0 bo_5
  s_mov_b32 s63, 32374784
bp_4:
  buffer_load_dword v15, v49, s[4:7], s63 offen sc1
  s_add_u32 s62, s62, 1
  s_waitcnt vmcnt(0)
  v_cmp_ne_u32 vcc, v243, v15
  s_cmp_lt_u32 s62, 0x8000
  s_cselect_b64 vcc, vcc, 0
  s_nop 4
  s_cbranch_vccz bo_5
  s_sleep 8
  s_branch bp_4
bo_5:
  s_waitcnt lgkmcnt(0)
  s_barrier
  v_mfma_f32_16x16x32_bf16 v[52:55], v[44:47], v[212:215], v[52:55]
  v_mfma_f32_16x16x32_bf16 v[56:59], v[44:47], v[216:219], v[56:59]
  v_mfma_f32_16x16x32_bf16 v[60:63], v[44:47], v[220:223], v[60:63]
  v_mfma_f32_16x16x32_bf16 v[64:67], v[180:183], v[36:39], v[64:67]
  ds_read_b128 v[224:227], v7 offset:0
  v_mfma_f32_16x16x32_bf16 v[68:71], v[180:183], v[40:43], v[68:71]
  ds_read_b128 v[228:231], v7 offset:1024
  v_mfma_f32_16x16x32_bf16 v[72:75], v[184:187], v[36:39], v[72:75]
  ds_read_b128 v[232:235], v8 offset:0
  v_mfma_f32_16x16x32_bf16 v[76:79], v[184:187], v[40:43], v[76:79]
  ds_read_b128 v[200:203], v7 offset:2560
  v_mfma_f32_16x16x32_bf16 v[80:83], v[188:191], v[36:39], v[80:83]
  ds_read_b128 v[204:207], v7 offset:3584
  v_mfma_f32_16x16x32_bf16 v[84:87], v[188:191], v[40:43], v[84:87]
  ds_read_b128 v[208:211], v8 offset:2560
  v_mfma_f32_16x16x32_bf16 v[88:91], v[192:195], v[36:39], v[88:91]
  v_mfma_f32_16x16x32_bf16 v[92:95], v[192:195], v[40:43], v[92:95]
  v_mfma_f32_16x16x32_bf16 v[96:99], v[196:199], v[36:39], v[96:99]
  v_mfma_f32_16x16x32_bf16 v[100:103], v[196:199], v[40:43], v[100:103]
  v_mfma_f32_16x16x32_bf16 v[128:131], v[188:191], v[44:47], v[128:131]
  v_mfma_f32_16x16x32_bf16 v[132:135], v[192:195], v[44:47], v[132:135]
  v_mfma_f32_16x16x32_bf16 v[136:139], v[196:199], v[44:47], v[136:139]
  s_mov_b32 s8, s100
  s_and_b32 s9, s101, 0xffff
  s_mov_b32 s10, 2621440
  s_mov_b32 s11, 0x20000
  s_waitcnt lgkmcnt(3)
  v_mfma_f32_16x16x32_bf16 v[104:107], a[0:3], v[224:227], 0
  s_mul_i32 s58, s12, 3072
  s_add_u32 s58, s58, 73728
  v_add_u32 v48, s58, v2
  ds_read_b128 v[212:215], v7 offset:5120
  v_mfma_f32_16x16x32_bf16 v[108:111], a[4:7], v[224:227], 0
  ds_read_b128 v[216:219], v7 offset:6144
  v_mfma_f32_16x16x32_bf16 v[112:115], a[0:3], v[228:231], 0
  s_lshl_b32 s58, s12, 11
  s_add_u32 s58, s58, 63488
  v_add_u32 v49, s58, v2
  ds_read_b128 v[220:223], v8 offset:5120
  v_mfma_f32_16x16x32_bf16 v[116:119], a[4:7], v[228:231], 0
  v_mfma_f32_16x16x32_bf16 v[120:123], a[0:3], v[232:235], 0
  ds_write_b128 v48, v[52:55] offset:12288
  v_mfma_f32_16x16x32_bf16 v[124:127], a[4:7], v[232:235], 0
  ds_write_b128 v48, v[56:59] offset:13312
  ds_write_b128 v48, v[60:63] offset:14336
  s_waitcnt lgkmcnt(6)
  v_mfma_f32_16x16x32_bf16 v[104:107], a[8:11], v[200:203], v[104:107]
  s_cmp_eq_u32 s12, 1
  s_cselect_b32 s58, 12288, 0
  s_cselect_b32 s59, 2560, 0
  s_add_u32 s58, s58, 73728
  s_add_u32 s59, s59, 98304
  v_add_u32 v12, s58, v2
  v_lshl_add_u32 v15, v1, 3, s59
  ds_read_b128 v[224:227], v7 offset:7680
  v_mfma_f32_16x16x32_bf16 v[108:111], a[12:15], v[200:203], v[108:111]
  ds_read_b128 v[228:231], v7 offset:8704
  v_mfma_f32_16x16x32_bf16 v[112:115], a[8:11], v[204:207], v[112:115]
  ds_read_b128 v[232:235], v8 offset:7680
  v_mfma_f32_16x16x32_bf16 v[116:119], a[12:15], v[204:207], v[116:119]
  s_add_u32 s36, s61, 0
  buffer_load_dwordx4 a[0:3], v2, s[4:7], s36 offen offset:0 sc1
  v_mfma_f32_16x16x32_bf16 v[120:123], a[8:11], v[208:211], v[120:123]
  buffer_load_dwordx4 a[4:7], v2, s[4:7], s36 offen offset:1024 sc1
  v_mfma_f32_16x16x32_bf16 v[124:127], a[12:15], v[208:211], v[124:127]
  s_waitcnt lgkmcnt(6)
  v_mfma_f32_16x16x32_bf16 v[104:107], a[16:19], v[212:215], v[104:107]
  v_pk_mul_f32 v[100:101], v[100:101], v[30:31] op_sel_hi:[1,0]
  v_pk_mul_f32 v[102:103], v[102:103], v[30:31] op_sel_hi:[1,0]
  v_pk_mul_f32 v[84:85], v[84:85], v[30:31] op_sel_hi:[1,0]
  v_pk_mul_f32 v[86:87], v[86:87], v[30:31] op_sel_hi:[1,0]
  v_pk_mul_f32 v[92:93], v[92:93], v[30:31] op_sel_hi:[1,0]
  v_pk_mul_f32 v[94:95], v[94:95], v[30:31] op_sel_hi:[1,0]
  v_pk_mul_f32 v[68:69], v[68:69], v[30:31] op_sel_hi:[1,0]
  v_pk_mul_f32 v[70:71], v[70:71], v[30:31] op_sel_hi:[1,0]
  v_pk_mul_f32 v[76:77], v[76:77], v[30:31] op_sel_hi:[1,0]
  v_pk_mul_f32 v[78:79], v[78:79], v[30:31] op_sel_hi:[1,0]
  v_pk_mul_f32 v[96:97], v[96:97], v[28:29] op_sel_hi:[1,0]
  v_pk_mul_f32 v[98:99], v[98:99], v[28:29] op_sel_hi:[1,0]
  v_pk_mul_f32 v[80:81], v[80:81], v[28:29] op_sel_hi:[1,0]
  v_pk_mul_f32 v[82:83], v[82:83], v[28:29] op_sel_hi:[1,0]
  v_pk_mul_f32 v[88:89], v[88:89], v[28:29] op_sel_hi:[1,0]
  v_pk_mul_f32 v[90:91], v[90:91], v[28:29] op_sel_hi:[1,0]
  v_pk_mul_f32 v[64:65], v[64:65], v[28:29] op_sel_hi:[1,0]
  v_pk_mul_f32 v[66:67], v[66:67], v[28:29] op_sel_hi:[1,0]
  v_pk_mul_f32 v[72:73], v[72:73], v[28:29] op_sel_hi:[1,0]
  v_pk_mul_f32 v[74:75], v[74:75], v[28:29] op_sel_hi:[1,0]
  ds_read_b128 v[200:203], v7 offset:10240
  v_mfma_f32_16x16x32_bf16 v[108:111], a[20:23], v[212:215], v[108:111]
  ds_read_b128 v[204:207], v7 offset:11264
  v_mfma_f32_16x16x32_bf16 v[112:115], a[16:19], v[216:219], v[112:115]
  ds_read_b128 v[208:211], v8 offset:10240
  v_mfma_f32_16x16x32_bf16 v[116:119], a[20:23], v[216:219], v[116:119]
  buffer_load_dwordx4 a[8:11], v2, s[4:7], s36 offen offset:2048 sc1
  v_mfma_f32_16x16x32_bf16 v[120:123], a[16:19], v[220:223], v[120:123]
  buffer_load_dwordx4 a[12:15], v2, s[4:7], s36 offen offset:3072 sc1
  v_mfma_f32_16x16x32_bf16 v[124:127], a[20:23], v[220:223], v[124:127]
  s_waitcnt lgkmcnt(3)
  v_mfma_f32_16x16x32_bf16 v[104:107], a[24:27], v[224:227], v[104:107]
  ds_read_b128 v[212:215], v7 offset:12800
  v_mfma_f32_16x16x32_bf16 v[108:111], a[28:31], v[224:227], v[108:111]
  ds_read_b128 v[216:219], v7 offset:13824
  v_mfma_f32_16x16x32_bf16 v[112:115], a[24:27], v[228:231], v[112:115]
  ds_read_b128 v[220:223], v8 offset:12800
  v_mfma_f32_16x16x32_bf16 v[116:119], a[28:31], v[228:231], v[116:119]
  buffer_load_dwordx4 a[16:19], v50, s[4:7], s36 offen sc1
  v_mfma_f32_16x16x32_bf16 v[120:123], a[24:27], v[232:235], v[120:123]
  s_add_u32 s36, s61, 5120
  buffer_load_dwordx4 a[20:23], v2, s[4:7], s36 offen offset:0 sc1
  v_mfma_f32_16x16x32_bf16 v[124:127], a[28:31], v[232:235], v[124:127]
  s_waitcnt lgkmcnt(3)
  v_mfma_f32_16x16x32_bf16 v[104:107], a[32:35], v[200:203], v[104:107]
  ds_read_b128 v[224:227], v7 offset:15360
  v_mfma_f32_16x16x32_bf16 v[108:111], a[36:39], v[200:203], v[108:111]
  ds_read_b128 v[228:231], v7 offset:16384
  v_mfma_f32_16x16x32_bf16 v[112:115], a[32:35], v[204:207], v[112:115]
  ds_read_b128 v[232:235], v8 offset:15360
  v_mfma_f32_16x16x32_bf16 v[116:119], a[36:39], v[204:207], v[116:119]
  buffer_load_dwordx4 a[24:27], v2, s[4:7], s36 offen offset:1024 sc1
  v_mfma_f32_16x16x32_bf16 v[120:123], a[32:35], v[208:211], v[120:123]
  buffer_load_dwordx4 a[28:31], v2, s[4:7], s36 offen offset:2048 sc1
  v_mfma_f32_16x16x32_bf16 v[124:127], a[36:39], v[208:211], v[124:127]
  s_waitcnt lgkmcnt(3)
  v_mfma_f32_16x16x32_bf16 v[104:107], a[40:43], v[212:215], v[104:107]
  ds_write_b128 v48, v[128:131] offset:0
  ds_read_b128 v[200:203], v7 offset:17920
  v_mfma_f32_16x16x32_bf16 v[108:111], a[44:47], v[212:215], v[108:111]
  ds_write_b128 v48, v[132:135] offset:1024
  ds_read_b128 v[204:207], v7 offset:18944
  v_mfma_f32_16x16x32_bf16 v[112:115], a[40:43], v[216:219], v[112:115]
  ds_write_b128 v48, v[136:139] offset:2048
  ds_read_b128 v[208:211], v8 offset:17920
  v_mfma_f32_16x16x32_bf16 v[116:119], a[44:47], v[216:219], v[116:119]
  v_cvt_pk_bf16_f32 v172, v84, v85
  buffer_load_dwordx4 a[32:35], v2, s[4:7], s36 offen offset:3072 sc1
  v_mfma_f32_16x16x32_bf16 v[120:123], a[40:43], v[220:223], v[120:123]
  v_cvt_pk_bf16_f32 v173, v86, v87
  buffer_load_dwordx4 a[36:39], v50, s[4:7], s36 offen sc1
  v_mfma_f32_16x16x32_bf16 v[124:127], a[44:47], v[220:223], v[124:127]
  v_cvt_pk_bf16_f32 v174, v102, 0
  s_waitcnt lgkmcnt(6)
  v_mfma_f32_16x16x32_bf16 v[104:107], a[48:51], v[224:227], v[104:107]
  v_mov_b32 v175, 0
  v_cvt_pk_bf16_f32 v176, v92, v93
  ds_read_b128 v[212:215], v7 offset:20480
  v_mfma_f32_16x16x32_bf16 v[108:111], a[52:55], v[224:227], v[108:111]
  v_cvt_pk_bf16_f32 v177, v94, v95
  ds_read_b128 v[216:219], v7 offset:21504
  v_mfma_f32_16x16x32_bf16 v[112:115], a[48:51], v[228:231], v[112:115]
  v_cvt_pk_bf16_f32 v178, v103, 0
  ds_read_b128 v[220:223], v8 offset:20480
  v_mfma_f32_16x16x32_bf16 v[116:119], a[52:55], v[228:231], v[116:119]
  v_mov_b32 v179, 0
  s_add_u32 s36, s61, 10240
  buffer_load_dwordx4 a[40:43], v2, s[4:7], s36 offen offset:0 sc1
  v_mfma_f32_16x16x32_bf16 v[120:123], a[48:51], v[232:235], v[120:123]
  buffer_load_dwordx4 a[44:47], v2, s[4:7], s36 offen offset:1024 sc1
  v_mfma_f32_16x16x32_bf16 v[124:127], a[52:55], v[232:235], v[124:127]
  ds_write_b128 v49, v[172:175] offset:2048
  s_waitcnt lgkmcnt(4)
  v_mfma_f32_16x16x32_bf16 v[104:107], a[56:59], v[200:203], v[104:107]
  ds_write_b128 v49, v[176:179] offset:3072
  v_cvt_pk_bf16_f32 v164, v80, v81
  ds_read_b128 v[224:227], v7 offset:23040
  v_mfma_f32_16x16x32_bf16 v[108:111], a[60:63], v[200:203], v[108:111]
  v_cvt_pk_bf16_f32 v165, v82, v83
  ds_read_b128 v[228:231], v7 offset:24064
  v_mfma_f32_16x16x32_bf16 v[112:115], a[56:59], v[204:207], v[112:115]
  v_cvt_pk_bf16_f32 v166, v98, 0
  ds_read_b128 v[232:235], v8 offset:23040
  v_mfma_f32_16x16x32_bf16 v[116:119], a[60:63], v[204:207], v[116:119]
  v_mov_b32 v167, 0
  buffer_load_dwordx4 a[48:51], v2, s[4:7], s36 offen offset:2048 sc1
  v_mfma_f32_16x16x32_bf16 v[120:123], a[56:59], v[208:211], v[120:123]
  v_cvt_pk_bf16_f32 v168, v88, v89
  buffer_load_dwordx4 a[52:55], v2, s[4:7], s36 offen offset:3072 sc1
  v_mfma_f32_16x16x32_bf16 v[124:127], a[60:63], v[208:211], v[124:127]
  v_cvt_pk_bf16_f32 v169, v90, v91
  s_waitcnt lgkmcnt(5)
  v_mfma_f32_16x16x32_bf16 v[104:107], a[64:67], v[212:215], v[104:107]
  v_cvt_pk_bf16_f32 v170, v99, 0
  v_mov_b32 v171, 0
  ds_read_b128 v[200:203], v7 offset:25600
  v_mfma_f32_16x16x32_bf16 v[108:111], a[68:71], v[212:215], v[108:111]
  v_cvt_pk_bf16_f32 v148, v68, v69
  ds_read_b128 v[204:207], v7 offset:26624
  v_mfma_f32_16x16x32_bf16 v[112:115], a[64:67], v[216:219], v[112:115]
  v_cvt_pk_bf16_f32 v149, v70, v71
  ds_read_b128 v[208:211], v8 offset:25600
  v_mfma_f32_16x16x32_bf16 v[116:119], a[68:71], v[216:219], v[116:119]
  v_cvt_pk_bf16_f32 v150, v100, 0
  s_mul_i32 s91, s12, 13312
  s_add_u32 s92, s91, s27
  s_add_u32 m0, s91, 0
  s_add_u32 s90, s92, 0
  buffer_load_dwordx4 v2, s[4:7], s90 offen offset:0 sc1 lds
  v_mfma_f32_16x16x32_bf16 v[120:123], a[64:67], v[220:223], v[120:123]
  buffer_load_dwordx4 a[56:59], v50, s[4:7], s36 offen sc1
  v_mfma_f32_16x16x32_bf16 v[124:127], a[68:71], v[220:223], v[124:127]
  s_add_u32 s36, s61, 15360
  buffer_load_dwordx4 a[60:63], v2, s[4:7], s36 offen offset:0 sc1
  s_waitcnt lgkmcnt(3)
  v_mfma_f32_16x16x32_bf16 v[104:107], a[72:75], v[224:227], v[104:107]
  ds_read_b128 v[212:215], v7 offset:28160
  v_mfma_f32_16x16x32_bf16 v[108:111], a[76:79], v[224:227], v[108:111]
  ds_read_b128 v[216:219], v7 offset:29184
  v_mfma_f32_16x16x32_bf16 v[112:115], a[72:75], v[228:231], v[112:115]
  ds_read_b128 v[220:223], v8 offset:28160
  v_mfma_f32_16x16x32_bf16 v[116:119], a[76:79], v[228:231], v[116:119]
  v_mov_b32 v151, 0
  buffer_load_dwordx4 v2, s[4:7], s90 offen offset:1024 sc1 lds
  v_mfma_f32_16x16x32_bf16 v[120:123], a[72:75], v[232:235], v[120:123]
  v_cvt_pk_bf16_f32 v152, v76, v77
  buffer_load_dwordx4 a[64:67], v2, s[4:7], s36 offen offset:1024 sc1
  v_mfma_f32_16x16x32_bf16 v[124:127], a[76:79], v[232:235], v[124:127]
  v_cvt_pk_bf16_f32 v153, v78, v79
  buffer_load_dwordx4 a[68:71], v2, s[4:7], s36 offen offset:2048 sc1
  s_waitcnt lgkmcnt(3)
  v_mfma_f32_16x16x32_bf16 v[104:107], a[80:83], v[200:203], v[104:107]
  v_cvt_pk_bf16_f32 v154, v101, 0
  ds_read_b128 v[224:227], v7 offset:30720
  v_mfma_f32_16x16x32_bf16 v[108:111], a[84:87], v[200:203], v[108:111]
  v_mov_b32 v155, 0
  ds_read_b128 v[228:231], v7 offset:31744
  v_mfma_f32_16x16x32_bf16 v[112:115], a[80:83], v[204:207], v[112:115]
  v_cvt_pk_bf16_f32 v140, v64, v65
  ds_read_b128 v[232:235], v8 offset:30720
  v_mfma_f32_16x16x32_bf16 v[116:119], a[84:87], v[204:207], v[116:119]
  v_cvt_pk_bf16_f32 v141, v66, v67
  buffer_load_dwordx4 v2, s[4:7], s90 offen offset:2048 sc1 lds
  v_mfma_f32_16x16x32_bf16 v[120:123], a[80:83], v[208:211], v[120:123]
  v_cvt_pk_bf16_f32 v142, v96, 0
  buffer_load_dwordx4 a[72:75], v2, s[4:7], s36 offen offset:3072 sc1
  v_mfma_f32_16x16x32_bf16 v[124:127], a[84:87], v[208:211], v[124:127]
  v_mov_b32 v143, 0
  buffer_load_dwordx4 a[76:79], v50, s[4:7], s36 offen sc1
  s_waitcnt lgkmcnt(3)
  v_mfma_f32_16x16x32_bf16 v[104:107], a[88:91], v[212:215], v[104:107]
  v_cvt_pk_bf16_f32 v144, v72, v73
  ds_read_b128 v[200:203], v7 offset:33280
  v_mfma_f32_16x16x32_bf16 v[108:111], a[92:95], v[212:215], v[108:111]
  v_cvt_pk_bf16_f32 v145, v74, v75
  ds_read_b128 v[204:207], v7 offset:34304
  v_mfma_f32_16x16x32_bf16 v[112:115], a[88:91], v[216:219], v[112:115]
  v_cvt_pk_bf16_f32 v146, v97, 0
  ds_read_b128 v[208:211], v8 offset:33280
  v_mfma_f32_16x16x32_bf16 v[116:119], a[92:95], v[216:219], v[116:119]
  v_mov_b32 v147, 0
  buffer_load_dwordx4 v2, s[4:7], s90 offen offset:3072 sc1 lds
  v_mfma_f32_16x16x32_bf16 v[120:123], a[88:91], v[220:223], v[120:123]
  s_waitcnt lgkmcnt(15)
  s_barrier
  s_add_u32 s36, s61, 20480
  buffer_load_dwordx4 a[80:83], v2, s[4:7], s36 offen offset:0 sc1
  v_mfma_f32_16x16x32_bf16 v[124:127], a[92:95], v[220:223], v[124:127]
  buffer_load_dwordx4 a[84:87], v2, s[4:7], s36 offen offset:1024 sc1
  s_waitcnt lgkmcnt(3)
  v_mfma_f32_16x16x32_bf16 v[104:107], a[96:99], v[224:227], v[104:107]
  v_mfma_f32_16x16x32_bf16 v[64:67], v[164:167], v[148:151], 0
  ds_read_b128 v[212:215], v7 offset:35840
  v_mfma_f32_16x16x32_bf16 v[108:111], a[100:103], v[224:227], v[108:111]
  v_mfma_f32_16x16x32_bf16 v[68:71], v[172:175], v[148:151], 0
  ds_read_b128 v[216:219], v7 offset:36864
  v_mfma_f32_16x16x32_bf16 v[112:115], a[96:99], v[228:231], v[112:115]
  v_mfma_f32_16x16x32_bf16 v[72:75], v[168:171], v[152:155], 0
  ds_read_b128 v[220:223], v8 offset:35840
  v_mfma_f32_16x16x32_bf16 v[116:119], a[100:103], v[228:231], v[116:119]
  v_mfma_f32_16x16x32_bf16 v[76:79], v[176:179], v[152:155], 0
  s_add_u32 m0, s91, 4096
  s_add_u32 s90, s92, 4096
  buffer_load_dwordx4 v2, s[4:7], s90 offen offset:0 sc1 lds
  v_mfma_f32_16x16x32_bf16 v[120:123], a[96:99], v[232:235], v[120:123]
  buffer_load_dwordx4 a[88:91], v2, s[4:7], s36 offen offset:2048 sc1
  v_mfma_f32_16x16x32_bf16 v[124:127], a[100:103], v[232:235], v[124:127]
  buffer_load_dwordx4 a[92:95], v2, s[4:7], s36 offen offset:3072 sc1
  s_waitcnt lgkmcnt(3)
  v_mfma_f32_16x16x32_bf16 v[104:107], a[104:107], v[200:203], v[104:107]
  ds_read_b128 v[128:131], v12 offset:0
  ds_read_b128 v[224:227], v7 offset:38400
  v_mfma_f32_16x16x32_bf16 v[108:111], a[108:111], v[200:203], v[108:111]
  ds_read_b128 v[132:135], v12 offset:1024
  ds_read_b128 v[228:231], v7 offset:39424
  v_mfma_f32_16x16x32_bf16 v[112:115], a[104:107], v[204:207], v[112:115]
  ds_read_b128 v[136:139], v12 offset:2048
  ds_read_b128 v[232:235], v8 offset:38400
  v_mfma_f32_16x16x32_bf16 v[116:119], a[108:111], v[204:207], v[116:119]
  ds_read_b128 v[180:183], v12 offset:3072
  buffer_load_dwordx4 v2, s[4:7], s90 offen offset:1024 sc1 lds
  v_mfma_f32_16x16x32_bf16 v[120:123], a[104:107], v[208:211], v[120:123]
  ds_read_b128 v[184:187], v12 offset:4096
  buffer_load_dwordx4 a[96:99], v50, s[4:7], s36 offen sc1
  v_mfma_f32_16x16x32_bf16 v[124:127], a[108:111], v[208:211], v[124:127]
  ds_read_b128 v[188:191], v12 offset:5120
  s_waitcnt lgkmcnt(9)
  v_mfma_f32_16x16x32_bf16 v[104:107], a[112:115], v[212:215], v[104:107]
  ds_read_b128 v[200:203], v7 offset:40960
  v_mfma_f32_16x16x32_bf16 v[108:111], a[116:119], v[212:215], v[108:111]
  ds_read_b128 v[204:207], v7 offset:41984
  v_mfma_f32_16x16x32_bf16 v[112:115], a[112:115], v[216:219], v[112:115]
  ds_read_b128 v[208:211], v8 offset:40960
  v_mfma_f32_16x16x32_bf16 v[116:119], a[116:119], v[216:219], v[116:119]
  buffer_load_dwordx4 v2, s[4:7], s90 offen offset:2048 sc1 lds
  v_mfma_f32_16x16x32_bf16 v[120:123], a[112:115], v[220:223], v[120:123]
  v_mfma_f32_16x16x32_bf16 v[124:127], a[116:119], v[220:223], v[124:127]
  s_waitcnt lgkmcnt(3)
  v_pk_fma_f32 v[64:65], v[64:65], s[54:55], v[16:17]
  v_pk_fma_f32 v[66:67], v[66:67], s[54:55], v[18:19]
  v_pk_fma_f32 v[68:69], v[68:69], s[54:55], v[20:21]
  v_pk_fma_f32 v[70:71], v[70:71], s[54:55], v[22:23]
  v_pk_fma_f32 v[72:73], v[72:73], s[54:55], v[16:17]
  v_pk_fma_f32 v[74:75], v[74:75], s[54:55], v[18:19]
  v_pk_fma_f32 v[76:77], v[76:77], s[54:55], v[20:21]
  v_pk_fma_f32 v[78:79], v[78:79], s[54:55], v[22:23]
  v_pk_add_f32 v[128:129], v[128:129], v[180:181]
  v_pk_add_f32 v[130:131], v[130:131], v[182:183]
  v_pk_add_f32 v[132:133], v[132:133], v[184:185]
  v_pk_add_f32 v[134:135], v[134:135], v[186:187]
  v_pk_add_f32 v[136:137], v[136:137], v[188:189]
  v_pk_add_f32 v[138:139], v[138:139], v[190:191]
  s_waitcnt lgkmcnt(6)
  v_mfma_f32_16x16x32_bf16 v[104:107], a[120:123], v[224:227], v[104:107]
  ds_read_b128 v[212:215], v7 offset:43520
  v_mfma_f32_16x16x32_bf16 v[108:111], a[124:127], v[224:227], v[108:111]
  ds_read_b128 v[216:219], v7 offset:44544
  v_mfma_f32_16x16x32_bf16 v[112:115], a[120:123], v[228:231], v[112:115]
  ds_read_b128 v[220:223], v8 offset:43520
  v_mfma_f32_16x16x32_bf16 v[116:119], a[124:127], v[228:231], v[116:119]
  buffer_load_dwordx4 v2, s[4:7], s90 offen offset:3072 sc1 lds
  v_mfma_f32_16x16x32_bf16 v[120:123], a[120:123], v[232:235], v[120:123]
  v_mfma_f32_16x16x32_bf16 v[124:127], a[124:127], v[232:235], v[124:127]
  s_waitcnt lgkmcnt(3)
  v_mfma_f32_16x16x32_bf16 v[104:107], a[128:131], v[200:203], v[104:107]
  ds_read_b128 v[224:227], v7 offset:46080
  v_mfma_f32_16x16x32_bf16 v[108:111], a[132:135], v[200:203], v[108:111]
  ds_read_b128 v[228:231], v7 offset:47104
  v_mfma_f32_16x16x32_bf16 v[112:115], a[128:131], v[204:207], v[112:115]
  ds_read_b128 v[180:183], v12 offset:6144
  ds_read_b128 v[232:235], v8 offset:46080
  v_mfma_f32_16x16x32_bf16 v[116:119], a[132:135], v[204:207], v[116:119]
  ds_read_b128 v[184:187], v12 offset:7168
  s_add_u32 m0, s91, 8192
  s_add_u32 s90, s92, 8192
  buffer_load_dwordx4 v2, s[4:7], s90 offen offset:0 sc1 lds
  v_mfma_f32_16x16x32_bf16 v[120:123], a[128:131], v[208:211], v[120:123]
  v_mfma_f32_16x16x32_bf16 v[124:127], a[132:135], v[208:211], v[124:127]
  ds_read_b128 v[188:191], v12 offset:8192
  s_waitcnt lgkmcnt(6)
  v_mfma_f32_16x16x32_bf16 v[104:107], a[136:139], v[212:215], v[104:107]
  v_max3_f32 v80, v64, v65, v66
  v_max3_f32 v84, v67, v68, v69
  ds_read_b128 v[200:203], v7 offset:48640
  v_mfma_f32_16x16x32_bf16 v[108:111], a[140:143], v[212:215], v[108:111]
  v_max3_f32 v82, v72, v73, v74
  ds_read_b128 v[204:207], v7 offset:49664
  v_mfma_f32_16x16x32_bf16 v[112:115], a[136:139], v[216:219], v[112:115]
  v_max3_f32 v85, v75, v76, v77
  ds_read_b128 v[208:211], v8 offset:48640
  v_mfma_f32_16x16x32_bf16 v[116:119], a[140:143], v[216:219], v[116:119]
  v_max3_f32 v80, v80, v70, v71
  buffer_load_dwordx4 v2, s[4:7], s90 offen offset:1024 sc1 lds
  v_mfma_f32_16x16x32_bf16 v[120:123], a[136:139], v[220:223], v[120:123]
  v_max3_f32 v82, v82, v78, v79
  v_mfma_f32_16x16x32_bf16 v[124:127], a[140:143], v[220:223], v[124:127]
  v_max_f32 v80, v80, v84
  v_max_f32 v82, v82, v85
  s_waitcnt lgkmcnt(5)
  v_mfma_f32_16x16x32_bf16 v[104:107], a[144:147], v[224:227], v[104:107]
  v_permlane32_swap_b32 v80, v82
  v_max_f32 v80, v80, v82
  ds_read_b128 v[212:215], v7 offset:51200
  v_mfma_f32_16x16x32_bf16 v[108:111], a[148:151], v[224:227], v[108:111]
  v_mov_b32 v82, v80
  ds_read_b128 v[216:219], v7 offset:52224
  v_mfma_f32_16x16x32_bf16 v[112:115], a[144:147], v[228:231], v[112:115]
  v_permlane16_swap_b32 v80, v82
  ds_read_b128 v[220:223], v8 offset:51200
  v_mfma_f32_16x16x32_bf16 v[116:119], a[148:151], v[228:231], v[116:119]
  v_max_f32 v80, v80, v82
  buffer_load_dwordx4 v2, s[4:7], s90 offen offset:2048 sc1 lds
  v_mfma_f32_16x16x32_bf16 v[120:123], a[144:147], v[232:235], v[120:123]
  v_mov_b32 v82, v80
  v_mfma_f32_16x16x32_bf16 v[124:127], a[148:151], v[232:235], v[124:127]
  s_waitcnt lgkmcnt(3)
  v_mfma_f32_16x16x32_bf16 v[104:107], a[152:155], v[200:203], v[104:107]
  v_permlane32_swap_b32 v80, v82
  s_waitcnt lgkmcnt(6)
  v_pk_add_f32 v[64:65], v[64:65], v[80:81] op_sel_hi:[1,0] neg_lo:[0,1] neg_hi:[0,1]
  v_pk_add_f32 v[66:67], v[66:67], v[80:81] op_sel_hi:[1,0] neg_lo:[0,1] neg_hi:[0,1]
  v_pk_add_f32 v[68:69], v[68:69], v[80:81] op_sel_hi:[1,0] neg_lo:[0,1] neg_hi:[0,1]
  v_pk_add_f32 v[70:71], v[70:71], v[80:81] op_sel_hi:[1,0] neg_lo:[0,1] neg_hi:[0,1]
  v_pk_add_f32 v[72:73], v[72:73], v[82:83] op_sel_hi:[1,0] neg_lo:[0,1] neg_hi:[0,1]
  v_pk_add_f32 v[74:75], v[74:75], v[82:83] op_sel_hi:[1,0] neg_lo:[0,1] neg_hi:[0,1]
  v_pk_add_f32 v[76:77], v[76:77], v[82:83] op_sel_hi:[1,0] neg_lo:[0,1] neg_hi:[0,1]
  v_pk_add_f32 v[78:79], v[78:79], v[82:83] op_sel_hi:[1,0] neg_lo:[0,1] neg_hi:[0,1]
  v_pk_add_f32 v[128:129], v[128:129], v[180:181]
  v_pk_add_f32 v[130:131], v[130:131], v[182:183]
  v_pk_add_f32 v[132:133], v[132:133], v[184:185]
  v_pk_add_f32 v[134:135], v[134:135], v[186:187]
  v_pk_add_f32 v[136:137], v[136:137], v[188:189]
  v_pk_add_f32 v[138:139], v[138:139], v[190:191]
  buffer_load_dwordx4 v2, s[4:7], s90 offen offset:3072 sc1 lds
  v_mfma_f32_16x16x32_bf16 v[108:111], a[156:159], v[200:203], v[108:111]
  v_mfma_f32_16x16x32_bf16 v[112:115], a[152:155], v[204:207], v[112:115]
  v_mfma_f32_16x16x32_bf16 v[116:119], a[156:159], v[204:207], v[116:119]
  v_mfma_f32_16x16x32_bf16 v[120:123], a[152:155], v[208:211], v[120:123]
  v_mfma_f32_16x16x32_bf16 v[124:127], a[156:159], v[208:211], v[124:127]
  s_waitcnt lgkmcnt(0)
  v_mfma_f32_16x16x32_bf16 v[104:107], v[36:39], v[212:215], v[104:107]
  s_add_u32 m0, s91, 12288
  s_add_u32 s90, s92, 12288
  buffer_load_dwordx4 v2, s[4:7], s90 offen offset:0 sc1 lds
  v_mfma_f32_16x16x32_bf16 v[108:111], v[40:43], v[212:215], v[108:111]
  v_mfma_f32_16x16x32_bf16 v[112:115], v[36:39], v[216:219], v[112:115]
  v_mfma_f32_16x16x32_bf16 v[116:119], v[40:43], v[216:219], v[116:119]
  ds_read_b128 v[180:183], v12 offset:9216
  ds_read_b128 v[184:187], v12 offset:10240
  v_mfma_f32_16x16x32_bf16 v[120:123], v[36:39], v[220:223], v[120:123]
  ds_read_b128 v[188:191], v12 offset:11264
  v_exp_f32 v64, v64
  v_mfma_f32_16x16x32_bf16 v[124:127], v[40:43], v[220:223], v[124:127]
  v_exp_f32 v65, v65
  v_exp_f32 v66, v66
  v_exp_f32 v67, v67
  v_exp_f32 v68, v68
  v_exp_f32 v69, v69
  v_exp_f32 v70, v70
  v_exp_f32 v71, v71
  s_waitcnt lgkmcnt(0)
  v_pk_add_f32 v[128:129], v[128:129], v[180:181]
  v_pk_add_f32 v[130:131], v[130:131], v[182:183]
  v_pk_add_f32 v[132:133], v[132:133], v[184:185]
  v_pk_add_f32 v[134:135], v[134:135], v[186:187]
  v_pk_add_f32 v[136:137], v[136:137], v[188:189]
  v_pk_add_f32 v[138:139], v[138:139], v[190:191]
  v_mul_f32_dpp v52, v34, v128 row_newbcast:8 row_mask:0xf bank_mask:0xf
  v_mul_f32_dpp v53, v34, v129 row_newbcast:9 row_mask:0xf bank_mask:0xf
  v_mul_f32_dpp v54, v34, v130 row_newbcast:10 row_mask:0xf bank_mask:0xf
  v_mul_f32_dpp v55, v34, v131 row_newbcast:11 row_mask:0xf bank_mask:0xf
  v_mul_f32_dpp v56, v34, v132 row_newbcast:8 row_mask:0xf bank_mask:0xf
  v_mul_f32_dpp v57, v34, v133 row_newbcast:9 row_mask:0xf bank_mask:0xf
  v_mul_f32_dpp v58, v34, v134 row_newbcast:10 row_mask:0xf bank_mask:0xf
  v_mul_f32_dpp v59, v34, v135 row_newbcast:11 row_mask:0xf bank_mask:0xf
  v_mul_f32_dpp v60, v34, v136 row_newbcast:8 row_mask:0xf bank_mask:0xf
  v_mul_f32_dpp v61, v34, v137 row_newbcast:9 row_mask:0xf bank_mask:0xf
  v_mul_f32_dpp v62, v34, v138 row_newbcast:10 row_mask:0xf bank_mask:0xf
  v_mul_f32_dpp v63, v34, v139 row_newbcast:11 row_mask:0xf bank_mask:0xf
  v_pk_mul_f32 v[128:129], v[128:129], v[32:33] op_sel_hi:[1,0]
  v_pk_mul_f32 v[130:131], v[130:131], v[32:33] op_sel_hi:[1,0]
  v_pk_mul_f32 v[132:133], v[132:133], v[32:33] op_sel_hi:[1,0]
  v_pk_mul_f32 v[134:135], v[134:135], v[32:33] op_sel_hi:[1,0]
  v_pk_mul_f32 v[138:139], v[138:139], v[32:33] op_sel_hi:[1,0]
  v_cvt_pk_bf16_f32 v156, v128, v129
  v_cvt_pk_bf16_f32 v157, v130, v131
  v_cvt_pk_bf16_f32 v158, v138, 0
  v_mov_b32 v159, 0
  v_cvt_pk_bf16_f32 v160, v132, v133
  v_cvt_pk_bf16_f32 v161, v134, v135
  v_cvt_pk_bf16_f32 v162, v139, 0
  v_mov_b32 v163, 0
  s_mov_b64 exec, s[56:57]
  ds_read_b128 v[156:159], v49 offset:0
  ds_read_b128 v[160:163], v49 offset:1024
  s_mov_b64 exec, -1
  v_exp_f32 v72, v72
  v_exp_f32 v73, v73
  v_exp_f32 v74, v74
  v_exp_f32 v75, v75
  v_exp_f32 v76, v76
  v_exp_f32 v77, v77
  v_exp_f32 v78, v78
  v_exp_f32 v79, v79
  v_cvt_pk_bf16_f32 v96, v64, v65
  v_cvt_pk_bf16_f32 v97, v66, v67
  v_cvt_pk_bf16_f32 v98, v68, v69
  v_cvt_pk_bf16_f32 v99, v70, v71
  v_cvt_pk_bf16_f32 v100, v72, v73
  v_cvt_pk_bf16_f32 v101, v74, v75
  v_cvt_pk_bf16_f32 v102, v76, v77
  v_cvt_pk_bf16_f32 v103, v78, v79
  s_waitcnt lgkmcnt(0)
  v_mfma_f32_16x16x32_bf16 v[64:67], v[156:159], v[140:143], 0
  v_mfma_f32_16x16x32_bf16 v[68:71], v[164:167], v[140:143], 0
  v_mfma_f32_16x16x32_bf16 v[72:75], v[160:163], v[144:147], 0
  v_mfma_f32_16x16x32_bf16 v[76:79], v[168:171], v[144:147], 0
  v_cvt_pk_bf16_f32 v192, v52, v53
  v_cvt_pk_bf16_f32 v193, v54, v55
  v_cvt_pk_bf16_f32 v194, v56, v57
  v_cvt_pk_bf16_f32 v195, v58, v59
  v_cvt_pk_bf16_f32 v196, v60, v61
  v_cvt_pk_bf16_f32 v197, v62, v63
  v_cndmask_b32 v196, v196, v51, s[50:51]
  v_cndmask_b32 v197, v197, v51, s[50:51]
  ds_write_b64 v15, v[192:193] offset:0
  ds_write_b64 v15, v[194:195] offset:512
  ds_write_b64 v15, v[196:197] offset:1024
  s_mul_i32 s58, s12, 1536
  s_add_u32 s58, s58, 100864
  v_lshl_add_u32 v49, v1, 3, s58
  v_pk_fma_f32 v[64:65], v[64:65], s[54:55], v[24:25]
  v_pk_fma_f32 v[66:67], v[66:67], s[54:55], v[26:27]
  v_pk_fma_f32 v[68:69], v[68:69], s[54:55], v[20:21]
  v_pk_fma_f32 v[70:71], v[70:71], s[54:55], v[22:23]
  v_pk_fma_f32 v[72:73], v[72:73], s[54:55], v[24:25]
  v_pk_fma_f32 v[74:75], v[74:75], s[54:55], v[26:27]
  v_pk_fma_f32 v[76:77], v[76:77], s[54:55], v[20:21]
  v_pk_fma_f32 v[78:79], v[78:79], s[54:55], v[22:23]
  v_max3_f32 v80, v64, v65, v66
  v_max3_f32 v84, v67, v68, v69
  v_max3_f32 v82, v72, v73, v74
  v_max3_f32 v85, v75, v76, v77
  v_max3_f32 v80, v80, v70, v71
  v_max3_f32 v82, v82, v78, v79
  v_max_f32 v80, v80, v84
  v_max_f32 v82, v82, v85
  s_nop 1
  v_permlane32_swap_b32 v80, v82
  v_max_f32 v80, v80, v82
  v_mov_b32 v82, v80
  s_nop 1
  v_permlane16_swap_b32 v80, v82
  v_max_f32 v80, v80, v82
  v_mov_b32 v82, v80
  s_nop 1
  v_permlane32_swap_b32 v80, v82
  v_pk_add_f32 v[64:65], v[64:65], v[80:81] op_sel_hi:[1,0] neg_lo:[0,1] neg_hi:[0,1]
  v_pk_add_f32 v[66:67], v[66:67], v[80:81] op_sel_hi:[1,0] neg_lo:[0,1] neg_hi:[0,1]
  v_pk_add_f32 v[68:69], v[68:69], v[80:81] op_sel_hi:[1,0] neg_lo:[0,1] neg_hi:[0,1]
  v_pk_add_f32 v[70:71], v[70:71], v[80:81] op_sel_hi:[1,0] neg_lo:[0,1] neg_hi:[0,1]
  v_pk_add_f32 v[72:73], v[72:73], v[82:83] op_sel_hi:[1,0] neg_lo:[0,1] neg_hi:[0,1]
  v_pk_add_f32 v[74:75], v[74:75], v[82:83] op_sel_hi:[1,0] neg_lo:[0,1] neg_hi:[0,1]
  v_pk_add_f32 v[76:77], v[76:77], v[82:83] op_sel_hi:[1,0] neg_lo:[0,1] neg_hi:[0,1]
  v_pk_add_f32 v[78:79], v[78:79], v[82:83] op_sel_hi:[1,0] neg_lo:[0,1] neg_hi:[0,1]
  v_exp_f32 v64, v64
  v_exp_f32 v65, v65
  v_exp_f32 v66, v66
  v_exp_f32 v67, v67
  v_exp_f32 v68, v68
  v_exp_f32 v69, v69
  v_exp_f32 v70, v70
  v_exp_f32 v71, v71
  v_exp_f32 v72, v72
  v_exp_f32 v73, v73
  v_exp_f32 v74, v74
  v_exp_f32 v75, v75
  v_exp_f32 v76, v76
  v_exp_f32 v77, v77
  v_exp_f32 v78, v78
  v_exp_f32 v79, v79
  v_cvt_pk_bf16_f32 v88, v64, v65
  v_cvt_pk_bf16_f32 v89, v66, v67
  v_cvt_pk_bf16_f32 v90, v68, v69
  v_cvt_pk_bf16_f32 v91, v70, v71
  v_cvt_pk_bf16_f32 v92, v72, v73
  v_cvt_pk_bf16_f32 v93, v74, v75
  v_cvt_pk_bf16_f32 v94, v76, v77
  v_cvt_pk_bf16_f32 v95, v78, v79
  v_mul_f32_dpp v108, v34, v108 row_newbcast:4 row_mask:0xf bank_mask:0xf
  v_mul_f32_dpp v109, v34, v109 row_newbcast:5 row_mask:0xf bank_mask:0xf
  v_mul_f32_dpp v110, v34, v110 row_newbcast:6 row_mask:0xf bank_mask:0xf
  v_mul_f32_dpp v111, v34, v111 row_newbcast:7 row_mask:0xf bank_mask:0xf
  v_mul_f32_dpp v116, v34, v116 row_newbcast:4 row_mask:0xf bank_mask:0xf
  v_mul_f32_dpp v117, v34, v117 row_newbcast:5 row_mask:0xf bank_mask:0xf
  v_mul_f32_dpp v118, v34, v118 row_newbcast:6 row_mask:0xf bank_mask:0xf
  v_mul_f32_dpp v119, v34, v119 row_newbcast:7 row_mask:0xf bank_mask:0xf
  v_mul_f32_dpp v124, v34, v124 row_newbcast:4 row_mask:0xf bank_mask:0xf
  v_mul_f32_dpp v125, v34, v125 row_newbcast:5 row_mask:0xf bank_mask:0xf
  v_mul_f32_dpp v126, v34, v126 row_newbcast:6 row_mask:0xf bank_mask:0xf
  v_mul_f32_dpp v127, v34, v127 row_newbcast:7 row_mask:0xf bank_mask:0xf
  v_mul_f32_dpp v104, v34, v104 row_newbcast:0 row_mask:0xf bank_mask:0xf
  v_mul_f32_dpp v105, v34, v105 row_newbcast:1 row_mask:0xf bank_mask:0xf
  v_mul_f32_dpp v106, v34, v106 row_newbcast:2 row_mask:0xf bank_mask:0xf
  v_mul_f32_dpp v107, v34, v107 row_newbcast:3 row_mask:0xf bank_mask:0xf
  v_mul_f32_dpp v112, v34, v112 row_newbcast:0 row_mask:0xf bank_mask:0xf
  v_mul_f32_dpp v113, v34, v113 row_newbcast:1 row_mask:0xf bank_mask:0xf
  v_mul_f32_dpp v114, v34, v114 row_newbcast:2 row_mask:0xf bank_mask:0xf
  v_mul_f32_dpp v115, v34, v115 row_newbcast:3 row_mask:0xf bank_mask:0xf
  v_mul_f32_dpp v120, v34, v120 row_newbcast:0 row_mask:0xf bank_mask:0xf
  v_mul_f32_dpp v121, v34, v121 row_newbcast:1 row_mask:0xf bank_mask:0xf
  v_mul_f32_dpp v122, v34, v122 row_newbcast:2 row_mask:0xf bank_mask:0xf
  v_mul_f32_dpp v123, v34, v123 row_newbcast:3 row_mask:0xf bank_mask:0xf
  v_cvt_pk_bf16_f32 v204, v108, v109
  v_cvt_pk_bf16_f32 v205, v110, v111
  v_cvt_pk_bf16_f32 v210, v116, v117
  v_cvt_pk_bf16_f32 v211, v118, v119
  v_cvt_pk_bf16_f32 v216, v124, v125
  v_cvt_pk_bf16_f32 v217, v126, v127
  v_cndmask_b32 v216, v216, v51, s[50:51]
  v_cndmask_b32 v217, v217, v51, s[50:51]
  ds_write_b64 v49, v[204:205] offset:1536
  ds_write_b64 v49, v[210:211] offset:2048
  ds_write_b64 v49, v[216:217] offset:2560
  v_cvt_pk_bf16_f32 v202, v104, v105
  v_cvt_pk_bf16_f32 v203, v106, v107
  v_cvt_pk_bf16_f32 v208, v112, v113
  v_cvt_pk_bf16_f32 v209, v114, v115
  v_cvt_pk_bf16_f32 v214, v120, v121
  v_cvt_pk_bf16_f32 v215, v122, v123
  v_cndmask_b32 v214, v214, v51, s[50:51]
  v_cndmask_b32 v215, v215, v51, s[50:51]
  s_waitcnt lgkmcnt(0)
  s_barrier
  ds_read_b64 v[200:201], v49 offset:0
  ds_read_b64 v[206:207], v49 offset:512
  ds_read_b64 v[212:213], v49 offset:1024
  v_mfma_f32_16x16x32_bf16 v[72:75], v[214:217], v[96:99], 0
  v_mfma_f32_16x16x32_bf16 v[76:79], v[214:217], v[100:103], 0
  v_mfma_f32_16x16x32_bf16 v[64:67], v[202:205], v[96:99], 0
  v_mfma_f32_16x16x32_bf16 v[68:71], v[208:211], v[100:103], 0
  s_waitcnt lgkmcnt(0)
  v_mfma_f32_16x16x32_bf16 v[124:127], v[212:215], v[88:91], 0
  v_mfma_f32_16x16x32_bf16 v[128:131], v[212:215], v[92:95], 0
  v_mfma_f32_16x16x32_bf16 v[116:119], v[200:203], v[88:91], 0
  v_mfma_f32_16x16x32_bf16 v[120:123], v[206:209], v[92:95], 0
  v_rcp_f32 v104, v72
  v_rcp_f32 v106, v76
  v_cndmask_b32 v74, v78, v74, s[48:49]
  v_cndmask_b32 v75, v79, v75, s[48:49]
  v_pk_mul_f32 v[64:65], v[64:65], v[104:105] op_sel_hi:[1,0]
  v_pk_mul_f32 v[66:67], v[66:67], v[104:105] op_sel_hi:[1,0]
  v_pk_mul_f32 v[68:69], v[68:69], v[106:107] op_sel_hi:[1,0]
  v_pk_mul_f32 v[70:71], v[70:71], v[106:107] op_sel_hi:[1,0]
  v_cndmask_b32 v104, v106, v104, s[48:49]
  v_cvt_pk_bf16_f32 v108, v64, v65
  v_cvt_pk_bf16_f32 v109, v66, v67
  v_cvt_pk_bf16_f32 v110, v68, v69
  v_cvt_pk_bf16_f32 v111, v70, v71
  v_pk_mul_f32 v[74:75], v[74:75], v[104:105] op_sel_hi:[1,0]
  buffer_store_dwordx4 v[108:111], v2, s[4:7], s45 offen sc1
  v_cvt_pk_bf16_f32 v112, v74, v75
  buffer_store_dword v112, v14, s[4:7], s47 offen sc1
  v_rcp_f32 v132, v124
  v_rcp_f32 v134, v128
  v_cndmask_b32 v126, v130, v126, s[48:49]
  v_cndmask_b32 v127, v131, v127, s[48:49]
  v_pk_mul_f32 v[116:117], v[116:117], v[132:133] op_sel_hi:[1,0]
  v_pk_mul_f32 v[118:119], v[118:119], v[132:133] op_sel_hi:[1,0]
  v_pk_mul_f32 v[120:121], v[120:121], v[134:135] op_sel_hi:[1,0]
  v_pk_mul_f32 v[122:123], v[122:123], v[134:135] op_sel_hi:[1,0]
  v_cndmask_b32 v132, v134, v132, s[48:49]
  v_cvt_pk_bf16_f32 v136, v116, v117
  v_cvt_pk_bf16_f32 v137, v118, v119
  v_cvt_pk_bf16_f32 v138, v120, v121
  v_cvt_pk_bf16_f32 v139, v122, v123
  v_pk_mul_f32 v[126:127], v[126:127], v[132:133] op_sel_hi:[1,0]
  buffer_store_dwordx4 v[136:139], v2, s[4:7], s44 offen sc1
  v_cvt_pk_bf16_f32 v140, v126, v127
  buffer_store_dword v140, v14, s[4:7], s46 offen sc1
  s_branch p_body
.p2align 6
qa_steady:
  s_mul_i32 s26, s14, 164864
  s_add_u32 s27, s26, s20
  s_add_u32 s26, s26, s19
  s_cmp_eq_u32 s12, 0
  s_cbranch_scc1 w0_10
  s_sub_u32 s91, s12, 1
  s_mul_i32 s91, s91, 13312
  s_add_u32 s92, s91, s26
  s_add_u32 m0, s91, 122880
  s_add_u32 s90, s92, 122880
  buffer_load_dwordx4 v2, s[4:7], s90 offen offset:0 sc1 lds
  buffer_load_dwordx4 v2, s[4:7], s90 offen offset:1024 sc1 lds
  buffer_load_dwordx4 v2, s[4:7], s90 offen offset:2048 sc1 lds
  buffer_load_dwordx4 v2, s[4:7], s90 offen offset:3072 sc1 lds
  s_add_u32 m0, s91, 126976
  s_add_u32 s90, s92, 126976
  buffer_load_dwordx4 v2, s[4:7], s90 offen offset:0 sc1 lds
  buffer_load_dwordx4 v2, s[4:7], s90 offen offset:1024 sc1 lds
  buffer_load_dwordx4 v2, s[4:7], s90 offen offset:2048 sc1 lds
  buffer_load_dwordx4 v2, s[4:7], s90 offen offset:3072 sc1 lds
  s_add_u32 m0, s91, 131072
  s_add_u32 s90, s92, 131072
  buffer_load_dwordx4 v2, s[4:7], s90 offen offset:0 sc1 lds
  buffer_load_dwordx4 v2, s[4:7], s90 offen offset:1024 sc1 lds
  buffer_load_dwordx4 v2, s[4:7], s90 offen offset:2048 sc1 lds
  buffer_load_dwordx4 v2, s[4:7], s90 offen offset:3072 sc1 lds
  s_add_u32 m0, s91, 135168
  s_add_u32 s90, s92, 135168
  buffer_load_dwordx4 v2, s[4:7], s90 offen offset:0 sc1 lds
  s_waitcnt vmcnt(13)
  s_branch jn_11
w0_10:
  s_lshl_b32 s29, s13, 3
  s_lshl_b32 s30, s12, 1
  s_add_u32 s28, s30, s29
  s_mul_i32 s30, s28, 21504
  s_add_u32 s30, s30, s16
  v_add_u32 v5, 21504, v2
  v_mov_b32 v6, v2
  v_add_u32 v7, 107520, v2
  v_lshrrev_b32 v12, 2, v3
  v_lshlrev_b32 v12, 1, v12
  v_and_b32 v13, 1, v3
  v_add_u32 v12, v12, v13
  v_lshl_add_u32 v12, v4, 3, v12
  v_lshlrev_b32 v12, 4, v12
  v_add_u32 v8, 109568, v12
  s_lshl_b32 s37, s28, 10
  s_add_u32 s37, s37, s17
  v_lshrrev_b32 v12, 2, v3
  v_lshlrev_b32 v48, 10, v12
  v_lshl_add_u32 v48, v4, 6, v48
  v_and_b32 v13, 3, v3
  v_lshl_add_u32 v48, v13, 4, v48
  v_lshlrev_b32 v35, 6, v12
  v_lshl_add_u32 v35, v13, 2, v35
  v_add_u32 v49, 4096, v0
  s_lshl_b32 s38, s15, 4
  s_add_u32 s38, s38, s13
  s_lshl_b32 s38, s38, 12
  s_add_u32 s38, s38, 31977472
  s_mul_i32 s31, s29, 21504
  s_add_u32 s31, s31, s16
  s_sub_u32 s31, s31, 21504
  s_lshl_b32 s32, s12, 10
  s_add_u32 s31, s31, s32
  s_cmp_eq_u32 s13, 0
  s_cselect_b32 s31, 1879048192, s31
  s_cselect_b64 s[40:41], 0, -1
  s_lshl_b32 s32, s12, 11
  s_add_u32 s32, s32, 3072
  s_sub_u32 s37, s37, s32
  v_add_u32 v12, s32, v48
  v_mov_b32 v13, 1879048192
  s_and_b32 s58, s41, 0x0f000f00
  s_mov_b32 s59, s58
  v_cndmask_b32 v13, v13, v48, s[58:59]
  v_cmp_gt_u32 vcc, 8, v3
  s_nop 1
  v_cndmask_b32 v48, v13, v12, vcc
  s_mov_b32 s40, 0
  v_cndmask_b32 v49, v49, v0, s[40:41]
  s_mul_i32 s32, s12, 5120
  s_add_u32 s32, s32, 2048
  v_add_u32 v9, s32, v2
  s_mul_i32 s32, s12, 2560
  v_add_u32 v10, s32, v7
  v_add_u32 v11, s32, v8
  s_lshr_b32 s60, s14, 1
  s_mul_i32 s60, s60, 103424
  s_mul_i32 s61, s12, 25600
  s_add_u32 s61, s61, s60
  s_add_u32 s61, s61, s21
  v_add_u32 v50, 4096, v2
  v_mov_b32 v51, 1065369472
  s_mul_i32 s44, s28, 21504
  s_add_u32 s44, s44, s18
  s_lshr_b32 s46, s14, 2
  s_add_u32 s46, s46, 16
  s_lshl_b32 s46, s46, 10
  s_and_b32 s47, s14, 3
  s_lshl_b32 s47, s47, 8
  s_add_u32 s46, s46, s47
  s_add_u32 s46, s46, s44
  s_add_u32 s47, s46, 21504
  s_lshl_b32 s45, s14, 10
  s_add_u32 s44, s44, s45
  s_add_u32 s45, s44, 21504
  v_lshlrev_b32 v14, 4, v3
  v_lshl_add_u32 v14, v4, 2, v14
  s_mov_b32 s48, -1
  s_mov_b32 s49, 0
  s_mov_b32 s50, 0x33333333
  s_mov_b32 s51, 0x33333333
  s_lshl_b32 s42, s15, 4
  s_add_u32 s42, s42, s13
  s_lshl_b32 s42, s42, 12
  s_add_u32 s99, s42, 31719424
  v_lshlrev_b32 v12, 2, v4
  v_sub_u32 v12, v3, v12
  v_mov_b32 v15, 4048155338
  s_or_b32 s52, s13, s12
  s_cmp_eq_u32 s52, 0
  s_cselect_b64 s[52:53], -1, 0
  v_add_u32 v52, 0, v12
  v_alignbit_b32 v52, v52, v52, 1
  v_cmp_ge_u32 vcc, 7, v52
  v_add_u32 v53, 16, v12
  v_alignbit_b32 v53, v53, v53, 1
  v_cmp_ge_u32 s[56:57], 7, v53
  v_cndmask_b32 v20, v15, 0, vcc
  s_nop 0
  v_cndmask_b32 v16, v15, 0, s[56:57]
  v_cndmask_b32 v24, v16, v15, s[52:53]
  v_add_u32 v52, -1, v12
  v_alignbit_b32 v52, v52, v52, 1
  v_cmp_ge_u32 vcc, 7, v52
  v_add_u32 v53, 15, v12
  v_alignbit_b32 v53, v53, v53, 1
  v_cmp_ge_u32 s[56:57], 7, v53
  v_cndmask_b32 v21, v15, 0, vcc
  s_nop 0
  v_cndmask_b32 v17, v15, 0, s[56:57]
  v_cndmask_b32 v25, v17, v15, s[52:53]
  v_add_u32 v52, -2, v12
  v_alignbit_b32 v52, v52, v52, 1
  v_cmp_ge_u32 vcc, 7, v52
  v_add_u32 v53, 14, v12
  v_alignbit_b32 v53, v53, v53, 1
  v_cmp_ge_u32 s[56:57], 7, v53
  v_cndmask_b32 v22, v15, 0, vcc
  s_nop 0
  v_cndmask_b32 v18, v15, 0, s[56:57]
  v_cndmask_b32 v26, v18, v15, s[52:53]
  v_add_u32 v52, -3, v12
  v_alignbit_b32 v52, v52, v52, 1
  v_cmp_ge_u32 vcc, 7, v52
  v_add_u32 v53, 13, v12
  v_alignbit_b32 v53, v53, v53, 1
  v_cmp_ge_u32 s[56:57], 7, v53
  v_cndmask_b32 v23, v15, 0, vcc
  s_nop 0
  v_cndmask_b32 v19, v15, 0, s[56:57]
  v_cndmask_b32 v27, v19, v15, s[52:53]
  s_mov_b32 s54, 1051011932
  s_mov_b32 s55, 1051011932
  s_cmp_eq_u32 s12, 0
  s_cselect_b64 s[56:57], 0, -1
  s_and_b32 s62, s14, 7
  s_lshl_b32 s62, s62, 8
  v_mov_b32 v12, s62
  v_mov_b32 v13, 1
  s_mov_b32 s62, 0
dr_12:
  s_waitcnt vmcnt(0)
jn_11:
  s_cmp_eq_u32 s12, 0
  s_waitcnt lgkmcnt(0)
  s_barrier
  s_cbranch_scc0 nosig_9
  s_mov_b64 exec, 1
  buffer_atomic_add v13, v12, s[4:7], s98 offen sc0 sc1
  s_waitcnt vmcnt(0)
  v_readfirstlane_b32 s63, v13
  s_mov_b64 exec, -1
  s_mov_b64 exec, -1
nosig_9:
  s_cmp_eq_u32 s12, 0
  s_cbranch_scc0 side_8
poll_6:
  buffer_load_dword v240, v49, s[4:7], s38 offen sc1
  s_add_u32 s62, s62, 1
  s_waitcnt vmcnt(0)
  v_cmp_gt_u32 vcc, 2, v240
  s_cmp_lt_u32 s62, 0x20000
  s_cselect_b64 vcc, vcc, 0
  s_nop 4
  s_cbranch_vccnz poll_6
  s_branch seen_7
side_8:
  s_lshl_b32 s29, s13, 3
  s_lshl_b32 s30, s12, 1
  s_add_u32 s28, s30, s29
  s_mul_i32 s30, s28, 21504
  s_add_u32 s30, s30, s16
  v_add_u32 v5, 21504, v2
  v_mov_b32 v6, v2
  v_add_u32 v7, 107520, v2
  v_lshrrev_b32 v12, 2, v3
  v_lshlrev_b32 v12, 1, v12
  v_and_b32 v13, 1, v3
  v_add_u32 v12, v12, v13
  v_lshl_add_u32 v12, v4, 3, v12
  v_lshlrev_b32 v12, 4, v12
  v_add_u32 v8, 109568, v12
  s_lshl_b32 s37, s28, 10
  s_add_u32 s37, s37, s17
  v_lshrrev_b32 v12, 2, v3
  v_lshlrev_b32 v48, 10, v12
  v_lshl_add_u32 v48, v4, 6, v48
  v_and_b32 v13, 3, v3
  v_lshl_add_u32 v48, v13, 4, v48
  v_lshlrev_b32 v35, 6, v12
  v_lshl_add_u32 v35, v13, 2, v35
  v_add_u32 v49, 4096, v0
  s_lshl_b32 s38, s15, 4
  s_add_u32 s38, s38, s13
  s_lshl_b32 s38, s38, 12
  s_add_u32 s38, s38, 31977472
  s_mul_i32 s31, s29, 21504
  s_add_u32 s31, s31, s16
  s_sub_u32 s31, s31, 21504
  s_lshl_b32 s32, s12, 10
  s_add_u32 s31, s31, s32
  s_cmp_eq_u32 s13, 0
  s_cselect_b32 s31, 1879048192, s31
  s_cselect_b64 s[40:41], 0, -1
  s_lshl_b32 s32, s12, 11
  s_add_u32 s32, s32, 3072
  s_sub_u32 s37, s37, s32
  v_add_u32 v12, s32, v48
  v_mov_b32 v13, 1879048192
  s_and_b32 s58, s41, 0x0f000f00
  s_mov_b32 s59, s58
  v_cndmask_b32 v13, v13, v48, s[58:59]
  v_cmp_gt_u32 vcc, 8, v3
  s_nop 1
  v_cndmask_b32 v48, v13, v12, vcc
  s_mov_b32 s40, 0
  v_cndmask_b32 v49, v49, v0, s[40:41]
  s_mul_i32 s32, s12, 5120
  s_add_u32 s32, s32, 2048
  v_add_u32 v9, s32, v2
  s_mul_i32 s32, s12, 2560
  v_add_u32 v10, s32, v7
  v_add_u32 v11, s32, v8
  s_lshr_b32 s60, s14, 1
  s_mul_i32 s60, s60, 103424
  s_mul_i32 s61, s12, 25600
  s_add_u32 s61, s61, s60
  s_add_u32 s61, s61, s21
  v_add_u32 v50, 4096, v2
  v_mov_b32 v51, 1065369472
  s_mul_i32 s44, s28, 21504
  s_add_u32 s44, s44, s18
  s_lshr_b32 s46, s14, 2
  s_add_u32 s46, s46, 16
  s_lshl_b32 s46, s46, 10
  s_and_b32 s47, s14, 3
  s_lshl_b32 s47, s47, 8
  s_add_u32 s46, s46, s47
  s_add_u32 s46, s46, s44
  s_add_u32 s47, s46, 21504
  s_lshl_b32 s45, s14, 10
  s_add_u32 s44, s44, s45
  s_add_u32 s45, s44, 21504
  v_lshlrev_b32 v14, 4, v3
  v_lshl_add_u32 v14, v4, 2, v14
  s_mov_b32 s48, -1
  s_mov_b32 s49, 0
  s_mov_b32 s50, 0x33333333
  s_mov_b32 s51, 0x33333333
  s_lshl_b32 s42, s15, 4
  s_add_u32 s42, s42, s13
  s_lshl_b32 s42, s42, 12
  s_add_u32 s99, s42, 31719424
  v_lshlrev_b32 v12, 2, v4
  v_sub_u32 v12, v3, v12
  v_mov_b32 v15, 4048155338
  s_or_b32 s52, s13, s12
  s_cmp_eq_u32 s52, 0
  s_cselect_b64 s[52:53], -1, 0
  v_add_u32 v52, 0, v12
  v_alignbit_b32 v52, v52, v52, 1
  v_cmp_ge_u32 vcc, 7, v52
  v_add_u32 v53, 16, v12
  v_alignbit_b32 v53, v53, v53, 1
  v_cmp_ge_u32 s[56:57], 7, v53
  v_cndmask_b32 v20, v15, 0, vcc
  s_nop 0
  v_cndmask_b32 v16, v15, 0, s[56:57]
  v_cndmask_b32 v24, v16, v15, s[52:53]
  v_add_u32 v52, -1, v12
  v_alignbit_b32 v52, v52, v52, 1
  v_cmp_ge_u32 vcc, 7, v52
  v_add_u32 v53, 15, v12
  v_alignbit_b32 v53, v53, v53, 1
  v_cmp_ge_u32 s[56:57], 7, v53
  v_cndmask_b32 v21, v15, 0, vcc
  s_nop 0
  v_cndmask_b32 v17, v15, 0, s[56:57]
  v_cndmask_b32 v25, v17, v15, s[52:53]
  v_add_u32 v52, -2, v12
  v_alignbit_b32 v52, v52, v52, 1
  v_cmp_ge_u32 vcc, 7, v52
  v_add_u32 v53, 14, v12
  v_alignbit_b32 v53, v53, v53, 1
  v_cmp_ge_u32 s[56:57], 7, v53
  v_cndmask_b32 v22, v15, 0, vcc
  s_nop 0
  v_cndmask_b32 v18, v15, 0, s[56:57]
  v_cndmask_b32 v26, v18, v15, s[52:53]
  v_add_u32 v52, -3, v12
  v_alignbit_b32 v52, v52, v52, 1
  v_cmp_ge_u32 vcc, 7, v52
  v_add_u32 v53, 13, v12
  v_alignbit_b32 v53, v53, v53, 1
  v_cmp_ge_u32 s[56:57], 7, v53
  v_cndmask_b32 v23, v15, 0, vcc
  s_nop 0
  v_cndmask_b32 v19, v15, 0, s[56:57]
  v_cndmask_b32 v27, v19, v15, s[52:53]
  s_mov_b32 s54, 1051011932
  s_mov_b32 s55, 1051011932
  s_cmp_eq_u32 s12, 0
  s_cselect_b64 s[56:57], 0, -1
seen_7:
  s_barrier
  ds_read_b128 v[140:143], v6 offset:0
  ds_read_b128 v[144:147], v6 offset:1024
  ds_read_b128 v[148:151], v6 offset:2048
  ds_read_b128 v[152:155], v6 offset:3072
  ds_read_b128 v[156:159], v6 offset:4096
  ds_read_b128 v[160:163], v6 offset:5120
  ds_read_b128 v[164:167], v6 offset:6144
  ds_read_b128 v[168:171], v6 offset:7168
  ds_read_b128 v[172:175], v6 offset:8192
  ds_read_b128 v[176:179], v6 offset:9216
  s_add_u32 s34, s30, 0
  buffer_load_dwordx4 a[0:3], v2, s[4:7], s34 offen offset:0 sc1
  s_nop 11
  buffer_load_dwordx4 a[4:7], v5, s[4:7], s34 offen offset:0 sc1
  s_nop 11
  buffer_load_dwordx4 a[8:11], v2, s[4:7], s34 offen offset:1024 sc1
  s_nop 11
  buffer_load_dwordx4 a[12:15], v5, s[4:7], s34 offen offset:1024 sc1
  s_nop 11
  s_add_u32 s35, s31, 0
  buffer_load_dwordx4 a[160:163], v2, s[4:7], s35 offen sc1
  s_nop 11
  buffer_load_dwordx4 a[16:19], v2, s[4:7], s34 offen offset:2048 sc1
  s_nop 11
  buffer_load_dwordx4 a[20:23], v5, s[4:7], s34 offen offset:2048 sc1
  s_nop 11
  buffer_load_dwordx4 a[24:27], v2, s[4:7], s34 offen offset:3072 sc1
  s_nop 11
  buffer_load_dwordx4 a[28:31], v5, s[4:7], s34 offen offset:3072 sc1
  s_nop 11
  s_add_u32 s34, s30, 4096
  buffer_load_dwordx4 a[32:35], v2, s[4:7], s34 offen offset:0 sc1
  s_nop 11
  buffer_load_dwordx4 a[36:39], v5, s[4:7], s34 offen offset:0 sc1
  s_nop 11
  buffer_load_dwordx4 a[40:43], v2, s[4:7], s34 offen offset:1024 sc1
  s_nop 11
  buffer_load_dwordx4 a[44:47], v5, s[4:7], s34 offen offset:1024 sc1
  s_nop 11
  s_add_u32 s35, s31, 4096
  buffer_load_dwordx4 a[164:167], v2, s[4:7], s35 offen sc1
  s_nop 11
  s_waitcnt vmcnt(12) lgkmcnt(5)
  v_mfma_f32_16x16x32_bf16 v[64:67], v[140:143], a[0:3], 0
  ds_read_b128 v[180:183], v6 offset:10240
  v_mfma_f32_16x16x32_bf16 v[68:71], v[140:143], a[4:7], 0
  ds_read_b128 v[184:187], v6 offset:11264
  v_mfma_f32_16x16x32_bf16 v[72:75], v[144:147], a[0:3], 0
  ds_read_b128 v[188:191], v6 offset:12288
  v_mfma_f32_16x16x32_bf16 v[76:79], v[144:147], a[4:7], 0
  ds_read_b128 v[192:195], v6 offset:13312
  v_mfma_f32_16x16x32_bf16 v[80:83], v[148:151], a[0:3], 0
  ds_read_b128 v[196:199], v6 offset:14336
  v_mfma_f32_16x16x32_bf16 v[84:87], v[148:151], a[4:7], 0
  buffer_load_dwordx4 a[48:51], v2, s[4:7], s34 offen offset:2048 sc1
  v_mfma_f32_16x16x32_bf16 v[88:91], v[152:155], a[0:3], 0
  buffer_load_dwordx4 a[52:55], v5, s[4:7], s34 offen offset:2048 sc1
  v_mfma_f32_16x16x32_bf16 v[92:95], v[152:155], a[4:7], 0
  buffer_load_dwordx4 v[224:227], v48, s[4:7], s37 offen offset:0 sc1
  v_mfma_f32_16x16x32_bf16 v[96:99], v[156:159], a[0:3], 0
  v_mfma_f32_16x16x32_bf16 v[100:103], v[156:159], a[4:7], 0
  s_waitcnt vmcnt(12) lgkmcnt(5)
  v_mfma_f32_16x16x32_bf16 v[64:67], v[160:163], a[8:11], v[64:67]
  ds_read_b128 v[140:143], v6 offset:15360
  v_mfma_f32_16x16x32_bf16 v[68:71], v[160:163], a[12:15], v[68:71]
  ds_read_b128 v[144:147], v6 offset:16384
  v_mfma_f32_16x16x32_bf16 v[72:75], v[164:167], a[8:11], v[72:75]
  ds_read_b128 v[148:151], v6 offset:17408
  v_mfma_f32_16x16x32_bf16 v[76:79], v[164:167], a[12:15], v[76:79]
  ds_read_b128 v[152:155], v6 offset:18432
  v_mfma_f32_16x16x32_bf16 v[80:83], v[168:171], a[8:11], v[80:83]
  ds_read_b128 v[156:159], v6 offset:19456
  v_mfma_f32_16x16x32_bf16 v[84:87], v[168:171], a[12:15], v[84:87]
  buffer_load_dwordx4 a[56:59], v2, s[4:7], s34 offen offset:3072 sc1
  v_mfma_f32_16x16x32_bf16 v[88:91], v[172:175], a[8:11], v[88:91]
  buffer_load_dwordx4 a[60:63], v5, s[4:7], s34 offen offset:3072 sc1
  v_mfma_f32_16x16x32_bf16 v[92:95], v[172:175], a[12:15], v[92:95]
  buffer_load_dwordx4 v[228:231], v48, s[4:7], s37 offen offset:256 sc1
  v_mfma_f32_16x16x32_bf16 v[96:99], v[176:179], a[8:11], v[96:99]
  v_mfma_f32_16x16x32_bf16 v[100:103], v[176:179], a[12:15], v[100:103]
  s_waitcnt vmcnt(13) lgkmcnt(5)
  v_mfma_f32_16x16x32_bf16 v[64:67], v[180:183], a[16:19], v[64:67]
  ds_read_b128 v[160:163], v6 offset:20480
  ds_read_b128 v[164:167], v6 offset:21504
  v_mfma_f32_16x16x32_bf16 v[68:71], v[180:183], a[20:23], v[68:71]
  ds_read_b128 v[168:171], v6 offset:22528
  v_mfma_f32_16x16x32_bf16 v[72:75], v[184:187], a[16:19], v[72:75]
  ds_read_b128 v[172:175], v6 offset:23552
  v_mfma_f32_16x16x32_bf16 v[76:79], v[184:187], a[20:23], v[76:79]
  ds_read_b128 v[176:179], v6 offset:24576
  v_mfma_f32_16x16x32_bf16 v[80:83], v[188:191], a[16:19], v[80:83]
  ds_read_b128 v[200:203], v9 offset:0
  v_mfma_f32_16x16x32_bf16 v[84:87], v[188:191], a[20:23], v[84:87]
  ds_read_b128 v[204:207], v9 offset:1024
  v_mfma_f32_16x16x32_bf16 v[88:91], v[192:195], a[16:19], v[88:91]
  ds_read_b128 v[208:211], v9 offset:2048
  v_mfma_f32_16x16x32_bf16 v[92:95], v[192:195], a[20:23], v[92:95]
  s_add_u32 s34, s30, 8192
  buffer_load_dwordx4 a[64:67], v2, s[4:7], s34 offen offset:0 sc1
  v_mfma_f32_16x16x32_bf16 v[96:99], v[196:199], a[16:19], v[96:99]
  buffer_load_dwordx4 a[68:71], v5, s[4:7], s34 offen offset:0 sc1
  v_mfma_f32_16x16x32_bf16 v[100:103], v[196:199], a[20:23], v[100:103]
  buffer_load_dwordx4 v[232:235], v48, s[4:7], s37 offen offset:512 sc1
  s_waitcnt vmcnt(14) lgkmcnt(8)
  s_waitcnt lgkmcnt(0)
  v_mfma_f32_16x16x32_bf16 v[128:131], v[200:203], a[160:163], 0
  v_mfma_f32_16x16x32_bf16 v[132:135], v[204:207], a[160:163], 0
  v_mfma_f32_16x16x32_bf16 v[136:139], v[208:211], a[160:163], 0
  v_mfma_f32_16x16x32_bf16 v[64:67], v[140:143], a[24:27], v[64:67]
  ds_read_b128 v[180:183], v6 offset:25600
  v_mfma_f32_16x16x32_bf16 v[68:71], v[140:143], a[28:31], v[68:71]
  ds_read_b128 v[184:187], v6 offset:26624
  v_mfma_f32_16x16x32_bf16 v[72:75], v[144:147], a[24:27], v[72:75]
  ds_read_b128 v[188:191], v6 offset:27648
  v_mfma_f32_16x16x32_bf16 v[76:79], v[144:147], a[28:31], v[76:79]
  ds_read_b128 v[192:195], v6 offset:28672
  v_mfma_f32_16x16x32_bf16 v[80:83], v[148:151], a[24:27], v[80:83]
  ds_read_b128 v[196:199], v6 offset:29696
  v_mfma_f32_16x16x32_bf16 v[84:87], v[148:151], a[28:31], v[84:87]
  buffer_load_dwordx4 a[72:75], v2, s[4:7], s34 offen offset:1024 sc1
  v_mfma_f32_16x16x32_bf16 v[88:91], v[152:155], a[24:27], v[88:91]
  buffer_load_dwordx4 a[76:79], v5, s[4:7], s34 offen offset:1024 sc1
  v_mfma_f32_16x16x32_bf16 v[92:95], v[152:155], a[28:31], v[92:95]
  s_add_u32 s35, s31, 8192
  buffer_load_dwordx4 a[168:171], v2, s[4:7], s35 offen sc1
  v_mfma_f32_16x16x32_bf16 v[96:99], v[156:159], a[24:27], v[96:99]
  buffer_load_dwordx4 v[236:239], v48, s[4:7], s37 offen offset:768 sc1
  v_mfma_f32_16x16x32_bf16 v[100:103], v[156:159], a[28:31], v[100:103]
  s_waitcnt vmcnt(16)
  v_mfma_f32_16x16x32_bf16 v[64:67], v[160:163], a[32:35], v[64:67]
  ds_read_b128 v[140:143], v6 offset:30720
  v_mfma_f32_16x16x32_bf16 v[68:71], v[160:163], a[36:39], v[68:71]
  ds_read_b128 v[144:147], v6 offset:31744
  v_mfma_f32_16x16x32_bf16 v[72:75], v[164:167], a[32:35], v[72:75]
  ds_read_b128 v[148:151], v6 offset:32768
  v_mfma_f32_16x16x32_bf16 v[76:79], v[164:167], a[36:39], v[76:79]
  ds_read_b128 v[152:155], v6 offset:33792
  v_mfma_f32_16x16x32_bf16 v[80:83], v[168:171], a[32:35], v[80:83]
  ds_read_b128 v[156:159], v6 offset:34816
  v_mfma_f32_16x16x32_bf16 v[84:87], v[168:171], a[36:39], v[84:87]
  buffer_load_dwordx4 a[80:83], v2, s[4:7], s34 offen offset:2048 sc1
  v_mfma_f32_16x16x32_bf16 v[88:91], v[172:175], a[32:35], v[88:91]
  buffer_load_dwordx4 a[84:87], v5, s[4:7], s34 offen offset:2048 sc1
  v_mfma_f32_16x16x32_bf16 v[92:95], v[172:175], a[36:39], v[92:95]
  v_mfma_f32_16x16x32_bf16 v[96:99], v[176:179], a[32:35], v[96:99]
  v_mfma_f32_16x16x32_bf16 v[100:103], v[176:179], a[36:39], v[100:103]
  s_waitcnt vmcnt(15) lgkmcnt(5)
  v_mfma_f32_16x16x32_bf16 v[64:67], v[180:183], a[40:43], v[64:67]
  ds_read_b128 v[160:163], v6 offset:35840
  v_mfma_f32_16x16x32_bf16 v[68:71], v[180:183], a[44:47], v[68:71]
  ds_read_b128 v[164:167], v6 offset:36864
  v_mfma_f32_16x16x32_bf16 v[72:75], v[184:187], a[40:43], v[72:75]
  ds_read_b128 v[168:171], v6 offset:37888
  v_mfma_f32_16x16x32_bf16 v[76:79], v[184:187], a[44:47], v[76:79]
  ds_read_b128 v[172:175], v6 offset:38912
  v_mfma_f32_16x16x32_bf16 v[80:83], v[188:191], a[40:43], v[80:83]
  ds_read_b128 v[176:179], v6 offset:39936
  v_mfma_f32_16x16x32_bf16 v[84:87], v[188:191], a[44:47], v[84:87]
  buffer_load_dwordx4 a[88:91], v2, s[4:7], s34 offen offset:3072 sc1
  v_mfma_f32_16x16x32_bf16 v[88:91], v[192:195], a[40:43], v[88:91]
  buffer_load_dwordx4 a[92:95], v5, s[4:7], s34 offen offset:3072 sc1
  v_mfma_f32_16x16x32_bf16 v[92:95], v[192:195], a[44:47], v[92:95]
  v_mfma_f32_16x16x32_bf16 v[96:99], v[196:199], a[40:43], v[96:99]
  v_mfma_f32_16x16x32_bf16 v[100:103], v[196:199], a[44:47], v[100:103]
  s_waitcnt vmcnt(15) lgkmcnt(5)
  v_mfma_f32_16x16x32_bf16 v[64:67], v[140:143], a[48:51], v[64:67]
  ds_read_b128 v[180:183], v6 offset:40960
  v_mfma_f32_16x16x32_bf16 v[68:71], v[140:143], a[52:55], v[68:71]
  ds_read_b128 v[184:187], v6 offset:41984
  v_mfma_f32_16x16x32_bf16 v[72:75], v[144:147], a[48:51], v[72:75]
  ds_read_b128 v[188:191], v6 offset:43008
  v_mfma_f32_16x16x32_bf16 v[76:79], v[144:147], a[52:55], v[76:79]
  ds_read_b128 v[192:195], v6 offset:44032
  v_mfma_f32_16x16x32_bf16 v[80:83], v[148:151], a[48:51], v[80:83]
  ds_read_b128 v[196:199], v6 offset:45056
  v_mfma_f32_16x16x32_bf16 v[84:87], v[148:151], a[52:55], v[84:87]
  ds_read_b128 v[200:203], v9 offset:20480
  v_mfma_f32_16x16x32_bf16 v[88:91], v[152:155], a[48:51], v[88:91]
  ds_read_b128 v[204:207], v9 offset:21504
  v_mfma_f32_16x16x32_bf16 v[92:95], v[152:155], a[52:55], v[92:95]
  ds_read_b128 v[208:211], v9 offset:22528
  v_mfma_f32_16x16x32_bf16 v[96:99], v[156:159], a[48:51], v[96:99]
  s_add_u32 s34, s30, 12288
  buffer_load_dwordx4 a[96:99], v2, s[4:7], s34 offen offset:0 sc1
  v_mfma_f32_16x16x32_bf16 v[100:103], v[156:159], a[52:55], v[100:103]
  buffer_load_dwordx4 a[100:103], v5, s[4:7], s34 offen offset:0 sc1
  s_waitcnt vmcnt(14) lgkmcnt(8)
  s_waitcnt lgkmcnt(0)
  v_mfma_f32_16x16x32_bf16 v[128:131], v[200:203], a[164:167], v[128:131]
  v_mfma_f32_16x16x32_bf16 v[132:135], v[204:207], a[164:167], v[132:135]
  v_mfma_f32_16x16x32_bf16 v[136:139], v[208:211], a[164:167], v[136:139]
  v_mfma_f32_16x16x32_bf16 v[64:67], v[160:163], a[56:59], v[64:67]
  ds_read_b128 v[140:143], v6 offset:46080
  v_mfma_f32_16x16x32_bf16 v[68:71], v[160:163], a[60:63], v[68:71]
  ds_read_b128 v[144:147], v6 offset:47104
  v_mfma_f32_16x16x32_bf16 v[72:75], v[164:167], a[56:59], v[72:75]
  ds_read_b128 v[148:151], v6 offset:48128
  v_mfma_f32_16x16x32_bf16 v[76:79], v[164:167], a[60:63], v[76:79]
  ds_read_b128 v[152:155], v6 offset:49152
  v_mfma_f32_16x16x32_bf16 v[80:83], v[168:171], a[56:59], v[80:83]
  ds_read_b128 v[156:159], v6 offset:50176
  v_mfma_f32_16x16x32_bf16 v[84:87], v[168:171], a[60:63], v[84:87]
  buffer_load_dwordx4 a[104:107], v2, s[4:7], s34 offen offset:1024 sc1
  v_mfma_f32_16x16x32_bf16 v[88:91], v[172:175], a[56:59], v[88:91]
  buffer_load_dwordx4 a[108:111], v5, s[4:7], s34 offen offset:1024 sc1
  v_mfma_f32_16x16x32_bf16 v[92:95], v[172:175], a[60:63], v[92:95]
  s_add_u32 s35, s31, 12288
  buffer_load_dwordx4 a[172:175], v2, s[4:7], s35 offen sc1
  v_mfma_f32_16x16x32_bf16 v[96:99], v[176:179], a[56:59], v[96:99]
  v_mfma_f32_16x16x32_bf16 v[100:103], v[176:179], a[60:63], v[100:103]
  s_waitcnt vmcnt(14)
  v_mfma_f32_16x16x32_bf16 v[64:67], v[180:183], a[64:67], v[64:67]
  ds_read_b128 v[160:163], v6 offset:51200
  v_mfma_f32_16x16x32_bf16 v[68:71], v[180:183], a[68:71], v[68:71]
  ds_read_b128 v[164:167], v6 offset:52224
  v_mfma_f32_16x16x32_bf16 v[72:75], v[184:187], a[64:67], v[72:75]
  ds_read_b128 v[168:171], v6 offset:53248
  v_mfma_f32_16x16x32_bf16 v[76:79], v[184:187], a[68:71], v[76:79]
  ds_read_b128 v[172:175], v6 offset:54272
  v_mfma_f32_16x16x32_bf16 v[80:83], v[188:191], a[64:67], v[80:83]
  ds_read_b128 v[176:179], v6 offset:55296
  v_mfma_f32_16x16x32_bf16 v[84:87], v[188:191], a[68:71], v[84:87]
  buffer_load_dwordx4 a[112:115], v2, s[4:7], s34 offen offset:2048 sc1
  v_mfma_f32_16x16x32_bf16 v[88:91], v[192:195], a[64:67], v[88:91]
  buffer_load_dwordx4 a[116:119], v5, s[4:7], s34 offen offset:2048 sc1
  v_mfma_f32_16x16x32_bf16 v[92:95], v[192:195], a[68:71], v[92:95]
  v_mfma_f32_16x16x32_bf16 v[96:99], v[196:199], a[64:67], v[96:99]
  v_mfma_f32_16x16x32_bf16 v[100:103], v[196:199], a[68:71], v[100:103]
  s_waitcnt vmcnt(12) lgkmcnt(5)
  v_mfma_f32_16x16x32_bf16 v[64:67], v[140:143], a[72:75], v[64:67]
  ds_read_b128 v[180:183], v6 offset:56320
  v_mfma_f32_16x16x32_bf16 v[68:71], v[140:143], a[76:79], v[68:71]
  ds_read_b128 v[184:187], v6 offset:57344
  v_mfma_f32_16x16x32_bf16 v[72:75], v[144:147], a[72:75], v[72:75]
  ds_read_b128 v[188:191], v6 offset:58368
  v_mfma_f32_16x16x32_bf16 v[76:79], v[144:147], a[76:79], v[76:79]
  ds_read_b128 v[192:195], v6 offset:59392
  v_mfma_f32_16x16x32_bf16 v[80:83], v[148:151], a[72:75], v[80:83]
  ds_read_b128 v[196:199], v6 offset:60416
  v_mfma_f32_16x16x32_bf16 v[84:87], v[148:151], a[76:79], v[84:87]
  buffer_load_dwordx4 a[120:123], v2, s[4:7], s34 offen offset:3072 sc1
  v_mfma_f32_16x16x32_bf16 v[88:91], v[152:155], a[72:75], v[88:91]
  buffer_load_dwordx4 a[124:127], v5, s[4:7], s34 offen offset:3072 sc1
  v_mfma_f32_16x16x32_bf16 v[92:95], v[152:155], a[76:79], v[92:95]
  v_mfma_f32_16x16x32_bf16 v[96:99], v[156:159], a[72:75], v[96:99]
  v_mfma_f32_16x16x32_bf16 v[100:103], v[156:159], a[76:79], v[100:103]
  s_waitcnt vmcnt(13)
  v_add_f32 v12, v224, v226
  v_add_f32 v13, v225, v227
  v_add_f32 v15, v228, v230
  s_waitcnt vmcnt(11) lgkmcnt(5)
  s_barrier
  v_mfma_f32_16x16x32_bf16 v[64:67], v[160:163], a[80:83], v[64:67]
  v_add_f32 v34, v229, v231
  v_add_u32 v6, 61440, v6
  ds_read_b128 v[140:143], v6 offset:0
  v_mfma_f32_16x16x32_bf16 v[68:71], v[160:163], a[84:87], v[68:71]
  ds_read_b128 v[144:147], v6 offset:1024
  v_mfma_f32_16x16x32_bf16 v[72:75], v[164:167], a[80:83], v[72:75]
  v_add_f32 v12, v12, v232
  ds_read_b128 v[148:151], v6 offset:2048
  v_mfma_f32_16x16x32_bf16 v[76:79], v[164:167], a[84:87], v[76:79]
  v_add_f32 v13, v13, v233
  ds_read_b128 v[152:155], v6 offset:3072
  v_mfma_f32_16x16x32_bf16 v[80:83], v[168:171], a[80:83], v[80:83]
  v_add_f32 v15, v15, v234
  ds_read_b128 v[156:159], v6 offset:4096
  v_mfma_f32_16x16x32_bf16 v[84:87], v[168:171], a[84:87], v[84:87]
  v_add_f32 v34, v34, v235
  ds_read_b128 v[200:203], v9 offset:40960
  v_mfma_f32_16x16x32_bf16 v[88:91], v[172:175], a[80:83], v[88:91]
  v_add_f32 v12, v12, v236
  ds_read_b128 v[204:207], v9 offset:41984
  v_mfma_f32_16x16x32_bf16 v[92:95], v[172:175], a[84:87], v[92:95]
  v_add_f32 v13, v13, v237
  ds_read_b128 v[208:211], v9 offset:43008
  v_mfma_f32_16x16x32_bf16 v[96:99], v[176:179], a[80:83], v[96:99]
  v_add_f32 v15, v15, v238
  s_add_u32 s34, s30, 16384
  buffer_load_dwordx4 a[128:131], v2, s[4:7], s34 offen offset:0 sc1
  v_mfma_f32_16x16x32_bf16 v[100:103], v[176:179], a[84:87], v[100:103]
  buffer_load_dwordx4 a[132:135], v5, s[4:7], s34 offen offset:0 sc1
  s_waitcnt vmcnt(11) lgkmcnt(8)
  s_waitcnt lgkmcnt(0)
  v_mfma_f32_16x16x32_bf16 v[128:131], v[200:203], a[168:171], v[128:131]
  v_add_f32 v34, v34, v239
  v_mfma_f32_16x16x32_bf16 v[132:135], v[204:207], a[168:171], v[132:135]
  v_add_f32 v12, v12, v15
  v_add_f32 v13, v13, v34
  v_mfma_f32_16x16x32_bf16 v[136:139], v[208:211], a[168:171], v[136:139]
  v_mul_f32 v12, 986500301, v12
  v_mul_f32 v13, 986500301, v13
  v_mfma_f32_16x16x32_bf16 v[64:67], v[180:183], a[88:91], v[64:67]
  v_fma_f32 v13, -v12, v12, v13
  v_cvt_pk_bf16_f32 v12, -v12, -v12
  ds_read_b128 v[160:163], v6 offset:5120
  ds_read_b128 v[164:167], v6 offset:6144
  v_mfma_f32_16x16x32_bf16 v[68:71], v[180:183], a[92:95], v[68:71]
  ds_read_b128 v[168:171], v6 offset:7168
  v_mfma_f32_16x16x32_bf16 v[72:75], v[184:187], a[88:91], v[72:75]
  v_max_f32 v13, 0, v13
  ds_read_b128 v[172:175], v6 offset:8192
  v_mfma_f32_16x16x32_bf16 v[76:79], v[184:187], a[92:95], v[76:79]
  ds_bpermute_b32 v36, v35, v12 offset:0
  ds_read_b128 v[176:179], v6 offset:9216
  v_mfma_f32_16x16x32_bf16 v[80:83], v[188:191], a[88:91], v[80:83]
  ds_bpermute_b32 v40, v35, v12 offset:16
  ds_read_b128 v[212:215], v10 offset:0
  v_mfma_f32_16x16x32_bf16 v[84:87], v[188:191], a[92:95], v[84:87]
  ds_bpermute_b32 v44, v35, v12 offset:32
  ds_read_b128 v[216:219], v10 offset:1024
  v_mfma_f32_16x16x32_bf16 v[88:91], v[192:195], a[88:91], v[88:91]
  v_cvt_pk_bf16_f32 v13, 0, v13
  ds_read_b128 v[220:223], v11 offset:0
  v_mfma_f32_16x16x32_bf16 v[92:95], v[192:195], a[92:95], v[92:95]
  v_add_f32 v13, 925353388, v13
  buffer_load_dwordx4 a[136:139], v2, s[4:7], s34 offen offset:1024 sc1
  v_mfma_f32_16x16x32_bf16 v[96:99], v[196:199], a[88:91], v[96:99]
  v_cvt_pk_bf16_f32 v13, 0, v13
  buffer_load_dwordx4 a[140:143], v5, s[4:7], s34 offen offset:1024 sc1
  v_mfma_f32_16x16x32_bf16 v[100:103], v[196:199], a[92:95], v[100:103]
  v_sqrt_f32 v13, v13
  s_add_u32 s35, s31, 16384
  buffer_load_dwordx4 a[176:179], v2, s[4:7], s35 offen sc1
  s_waitcnt vmcnt(12)
  s_waitcnt lgkmcnt(0)
  v_mfma_f32_16x16x32_bf16 v[52:55], a[160:163], v[212:215], 0
  v_mfma_f32_16x16x32_bf16 v[56:59], a[160:163], v[216:219], 0
  v_cvt_pk_bf16_f32 v13, 0, v13
  v_mfma_f32_16x16x32_bf16 v[60:63], a[160:163], v[220:223], 0
  v_rcp_f32 v34, v13
  v_mfma_f32_16x16x32_bf16 v[64:67], v[140:143], a[96:99], v[64:67]
  ds_bpermute_b32 v28, v35, v34 offset:0
  ds_bpermute_b32 v30, v35, v34 offset:16
  ds_read_b128 v[180:183], v6 offset:10240
  v_mfma_f32_16x16x32_bf16 v[68:71], v[140:143], a[100:103], v[68:71]
  ds_bpermute_b32 v32, v35, v34 offset:32
  ds_read_b128 v[184:187], v6 offset:11264
  v_mfma_f32_16x16x32_bf16 v[72:75], v[144:147], a[96:99], v[72:75]
  ds_read_b128 v[188:191], v6 offset:12288
  v_mfma_f32_16x16x32_bf16 v[76:79], v[144:147], a[100:103], v[76:79]
  ds_read_b128 v[192:195], v6 offset:13312
  v_mfma_f32_16x16x32_bf16 v[80:83], v[148:151], a[96:99], v[80:83]
  ds_read_b128 v[196:199], v6 offset:14336
  v_mfma_f32_16x16x32_bf16 v[84:87], v[148:151], a[100:103], v[84:87]
  buffer_load_dwordx4 a[144:147], v2, s[4:7], s34 offen offset:2048 sc1
  v_mfma_f32_16x16x32_bf16 v[88:91], v[152:155], a[96:99], v[88:91]
  buffer_load_dwordx4 a[148:151], v5, s[4:7], s34 offen offset:2048 sc1
  v_mfma_f32_16x16x32_bf16 v[92:95], v[152:155], a[100:103], v[92:95]
  s_waitcnt lgkmcnt(4)
  s_cmp_eq_u32 s12, 0
  s_cselect_b64 s[40:41], -1, 0
  v_cndmask_b32 v44, 0, v44, s[40:41]
  v_mfma_f32_16x16x32_bf16 v[96:99], v[156:159], a[96:99], v[96:99]
  v_mov_b32 v37, v36
  v_mov_b32 v41, v40
  v_mfma_f32_16x16x32_bf16 v[100:103], v[156:159], a[100:103], v[100:103]
  v_mov_b32 v45, v44
  v_mov_b64 v[38:39], v[36:37]
  s_waitcnt vmcnt(11)
  v_mfma_f32_16x16x32_bf16 v[64:67], v[160:163], a[104:107], v[64:67]
  v_mov_b64 v[42:43], v[40:41]
  v_mov_b64 v[46:47], v[44:45]
  ds_read_b128 v[140:143], v6 offset:15360
  v_mfma_f32_16x16x32_bf16 v[68:71], v[160:163], a[108:111], v[68:71]
  ds_read_b128 v[144:147], v6 offset:16384
  v_mfma_f32_16x16x32_bf16 v[72:75], v[164:167], a[104:107], v[72:75]
  ds_read_b128 v[148:151], v6 offset:17408
  v_mfma_f32_16x16x32_bf16 v[76:79], v[164:167], a[108:111], v[76:79]
  ds_read_b128 v[152:155], v6 offset:18432
  v_mfma_f32_16x16x32_bf16 v[80:83], v[168:171], a[104:107], v[80:83]
  ds_read_b128 v[156:159], v6 offset:19456
  v_mfma_f32_16x16x32_bf16 v[84:87], v[168:171], a[108:111], v[84:87]
  ds_read_b128 v[212:215], v10 offset:10240
  v_mfma_f32_16x16x32_bf16 v[88:91], v[172:175], a[104:107], v[88:91]
  ds_read_b128 v[216:219], v10 offset:11264
  v_mfma_f32_16x16x32_bf16 v[92:95], v[172:175], a[108:111], v[92:95]
  ds_read_b128 v[220:223], v11 offset:10240
  v_mfma_f32_16x16x32_bf16 v[96:99], v[176:179], a[104:107], v[96:99]
  buffer_load_dwordx4 a[152:155], v2, s[4:7], s34 offen offset:3072 sc1
  v_mfma_f32_16x16x32_bf16 v[100:103], v[176:179], a[108:111], v[100:103]
  buffer_load_dwordx4 a[156:159], v5, s[4:7], s34 offen offset:3072 sc1
  s_waitcnt vmcnt(11) lgkmcnt(8)
  s_waitcnt lgkmcnt(0)
  v_mfma_f32_16x16x32_bf16 v[52:55], a[164:167], v[212:215], v[52:55]
  v_mfma_f32_16x16x32_bf16 v[56:59], a[164:167], v[216:219], v[56:59]
  v_mfma_f32_16x16x32_bf16 v[60:63], a[164:167], v[220:223], v[60:63]
  v_mfma_f32_16x16x32_bf16 v[64:67], v[180:183], a[112:115], v[64:67]
  ds_read_b128 v[160:163], v6 offset:20480
  v_mfma_f32_16x16x32_bf16 v[68:71], v[180:183], a[116:119], v[68:71]
  ds_read_b128 v[164:167], v6 offset:21504
  v_mfma_f32_16x16x32_bf16 v[72:75], v[184:187], a[112:115], v[72:75]
  ds_read_b128 v[168:171], v6 offset:22528
  v_mfma_f32_16x16x32_bf16 v[76:79], v[184:187], a[116:119], v[76:79]
  ds_read_b128 v[172:175], v6 offset:23552
  v_mfma_f32_16x16x32_bf16 v[80:83], v[188:191], a[112:115], v[80:83]
  ds_read_b128 v[176:179], v6 offset:24576
  v_mfma_f32_16x16x32_bf16 v[84:87], v[188:191], a[116:119], v[84:87]
  v_add_u32 v9, 61440, v9
  v_mfma_f32_16x16x32_bf16 v[88:91], v[192:195], a[112:115], v[88:91]
  ds_read_b128 v[200:203], v9 offset:0
  v_mfma_f32_16x16x32_bf16 v[92:95], v[192:195], a[116:119], v[92:95]
  ds_read_b128 v[204:207], v9 offset:1024
  v_mfma_f32_16x16x32_bf16 v[96:99], v[196:199], a[112:115], v[96:99]
  ds_read_b128 v[208:211], v9 offset:2048
  v_mfma_f32_16x16x32_bf16 v[100:103], v[196:199], a[116:119], v[100:103]
  s_waitcnt vmcnt(9)
  s_waitcnt lgkmcnt(0)
  v_mfma_f32_16x16x32_bf16 v[128:131], v[200:203], a[172:175], v[128:131]
  v_mfma_f32_16x16x32_bf16 v[132:135], v[204:207], a[172:175], v[132:135]
  v_mfma_f32_16x16x32_bf16 v[136:139], v[208:211], a[172:175], v[136:139]
  v_mfma_f32_16x16x32_bf16 v[64:67], v[140:143], a[120:123], v[64:67]
  ds_read_b128 v[180:183], v6 offset:25600
  v_mfma_f32_16x16x32_bf16 v[68:71], v[140:143], a[124:127], v[68:71]
  ds_read_b128 v[184:187], v6 offset:26624
  v_mfma_f32_16x16x32_bf16 v[72:75], v[144:147], a[120:123], v[72:75]
  ds_read_b128 v[188:191], v6 offset:27648
  v_mfma_f32_16x16x32_bf16 v[76:79], v[144:147], a[124:127], v[76:79]
  ds_read_b128 v[192:195], v6 offset:28672
  v_mfma_f32_16x16x32_bf16 v[80:83], v[148:151], a[120:123], v[80:83]
  ds_read_b128 v[196:199], v6 offset:29696
  v_mfma_f32_16x16x32_bf16 v[84:87], v[148:151], a[124:127], v[84:87]
  ds_read_b128 v[212:215], v10 offset:20480
  v_mfma_f32_16x16x32_bf16 v[88:91], v[152:155], a[120:123], v[88:91]
  ds_read_b128 v[216:219], v10 offset:21504
  v_mfma_f32_16x16x32_bf16 v[92:95], v[152:155], a[124:127], v[92:95]
  ds_read_b128 v[220:223], v11 offset:20480
  v_mfma_f32_16x16x32_bf16 v[96:99], v[156:159], a[120:123], v[96:99]
  v_mfma_f32_16x16x32_bf16 v[100:103], v[156:159], a[124:127], v[100:103]
  s_waitcnt vmcnt(7)
  s_waitcnt lgkmcnt(0)
  v_mfma_f32_16x16x32_bf16 v[52:55], a[168:171], v[212:215], v[52:55]
  v_mfma_f32_16x16x32_bf16 v[56:59], a[168:171], v[216:219], v[56:59]
  v_mfma_f32_16x16x32_bf16 v[60:63], a[168:171], v[220:223], v[60:63]
  v_mfma_f32_16x16x32_bf16 v[64:67], v[160:163], a[128:131], v[64:67]
  ds_read_b128 v[140:143], v6 offset:30720
  v_mfma_f32_16x16x32_bf16 v[68:71], v[160:163], a[132:135], v[68:71]
  ds_read_b128 v[144:147], v6 offset:31744
  v_mfma_f32_16x16x32_bf16 v[72:75], v[164:167], a[128:131], v[72:75]
  ds_read_b128 v[148:151], v6 offset:32768
  v_mfma_f32_16x16x32_bf16 v[76:79], v[164:167], a[132:135], v[76:79]
  ds_read_b128 v[152:155], v6 offset:33792
  v_mfma_f32_16x16x32_bf16 v[80:83], v[168:171], a[128:131], v[80:83]
  ds_read_b128 v[156:159], v6 offset:34816
  v_mfma_f32_16x16x32_bf16 v[84:87], v[168:171], a[132:135], v[84:87]
  v_mfma_f32_16x16x32_bf16 v[88:91], v[172:175], a[128:131], v[88:91]
  v_mfma_f32_16x16x32_bf16 v[92:95], v[172:175], a[132:135], v[92:95]
  v_mfma_f32_16x16x32_bf16 v[96:99], v[176:179], a[128:131], v[96:99]
  v_mfma_f32_16x16x32_bf16 v[100:103], v[176:179], a[132:135], v[100:103]
  s_waitcnt vmcnt(4)
  v_mfma_f32_16x16x32_bf16 v[64:67], v[180:183], a[136:139], v[64:67]
  ds_read_b128 v[160:163], v6 offset:35840
  v_mfma_f32_16x16x32_bf16 v[68:71], v[180:183], a[140:143], v[68:71]
  ds_read_b128 v[164:167], v6 offset:36864
  v_mfma_f32_16x16x32_bf16 v[72:75], v[184:187], a[136:139], v[72:75]
  ds_read_b128 v[168:171], v6 offset:37888
  v_mfma_f32_16x16x32_bf16 v[76:79], v[184:187], a[140:143], v[76:79]
  ds_read_b128 v[172:175], v6 offset:38912
  v_mfma_f32_16x16x32_bf16 v[80:83], v[188:191], a[136:139], v[80:83]
  ds_read_b128 v[176:179], v6 offset:39936
  v_mfma_f32_16x16x32_bf16 v[84:87], v[188:191], a[140:143], v[84:87]
  ds_read_b128 v[212:215], v10 offset:30720
  v_mfma_f32_16x16x32_bf16 v[88:91], v[192:195], a[136:139], v[88:91]
  ds_read_b128 v[216:219], v10 offset:31744
  v_mfma_f32_16x16x32_bf16 v[92:95], v[192:195], a[140:143], v[92:95]
  ds_read_b128 v[220:223], v11 offset:30720
  v_mfma_f32_16x16x32_bf16 v[96:99], v[196:199], a[136:139], v[96:99]
  v_mfma_f32_16x16x32_bf16 v[100:103], v[196:199], a[140:143], v[100:103]
  s_waitcnt vmcnt(2) lgkmcnt(8)
  s_waitcnt lgkmcnt(0)
  v_mfma_f32_16x16x32_bf16 v[52:55], a[172:175], v[212:215], v[52:55]
  v_mfma_f32_16x16x32_bf16 v[56:59], a[172:175], v[216:219], v[56:59]
  v_mfma_f32_16x16x32_bf16 v[60:63], a[172:175], v[220:223], v[60:63]
  v_mfma_f32_16x16x32_bf16 v[64:67], v[140:143], a[144:147], v[64:67]
  ds_read_b128 v[180:183], v6 offset:40960
  ds_read_b128 v[184:187], v6 offset:41984
  v_mfma_f32_16x16x32_bf16 v[68:71], v[140:143], a[148:151], v[68:71]
  ds_read_b128 v[188:191], v6 offset:43008
  v_mfma_f32_16x16x32_bf16 v[72:75], v[144:147], a[144:147], v[72:75]
  ds_read_b128 v[192:195], v6 offset:44032
  v_mfma_f32_16x16x32_bf16 v[76:79], v[144:147], a[148:151], v[76:79]
  ds_read_b128 v[196:199], v6 offset:45056
  v_mfma_f32_16x16x32_bf16 v[80:83], v[148:151], a[144:147], v[80:83]
  ds_read_b128 v[200:203], v9 offset:20480
  v_mfma_f32_16x16x32_bf16 v[84:87], v[148:151], a[148:151], v[84:87]
  ds_read_b128 v[204:207], v9 offset:21504
  v_mfma_f32_16x16x32_bf16 v[88:91], v[152:155], a[144:147], v[88:91]
  ds_read_b128 v[208:211], v9 offset:22528
  v_mfma_f32_16x16x32_bf16 v[92:95], v[152:155], a[148:151], v[92:95]
  ds_read_b128 v[212:215], v10 offset:40960
  v_mfma_f32_16x16x32_bf16 v[96:99], v[156:159], a[144:147], v[96:99]
  ds_read_b128 v[216:219], v10 offset:41984
  v_mfma_f32_16x16x32_bf16 v[100:103], v[156:159], a[148:151], v[100:103]
  ds_read_b128 v[220:223], v11 offset:40960
  s_waitcnt vmcnt(0)
  s_waitcnt lgkmcnt(0)
  v_mfma_f32_16x16x32_bf16 v[52:55], a[176:179], v[212:215], v[52:55]
  v_mfma_f32_16x16x32_bf16 v[56:59], a[176:179], v[216:219], v[56:59]
  v_mfma_f32_16x16x32_bf16 v[60:63], a[176:179], v[220:223], v[60:63]
  v_mfma_f32_16x16x32_bf16 v[128:131], v[200:203], a[176:179], v[128:131]
  v_mfma_f32_16x16x32_bf16 v[132:135], v[204:207], a[176:179], v[132:135]
  v_mfma_f32_16x16x32_bf16 v[136:139], v[208:211], a[176:179], v[136:139]
  v_mfma_f32_16x16x32_bf16 v[64:67], v[160:163], a[152:155], v[64:67]
  ds_read_b128 v[212:215], v7 offset:51200
  v_mfma_f32_16x16x32_bf16 v[68:71], v[160:163], a[156:159], v[68:71]
  ds_read_b128 v[216:219], v7 offset:52224
  v_mfma_f32_16x16x32_bf16 v[72:75], v[164:167], a[152:155], v[72:75]
  ds_read_b128 v[220:223], v8 offset:51200
  v_mfma_f32_16x16x32_bf16 v[76:79], v[164:167], a[156:159], v[76:79]
  v_mfma_f32_16x16x32_bf16 v[80:83], v[168:171], a[152:155], v[80:83]
  v_mfma_f32_16x16x32_bf16 v[84:87], v[168:171], a[156:159], v[84:87]
  v_mfma_f32_16x16x32_bf16 v[88:91], v[172:175], a[152:155], v[88:91]
  v_mfma_f32_16x16x32_bf16 v[92:95], v[172:175], a[156:159], v[92:95]
  v_mfma_f32_16x16x32_bf16 v[96:99], v[176:179], a[152:155], v[96:99]
  v_mfma_f32_16x16x32_bf16 v[100:103], v[176:179], a[156:159], v[100:103]
  s_waitcnt lgkmcnt(0)
  s_barrier
  v_mfma_f32_16x16x32_bf16 v[52:55], v[44:47], v[212:215], v[52:55]
  v_mfma_f32_16x16x32_bf16 v[56:59], v[44:47], v[216:219], v[56:59]
  v_mfma_f32_16x16x32_bf16 v[60:63], v[44:47], v[220:223], v[60:63]
  v_mfma_f32_16x16x32_bf16 v[64:67], v[180:183], v[36:39], v[64:67]
  ds_read_b128 v[224:227], v7 offset:0
  v_mfma_f32_16x16x32_bf16 v[68:71], v[180:183], v[40:43], v[68:71]
  ds_read_b128 v[228:231], v7 offset:1024
  v_mfma_f32_16x16x32_bf16 v[72:75], v[184:187], v[36:39], v[72:75]
  ds_read_b128 v[232:235], v8 offset:0
  v_mfma_f32_16x16x32_bf16 v[76:79], v[184:187], v[40:43], v[76:79]
  ds_read_b128 v[200:203], v7 offset:2560
  v_mfma_f32_16x16x32_bf16 v[80:83], v[188:191], v[36:39], v[80:83]
  ds_read_b128 v[204:207], v7 offset:3584
  v_mfma_f32_16x16x32_bf16 v[84:87], v[188:191], v[40:43], v[84:87]
  ds_read_b128 v[208:211], v8 offset:2560
  v_mfma_f32_16x16x32_bf16 v[88:91], v[192:195], v[36:39], v[88:91]
  v_mfma_f32_16x16x32_bf16 v[92:95], v[192:195], v[40:43], v[92:95]
  v_mfma_f32_16x16x32_bf16 v[96:99], v[196:199], v[36:39], v[96:99]
  v_mfma_f32_16x16x32_bf16 v[100:103], v[196:199], v[40:43], v[100:103]
  v_mfma_f32_16x16x32_bf16 v[128:131], v[188:191], v[44:47], v[128:131]
  v_mfma_f32_16x16x32_bf16 v[132:135], v[192:195], v[44:47], v[132:135]
  v_mfma_f32_16x16x32_bf16 v[136:139], v[196:199], v[44:47], v[136:139]
  s_waitcnt lgkmcnt(3)
  v_mfma_f32_16x16x32_bf16 v[104:107], a[0:3], v[224:227], 0
  s_mul_i32 s58, s12, 3072
  s_add_u32 s58, s58, 73728
  v_add_u32 v48, s58, v2
  ds_read_b128 v[212:215], v7 offset:5120
  v_mfma_f32_16x16x32_bf16 v[108:111], a[4:7], v[224:227], 0
  ds_read_b128 v[216:219], v7 offset:6144
  v_mfma_f32_16x16x32_bf16 v[112:115], a[0:3], v[228:231], 0
  s_lshl_b32 s58, s12, 11
  s_add_u32 s58, s58, 63488
  v_add_u32 v49, s58, v2
  ds_read_b128 v[220:223], v8 offset:5120
  v_mfma_f32_16x16x32_bf16 v[116:119], a[4:7], v[228:231], 0
  v_mfma_f32_16x16x32_bf16 v[120:123], a[0:3], v[232:235], 0
  ds_write_b128 v48, v[52:55] offset:12288
  v_mfma_f32_16x16x32_bf16 v[124:127], a[4:7], v[232:235], 0
  ds_write_b128 v48, v[56:59] offset:13312
  ds_write_b128 v48, v[60:63] offset:14336
  s_waitcnt lgkmcnt(6)
  v_mfma_f32_16x16x32_bf16 v[104:107], a[8:11], v[200:203], v[104:107]
  s_cmp_eq_u32 s12, 1
  s_cselect_b32 s58, 12288, 0
  s_cselect_b32 s59, 2560, 0
  s_add_u32 s58, s58, 73728
  s_add_u32 s59, s59, 98304
  v_add_u32 v12, s58, v2
  v_lshl_add_u32 v15, v1, 3, s59
  ds_read_b128 v[224:227], v7 offset:7680
  v_mfma_f32_16x16x32_bf16 v[108:111], a[12:15], v[200:203], v[108:111]
  ds_read_b128 v[228:231], v7 offset:8704
  v_mfma_f32_16x16x32_bf16 v[112:115], a[8:11], v[204:207], v[112:115]
  ds_read_b128 v[232:235], v8 offset:7680
  v_mfma_f32_16x16x32_bf16 v[116:119], a[12:15], v[204:207], v[116:119]
  s_add_u32 s36, s61, 0
  buffer_load_dwordx4 a[0:3], v2, s[4:7], s36 offen offset:0 sc1
  v_mfma_f32_16x16x32_bf16 v[120:123], a[8:11], v[208:211], v[120:123]
  buffer_load_dwordx4 a[4:7], v2, s[4:7], s36 offen offset:1024 sc1
  v_mfma_f32_16x16x32_bf16 v[124:127], a[12:15], v[208:211], v[124:127]
  s_waitcnt lgkmcnt(6)
  v_mfma_f32_16x16x32_bf16 v[104:107], a[16:19], v[212:215], v[104:107]
  v_pk_mul_f32 v[100:101], v[100:101], v[30:31] op_sel_hi:[1,0]
  v_pk_mul_f32 v[102:103], v[102:103], v[30:31] op_sel_hi:[1,0]
  v_pk_mul_f32 v[84:85], v[84:85], v[30:31] op_sel_hi:[1,0]
  v_pk_mul_f32 v[86:87], v[86:87], v[30:31] op_sel_hi:[1,0]
  v_pk_mul_f32 v[92:93], v[92:93], v[30:31] op_sel_hi:[1,0]
  v_pk_mul_f32 v[94:95], v[94:95], v[30:31] op_sel_hi:[1,0]
  v_pk_mul_f32 v[68:69], v[68:69], v[30:31] op_sel_hi:[1,0]
  v_pk_mul_f32 v[70:71], v[70:71], v[30:31] op_sel_hi:[1,0]
  v_pk_mul_f32 v[76:77], v[76:77], v[30:31] op_sel_hi:[1,0]
  v_pk_mul_f32 v[78:79], v[78:79], v[30:31] op_sel_hi:[1,0]
  v_pk_mul_f32 v[96:97], v[96:97], v[28:29] op_sel_hi:[1,0]
  v_pk_mul_f32 v[98:99], v[98:99], v[28:29] op_sel_hi:[1,0]
  v_pk_mul_f32 v[80:81], v[80:81], v[28:29] op_sel_hi:[1,0]
  v_pk_mul_f32 v[82:83], v[82:83], v[28:29] op_sel_hi:[1,0]
  v_pk_mul_f32 v[88:89], v[88:89], v[28:29] op_sel_hi:[1,0]
  v_pk_mul_f32 v[90:91], v[90:91], v[28:29] op_sel_hi:[1,0]
  v_pk_mul_f32 v[64:65], v[64:65], v[28:29] op_sel_hi:[1,0]
  v_pk_mul_f32 v[66:67], v[66:67], v[28:29] op_sel_hi:[1,0]
  v_pk_mul_f32 v[72:73], v[72:73], v[28:29] op_sel_hi:[1,0]
  v_pk_mul_f32 v[74:75], v[74:75], v[28:29] op_sel_hi:[1,0]
  ds_read_b128 v[200:203], v7 offset:10240
  v_mfma_f32_16x16x32_bf16 v[108:111], a[20:23], v[212:215], v[108:111]
  ds_read_b128 v[204:207], v7 offset:11264
  v_mfma_f32_16x16x32_bf16 v[112:115], a[16:19], v[216:219], v[112:115]
  ds_read_b128 v[208:211], v8 offset:10240
  v_mfma_f32_16x16x32_bf16 v[116:119], a[20:23], v[216:219], v[116:119]
  buffer_load_dwordx4 a[8:11], v2, s[4:7], s36 offen offset:2048 sc1
  v_mfma_f32_16x16x32_bf16 v[120:123], a[16:19], v[220:223], v[120:123]
  buffer_load_dwordx4 a[12:15], v2, s[4:7], s36 offen offset:3072 sc1
  v_mfma_f32_16x16x32_bf16 v[124:127], a[20:23], v[220:223], v[124:127]
  s_waitcnt lgkmcnt(3)
  v_mfma_f32_16x16x32_bf16 v[104:107], a[24:27], v[224:227], v[104:107]
  ds_read_b128 v[212:215], v7 offset:12800
  v_mfma_f32_16x16x32_bf16 v[108:111], a[28:31], v[224:227], v[108:111]
  ds_read_b128 v[216:219], v7 offset:13824
  v_mfma_f32_16x16x32_bf16 v[112:115], a[24:27], v[228:231], v[112:115]
  ds_read_b128 v[220:223], v8 offset:12800
  v_mfma_f32_16x16x32_bf16 v[116:119], a[28:31], v[228:231], v[116:119]
  buffer_load_dwordx4 a[16:19], v50, s[4:7], s36 offen sc1
  v_mfma_f32_16x16x32_bf16 v[120:123], a[24:27], v[232:235], v[120:123]
  s_add_u32 s36, s61, 5120
  buffer_load_dwordx4 a[20:23], v2, s[4:7], s36 offen offset:0 sc1
  v_mfma_f32_16x16x32_bf16 v[124:127], a[28:31], v[232:235], v[124:127]
  s_waitcnt lgkmcnt(3)
  v_mfma_f32_16x16x32_bf16 v[104:107], a[32:35], v[200:203], v[104:107]
  ds_read_b128 v[224:227], v7 offset:15360
  v_mfma_f32_16x16x32_bf16 v[108:111], a[36:39], v[200:203], v[108:111]
  ds_read_b128 v[228:231], v7 offset:16384
  v_mfma_f32_16x16x32_bf16 v[112:115], a[32:35], v[204:207], v[112:115]
  ds_read_b128 v[232:235], v8 offset:15360
  v_mfma_f32_16x16x32_bf16 v[116:119], a[36:39], v[204:207], v[116:119]
  buffer_load_dwordx4 a[24:27], v2, s[4:7], s36 offen offset:1024 sc1
  v_mfma_f32_16x16x32_bf16 v[120:123], a[32:35], v[208:211], v[120:123]
  buffer_load_dwordx4 a[28:31], v2, s[4:7], s36 offen offset:2048 sc1
  v_mfma_f32_16x16x32_bf16 v[124:127], a[36:39], v[208:211], v[124:127]
  s_waitcnt lgkmcnt(3)
  v_mfma_f32_16x16x32_bf16 v[104:107], a[40:43], v[212:215], v[104:107]
  ds_write_b128 v48, v[128:131] offset:0
  ds_read_b128 v[200:203], v7 offset:17920
  v_mfma_f32_16x16x32_bf16 v[108:111], a[44:47], v[212:215], v[108:111]
  ds_write_b128 v48, v[132:135] offset:1024
  ds_read_b128 v[204:207], v7 offset:18944
  v_mfma_f32_16x16x32_bf16 v[112:115], a[40:43], v[216:219], v[112:115]
  ds_write_b128 v48, v[136:139] offset:2048
  ds_read_b128 v[208:211], v8 offset:17920
  v_mfma_f32_16x16x32_bf16 v[116:119], a[44:47], v[216:219], v[116:119]
  v_cvt_pk_bf16_f32 v172, v84, v85
  buffer_load_dwordx4 a[32:35], v2, s[4:7], s36 offen offset:3072 sc1
  v_mfma_f32_16x16x32_bf16 v[120:123], a[40:43], v[220:223], v[120:123]
  v_cvt_pk_bf16_f32 v173, v86, v87
  buffer_load_dwordx4 a[36:39], v50, s[4:7], s36 offen sc1
  v_mfma_f32_16x16x32_bf16 v[124:127], a[44:47], v[220:223], v[124:127]
  v_cvt_pk_bf16_f32 v174, v102, 0
  s_waitcnt lgkmcnt(6)
  v_mfma_f32_16x16x32_bf16 v[104:107], a[48:51], v[224:227], v[104:107]
  v_mov_b32 v175, 0
  v_cvt_pk_bf16_f32 v176, v92, v93
  ds_read_b128 v[212:215], v7 offset:20480
  v_mfma_f32_16x16x32_bf16 v[108:111], a[52:55], v[224:227], v[108:111]
  v_cvt_pk_bf16_f32 v177, v94, v95
  ds_read_b128 v[216:219], v7 offset:21504
  v_mfma_f32_16x16x32_bf16 v[112:115], a[48:51], v[228:231], v[112:115]
  v_cvt_pk_bf16_f32 v178, v103, 0
  ds_read_b128 v[220:223], v8 offset:20480
  v_mfma_f32_16x16x32_bf16 v[116:119], a[52:55], v[228:231], v[116:119]
  v_mov_b32 v179, 0
  s_add_u32 s36, s61, 10240
  buffer_load_dwordx4 a[40:43], v2, s[4:7], s36 offen offset:0 sc1
  v_mfma_f32_16x16x32_bf16 v[120:123], a[48:51], v[232:235], v[120:123]
  buffer_load_dwordx4 a[44:47], v2, s[4:7], s36 offen offset:1024 sc1
  v_mfma_f32_16x16x32_bf16 v[124:127], a[52:55], v[232:235], v[124:127]
  ds_write_b128 v49, v[172:175] offset:2048
  s_waitcnt lgkmcnt(4)
  v_mfma_f32_16x16x32_bf16 v[104:107], a[56:59], v[200:203], v[104:107]
  ds_write_b128 v49, v[176:179] offset:3072
  v_cvt_pk_bf16_f32 v164, v80, v81
  ds_read_b128 v[224:227], v7 offset:23040
  v_mfma_f32_16x16x32_bf16 v[108:111], a[60:63], v[200:203], v[108:111]
  v_cvt_pk_bf16_f32 v165, v82, v83
  ds_read_b128 v[228:231], v7 offset:24064
  v_mfma_f32_16x16x32_bf16 v[112:115], a[56:59], v[204:207], v[112:115]
  v_cvt_pk_bf16_f32 v166, v98, 0
  ds_read_b128 v[232:235], v8 offset:23040
  v_mfma_f32_16x16x32_bf16 v[116:119], a[60:63], v[204:207], v[116:119]
  v_mov_b32 v167, 0
  buffer_load_dwordx4 a[48:51], v2, s[4:7], s36 offen offset:2048 sc1
  v_mfma_f32_16x16x32_bf16 v[120:123], a[56:59], v[208:211], v[120:123]
  v_cvt_pk_bf16_f32 v168, v88, v89
  buffer_load_dwordx4 a[52:55], v2, s[4:7], s36 offen offset:3072 sc1
  v_mfma_f32_16x16x32_bf16 v[124:127], a[60:63], v[208:211], v[124:127]
  v_cvt_pk_bf16_f32 v169, v90, v91
  s_waitcnt lgkmcnt(5)
  v_mfma_f32_16x16x32_bf16 v[104:107], a[64:67], v[212:215], v[104:107]
  v_cvt_pk_bf16_f32 v170, v99, 0
  v_mov_b32 v171, 0
  ds_read_b128 v[200:203], v7 offset:25600
  v_mfma_f32_16x16x32_bf16 v[108:111], a[68:71], v[212:215], v[108:111]
  v_cvt_pk_bf16_f32 v148, v68, v69
  ds_read_b128 v[204:207], v7 offset:26624
  v_mfma_f32_16x16x32_bf16 v[112:115], a[64:67], v[216:219], v[112:115]
  v_cvt_pk_bf16_f32 v149, v70, v71
  ds_read_b128 v[208:211], v8 offset:25600
  v_mfma_f32_16x16x32_bf16 v[116:119], a[68:71], v[216:219], v[116:119]
  v_cvt_pk_bf16_f32 v150, v100, 0
  s_mul_i32 s91, s12, 13312
  s_add_u32 s92, s91, s27
  s_add_u32 m0, s91, 0
  s_add_u32 s90, s92, 0
  buffer_load_dwordx4 v2, s[4:7], s90 offen offset:0 sc1 lds
  v_mfma_f32_16x16x32_bf16 v[120:123], a[64:67], v[220:223], v[120:123]
  buffer_load_dwordx4 a[56:59], v50, s[4:7], s36 offen sc1
  v_mfma_f32_16x16x32_bf16 v[124:127], a[68:71], v[220:223], v[124:127]
  s_add_u32 s36, s61, 15360
  buffer_load_dwordx4 a[60:63], v2, s[4:7], s36 offen offset:0 sc1
  s_waitcnt lgkmcnt(3)
  v_mfma_f32_16x16x32_bf16 v[104:107], a[72:75], v[224:227], v[104:107]
  ds_read_b128 v[212:215], v7 offset:28160
  v_mfma_f32_16x16x32_bf16 v[108:111], a[76:79], v[224:227], v[108:111]
  ds_read_b128 v[216:219], v7 offset:29184
  v_mfma_f32_16x16x32_bf16 v[112:115], a[72:75], v[228:231], v[112:115]
  ds_read_b128 v[220:223], v8 offset:28160
  v_mfma_f32_16x16x32_bf16 v[116:119], a[76:79], v[228:231], v[116:119]
  v_mov_b32 v151, 0
  buffer_load_dwordx4 v2, s[4:7], s90 offen offset:1024 sc1 lds
  v_mfma_f32_16x16x32_bf16 v[120:123], a[72:75], v[232:235], v[120:123]
  v_cvt_pk_bf16_f32 v152, v76, v77
  buffer_load_dwordx4 a[64:67], v2, s[4:7], s36 offen offset:1024 sc1
  v_mfma_f32_16x16x32_bf16 v[124:127], a[76:79], v[232:235], v[124:127]
  v_cvt_pk_bf16_f32 v153, v78, v79
  buffer_load_dwordx4 a[68:71], v2, s[4:7], s36 offen offset:2048 sc1
  s_waitcnt lgkmcnt(3)
  v_mfma_f32_16x16x32_bf16 v[104:107], a[80:83], v[200:203], v[104:107]
  v_cvt_pk_bf16_f32 v154, v101, 0
  ds_read_b128 v[224:227], v7 offset:30720
  v_mfma_f32_16x16x32_bf16 v[108:111], a[84:87], v[200:203], v[108:111]
  v_mov_b32 v155, 0
  ds_read_b128 v[228:231], v7 offset:31744
  v_mfma_f32_16x16x32_bf16 v[112:115], a[80:83], v[204:207], v[112:115]
  v_cvt_pk_bf16_f32 v140, v64, v65
  ds_read_b128 v[232:235], v8 offset:30720
  v_mfma_f32_16x16x32_bf16 v[116:119], a[84:87], v[204:207], v[116:119]
  v_cvt_pk_bf16_f32 v141, v66, v67
  buffer_load_dwordx4 v2, s[4:7], s90 offen offset:2048 sc1 lds
  v_mfma_f32_16x16x32_bf16 v[120:123], a[80:83], v[208:211], v[120:123]
  v_cvt_pk_bf16_f32 v142, v96, 0
  buffer_load_dwordx4 a[72:75], v2, s[4:7], s36 offen offset:3072 sc1
  v_mfma_f32_16x16x32_bf16 v[124:127], a[84:87], v[208:211], v[124:127]
  v_mov_b32 v143, 0
  buffer_load_dwordx4 a[76:79], v50, s[4:7], s36 offen sc1
  s_waitcnt lgkmcnt(3)
  v_mfma_f32_16x16x32_bf16 v[104:107], a[88:91], v[212:215], v[104:107]
  v_cvt_pk_bf16_f32 v144, v72, v73
  ds_read_b128 v[200:203], v7 offset:33280
  v_mfma_f32_16x16x32_bf16 v[108:111], a[92:95], v[212:215], v[108:111]
  v_cvt_pk_bf16_f32 v145, v74, v75
  ds_read_b128 v[204:207], v7 offset:34304
  v_mfma_f32_16x16x32_bf16 v[112:115], a[88:91], v[216:219], v[112:115]
  v_cvt_pk_bf16_f32 v146, v97, 0
  ds_read_b128 v[208:211], v8 offset:33280
  v_mfma_f32_16x16x32_bf16 v[116:119], a[92:95], v[216:219], v[116:119]
  v_mov_b32 v147, 0
  buffer_load_dwordx4 v2, s[4:7], s90 offen offset:3072 sc1 lds
  v_mfma_f32_16x16x32_bf16 v[120:123], a[88:91], v[220:223], v[120:123]
  s_waitcnt lgkmcnt(15)
  s_barrier
  s_add_u32 s36, s61, 20480
  buffer_load_dwordx4 a[80:83], v2, s[4:7], s36 offen offset:0 sc1
  v_mfma_f32_16x16x32_bf16 v[124:127], a[92:95], v[220:223], v[124:127]
  buffer_load_dwordx4 a[84:87], v2, s[4:7], s36 offen offset:1024 sc1
  s_waitcnt lgkmcnt(3)
  v_mfma_f32_16x16x32_bf16 v[104:107], a[96:99], v[224:227], v[104:107]
  v_mfma_f32_16x16x32_bf16 v[64:67], v[164:167], v[148:151], 0
  ds_read_b128 v[212:215], v7 offset:35840
  v_mfma_f32_16x16x32_bf16 v[108:111], a[100:103], v[224:227], v[108:111]
  v_mfma_f32_16x16x32_bf16 v[68:71], v[172:175], v[148:151], 0
  ds_read_b128 v[216:219], v7 offset:36864
  v_mfma_f32_16x16x32_bf16 v[112:115], a[96:99], v[228:231], v[112:115]
  v_mfma_f32_16x16x32_bf16 v[72:75], v[168:171], v[152:155], 0
  ds_read_b128 v[220:223], v8 offset:35840
  v_mfma_f32_16x16x32_bf16 v[116:119], a[100:103], v[228:231], v[116:119]
  v_mfma_f32_16x16x32_bf16 v[76:79], v[176:179], v[152:155], 0
  s_add_u32 m0, s91, 4096
  s_add_u32 s90, s92, 4096
  buffer_load_dwordx4 v2, s[4:7], s90 offen offset:0 sc1 lds
  v_mfma_f32_16x16x32_bf16 v[120:123], a[96:99], v[232:235], v[120:123]
  buffer_load_dwordx4 a[88:91], v2, s[4:7], s36 offen offset:2048 sc1
  v_mfma_f32_16x16x32_bf16 v[124:127], a[100:103], v[232:235], v[124:127]
  buffer_load_dwordx4 a[92:95], v2, s[4:7], s36 offen offset:3072 sc1
  s_waitcnt lgkmcnt(3)
  v_mfma_f32_16x16x32_bf16 v[104:107], a[104:107], v[200:203], v[104:107]
  ds_read_b128 v[128:131], v12 offset:0
  ds_read_b128 v[224:227], v7 offset:38400
  v_mfma_f32_16x16x32_bf16 v[108:111], a[108:111], v[200:203], v[108:111]
  ds_read_b128 v[132:135], v12 offset:1024
  ds_read_b128 v[228:231], v7 offset:39424
  v_mfma_f32_16x16x32_bf16 v[112:115], a[104:107], v[204:207], v[112:115]
  ds_read_b128 v[136:139], v12 offset:2048
  ds_read_b128 v[232:235], v8 offset:38400
  v_mfma_f32_16x16x32_bf16 v[116:119], a[108:111], v[204:207], v[116:119]
  ds_read_b128 v[180:183], v12 offset:3072
  buffer_load_dwordx4 v2, s[4:7], s90 offen offset:1024 sc1 lds
  v_mfma_f32_16x16x32_bf16 v[120:123], a[104:107], v[208:211], v[120:123]
  ds_read_b128 v[184:187], v12 offset:4096
  buffer_load_dwordx4 a[96:99], v50, s[4:7], s36 offen sc1
  v_mfma_f32_16x16x32_bf16 v[124:127], a[108:111], v[208:211], v[124:127]
  ds_read_b128 v[188:191], v12 offset:5120
  s_waitcnt lgkmcnt(9)
  v_mfma_f32_16x16x32_bf16 v[104:107], a[112:115], v[212:215], v[104:107]
  ds_read_b128 v[200:203], v7 offset:40960
  v_mfma_f32_16x16x32_bf16 v[108:111], a[116:119], v[212:215], v[108:111]
  ds_read_b128 v[204:207], v7 offset:41984
  v_mfma_f32_16x16x32_bf16 v[112:115], a[112:115], v[216:219], v[112:115]
  ds_read_b128 v[208:211], v8 offset:40960
  v_mfma_f32_16x16x32_bf16 v[116:119], a[116:119], v[216:219], v[116:119]
  buffer_load_dwordx4 v2, s[4:7], s90 offen offset:2048 sc1 lds
  v_mfma_f32_16x16x32_bf16 v[120:123], a[112:115], v[220:223], v[120:123]
  v_mfma_f32_16x16x32_bf16 v[124:127], a[116:119], v[220:223], v[124:127]
  s_waitcnt lgkmcnt(3)
  v_pk_fma_f32 v[64:65], v[64:65], s[54:55], v[16:17]
  v_pk_fma_f32 v[66:67], v[66:67], s[54:55], v[18:19]
  v_pk_fma_f32 v[68:69], v[68:69], s[54:55], v[20:21]
  v_pk_fma_f32 v[70:71], v[70:71], s[54:55], v[22:23]
  v_pk_fma_f32 v[72:73], v[72:73], s[54:55], v[16:17]
  v_pk_fma_f32 v[74:75], v[74:75], s[54:55], v[18:19]
  v_pk_fma_f32 v[76:77], v[76:77], s[54:55], v[20:21]
  v_pk_fma_f32 v[78:79], v[78:79], s[54:55], v[22:23]
  v_pk_add_f32 v[128:129], v[128:129], v[180:181]
  v_pk_add_f32 v[130:131], v[130:131], v[182:183]
  v_pk_add_f32 v[132:133], v[132:133], v[184:185]
  v_pk_add_f32 v[134:135], v[134:135], v[186:187]
  v_pk_add_f32 v[136:137], v[136:137], v[188:189]
  v_pk_add_f32 v[138:139], v[138:139], v[190:191]
  s_waitcnt lgkmcnt(6)
  v_mfma_f32_16x16x32_bf16 v[104:107], a[120:123], v[224:227], v[104:107]
  ds_read_b128 v[212:215], v7 offset:43520
  v_mfma_f32_16x16x32_bf16 v[108:111], a[124:127], v[224:227], v[108:111]
  ds_read_b128 v[216:219], v7 offset:44544
  v_mfma_f32_16x16x32_bf16 v[112:115], a[120:123], v[228:231], v[112:115]
  ds_read_b128 v[220:223], v8 offset:43520
  v_mfma_f32_16x16x32_bf16 v[116:119], a[124:127], v[228:231], v[116:119]
  buffer_load_dwordx4 v2, s[4:7], s90 offen offset:3072 sc1 lds
  v_mfma_f32_16x16x32_bf16 v[120:123], a[120:123], v[232:235], v[120:123]
  v_mfma_f32_16x16x32_bf16 v[124:127], a[124:127], v[232:235], v[124:127]
  s_waitcnt lgkmcnt(3)
  v_mfma_f32_16x16x32_bf16 v[104:107], a[128:131], v[200:203], v[104:107]
  ds_read_b128 v[224:227], v7 offset:46080
  v_mfma_f32_16x16x32_bf16 v[108:111], a[132:135], v[200:203], v[108:111]
  ds_read_b128 v[228:231], v7 offset:47104
  v_mfma_f32_16x16x32_bf16 v[112:115], a[128:131], v[204:207], v[112:115]
  ds_read_b128 v[180:183], v12 offset:6144
  ds_read_b128 v[232:235], v8 offset:46080
  v_mfma_f32_16x16x32_bf16 v[116:119], a[132:135], v[204:207], v[116:119]
  ds_read_b128 v[184:187], v12 offset:7168
  s_add_u32 m0, s91, 8192
  s_add_u32 s90, s92, 8192
  buffer_load_dwordx4 v2, s[4:7], s90 offen offset:0 sc1 lds
  v_mfma_f32_16x16x32_bf16 v[120:123], a[128:131], v[208:211], v[120:123]
  v_mfma_f32_16x16x32_bf16 v[124:127], a[132:135], v[208:211], v[124:127]
  ds_read_b128 v[188:191], v12 offset:8192
  s_waitcnt lgkmcnt(6)
  v_mfma_f32_16x16x32_bf16 v[104:107], a[136:139], v[212:215], v[104:107]
  v_max3_f32 v80, v64, v65, v66
  v_max3_f32 v84, v67, v68, v69
  ds_read_b128 v[200:203], v7 offset:48640
  v_mfma_f32_16x16x32_bf16 v[108:111], a[140:143], v[212:215], v[108:111]
  v_max3_f32 v82, v72, v73, v74
  ds_read_b128 v[204:207], v7 offset:49664
  v_mfma_f32_16x16x32_bf16 v[112:115], a[136:139], v[216:219], v[112:115]
  v_max3_f32 v85, v75, v76, v77
  ds_read_b128 v[208:211], v8 offset:48640
  v_mfma_f32_16x16x32_bf16 v[116:119], a[140:143], v[216:219], v[116:119]
  v_max3_f32 v80, v80, v70, v71
  buffer_load_dwordx4 v2, s[4:7], s90 offen offset:1024 sc1 lds
  v_mfma_f32_16x16x32_bf16 v[120:123], a[136:139], v[220:223], v[120:123]
  v_max3_f32 v82, v82, v78, v79
  v_mfma_f32_16x16x32_bf16 v[124:127], a[140:143], v[220:223], v[124:127]
  v_max_f32 v80, v80, v84
  v_max_f32 v82, v82, v85
  s_waitcnt lgkmcnt(5)
  v_mfma_f32_16x16x32_bf16 v[104:107], a[144:147], v[224:227], v[104:107]
  v_permlane32_swap_b32 v80, v82
  v_max_f32 v80, v80, v82
  ds_read_b128 v[212:215], v7 offset:51200
  v_mfma_f32_16x16x32_bf16 v[108:111], a[148:151], v[224:227], v[108:111]
  v_mov_b32 v82, v80
  ds_read_b128 v[216:219], v7 offset:52224
  v_mfma_f32_16x16x32_bf16 v[112:115], a[144:147], v[228:231], v[112:115]
  v_permlane16_swap_b32 v80, v82
  ds_read_b128 v[220:223], v8 offset:51200
  v_mfma_f32_16x16x32_bf16 v[116:119], a[148:151], v[228:231], v[116:119]
  v_max_f32 v80, v80, v82
  buffer_load_dwordx4 v2, s[4:7], s90 offen offset:2048 sc1 lds
  v_mfma_f32_16x16x32_bf16 v[120:123], a[144:147], v[232:235], v[120:123]
  v_mov_b32 v82, v80
  v_mfma_f32_16x16x32_bf16 v[124:127], a[148:151], v[232:235], v[124:127]
  s_waitcnt lgkmcnt(3)
  v_mfma_f32_16x16x32_bf16 v[104:107], a[152:155], v[200:203], v[104:107]
  v_permlane32_swap_b32 v80, v82
  s_waitcnt lgkmcnt(6)
  v_pk_add_f32 v[64:65], v[64:65], v[80:81] op_sel_hi:[1,0] neg_lo:[0,1] neg_hi:[0,1]
  v_pk_add_f32 v[66:67], v[66:67], v[80:81] op_sel_hi:[1,0] neg_lo:[0,1] neg_hi:[0,1]
  v_pk_add_f32 v[68:69], v[68:69], v[80:81] op_sel_hi:[1,0] neg_lo:[0,1] neg_hi:[0,1]
  v_pk_add_f32 v[70:71], v[70:71], v[80:81] op_sel_hi:[1,0] neg_lo:[0,1] neg_hi:[0,1]
  v_pk_add_f32 v[72:73], v[72:73], v[82:83] op_sel_hi:[1,0] neg_lo:[0,1] neg_hi:[0,1]
  v_pk_add_f32 v[74:75], v[74:75], v[82:83] op_sel_hi:[1,0] neg_lo:[0,1] neg_hi:[0,1]
  v_pk_add_f32 v[76:77], v[76:77], v[82:83] op_sel_hi:[1,0] neg_lo:[0,1] neg_hi:[0,1]
  v_pk_add_f32 v[78:79], v[78:79], v[82:83] op_sel_hi:[1,0] neg_lo:[0,1] neg_hi:[0,1]
  v_pk_add_f32 v[128:129], v[128:129], v[180:181]
  v_pk_add_f32 v[130:131], v[130:131], v[182:183]
  v_pk_add_f32 v[132:133], v[132:133], v[184:185]
  v_pk_add_f32 v[134:135], v[134:135], v[186:187]
  v_pk_add_f32 v[136:137], v[136:137], v[188:189]
  v_pk_add_f32 v[138:139], v[138:139], v[190:191]
  buffer_load_dwordx4 v2, s[4:7], s90 offen offset:3072 sc1 lds
  v_mfma_f32_16x16x32_bf16 v[108:111], a[156:159], v[200:203], v[108:111]
  v_mfma_f32_16x16x32_bf16 v[112:115], a[152:155], v[204:207], v[112:115]
  v_mfma_f32_16x16x32_bf16 v[116:119], a[156:159], v[204:207], v[116:119]
  v_mfma_f32_16x16x32_bf16 v[120:123], a[152:155], v[208:211], v[120:123]
  v_mfma_f32_16x16x32_bf16 v[124:127], a[156:159], v[208:211], v[124:127]
  s_waitcnt lgkmcnt(0)
  v_mfma_f32_16x16x32_bf16 v[104:107], v[36:39], v[212:215], v[104:107]
  s_add_u32 m0, s91, 12288
  s_add_u32 s90, s92, 12288
  buffer_load_dwordx4 v2, s[4:7], s90 offen offset:0 sc1 lds
  v_mfma_f32_16x16x32_bf16 v[108:111], v[40:43], v[212:215], v[108:111]
  v_mfma_f32_16x16x32_bf16 v[112:115], v[36:39], v[216:219], v[112:115]
  v_mfma_f32_16x16x32_bf16 v[116:119], v[40:43], v[216:219], v[116:119]
  ds_read_b128 v[180:183], v12 offset:9216
  ds_read_b128 v[184:187], v12 offset:10240
  v_mfma_f32_16x16x32_bf16 v[120:123], v[36:39], v[220:223], v[120:123]
  ds_read_b128 v[188:191], v12 offset:11264
  v_exp_f32 v64, v64
  v_mfma_f32_16x16x32_bf16 v[124:127], v[40:43], v[220:223], v[124:127]
  v_exp_f32 v65, v65
  v_exp_f32 v66, v66
  v_exp_f32 v67, v67
  v_exp_f32 v68, v68
  v_exp_f32 v69, v69
  v_exp_f32 v70, v70
  v_exp_f32 v71, v71
  s_waitcnt lgkmcnt(0)
  v_pk_add_f32 v[128:129], v[128:129], v[180:181]
  v_pk_add_f32 v[130:131], v[130:131], v[182:183]
  v_pk_add_f32 v[132:133], v[132:133], v[184:185]
  v_pk_add_f32 v[134:135], v[134:135], v[186:187]
  v_pk_add_f32 v[136:137], v[136:137], v[188:189]
  v_pk_add_f32 v[138:139], v[138:139], v[190:191]
  v_mul_f32_dpp v52, v34, v128 row_newbcast:8 row_mask:0xf bank_mask:0xf
  v_mul_f32_dpp v53, v34, v129 row_newbcast:9 row_mask:0xf bank_mask:0xf
  v_mul_f32_dpp v54, v34, v130 row_newbcast:10 row_mask:0xf bank_mask:0xf
  v_mul_f32_dpp v55, v34, v131 row_newbcast:11 row_mask:0xf bank_mask:0xf
  v_mul_f32_dpp v56, v34, v132 row_newbcast:8 row_mask:0xf bank_mask:0xf
  v_mul_f32_dpp v57, v34, v133 row_newbcast:9 row_mask:0xf bank_mask:0xf
  v_mul_f32_dpp v58, v34, v134 row_newbcast:10 row_mask:0xf bank_mask:0xf
  v_mul_f32_dpp v59, v34, v135 row_newbcast:11 row_mask:0xf bank_mask:0xf
  v_mul_f32_dpp v60, v34, v136 row_newbcast:8 row_mask:0xf bank_mask:0xf
  v_mul_f32_dpp v61, v34, v137 row_newbcast:9 row_mask:0xf bank_mask:0xf
  v_mul_f32_dpp v62, v34, v138 row_newbcast:10 row_mask:0xf bank_mask:0xf
  v_mul_f32_dpp v63, v34, v139 row_newbcast:11 row_mask:0xf bank_mask:0xf
  v_pk_mul_f32 v[128:129], v[128:129], v[32:33] op_sel_hi:[1,0]
  v_pk_mul_f32 v[130:131], v[130:131], v[32:33] op_sel_hi:[1,0]
  v_pk_mul_f32 v[132:133], v[132:133], v[32:33] op_sel_hi:[1,0]
  v_pk_mul_f32 v[134:135], v[134:135], v[32:33] op_sel_hi:[1,0]
  v_pk_mul_f32 v[138:139], v[138:139], v[32:33] op_sel_hi:[1,0]
  v_cvt_pk_bf16_f32 v156, v128, v129
  v_cvt_pk_bf16_f32 v157, v130, v131
  v_cvt_pk_bf16_f32 v158, v138, 0
  v_mov_b32 v159, 0
  v_cvt_pk_bf16_f32 v160, v132, v133
  v_cvt_pk_bf16_f32 v161, v134, v135
  v_cvt_pk_bf16_f32 v162, v139, 0
  v_mov_b32 v163, 0
  s_mov_b64 exec, s[56:57]
  ds_read_b128 v[156:159], v49 offset:0
  ds_read_b128 v[160:163], v49 offset:1024
  s_mov_b64 exec, -1
  v_exp_f32 v72, v72
  v_exp_f32 v73, v73
  v_exp_f32 v74, v74
  v_exp_f32 v75, v75
  v_exp_f32 v76, v76
  v_exp_f32 v77, v77
  v_exp_f32 v78, v78
  v_exp_f32 v79, v79
  v_cvt_pk_bf16_f32 v96, v64, v65
  v_cvt_pk_bf16_f32 v97, v66, v67
  v_cvt_pk_bf16_f32 v98, v68, v69
  v_cvt_pk_bf16_f32 v99, v70, v71
  v_cvt_pk_bf16_f32 v100, v72, v73
  v_cvt_pk_bf16_f32 v101, v74, v75
  v_cvt_pk_bf16_f32 v102, v76, v77
  v_cvt_pk_bf16_f32 v103, v78, v79
  s_waitcnt lgkmcnt(0)
  v_mfma_f32_16x16x32_bf16 v[64:67], v[156:159], v[140:143], 0
  v_mfma_f32_16x16x32_bf16 v[68:71], v[164:167], v[140:143], 0
  v_mfma_f32_16x16x32_bf16 v[72:75], v[160:163], v[144:147], 0
  v_mfma_f32_16x16x32_bf16 v[76:79], v[168:171], v[144:147], 0
  v_cvt_pk_bf16_f32 v192, v52, v53
  v_cvt_pk_bf16_f32 v193, v54, v55
  v_cvt_pk_bf16_f32 v194, v56, v57
  v_cvt_pk_bf16_f32 v195, v58, v59
  v_cvt_pk_bf16_f32 v196, v60, v61
  v_cvt_pk_bf16_f32 v197, v62, v63
  v_cndmask_b32 v196, v196, v51, s[50:51]
  v_cndmask_b32 v197, v197, v51, s[50:51]
  ds_write_b64 v15, v[192:193] offset:0
  ds_write_b64 v15, v[194:195] offset:512
  ds_write_b64 v15, v[196:197] offset:1024
  s_mul_i32 s58, s12, 1536
  s_add_u32 s58, s58, 100864
  v_lshl_add_u32 v49, v1, 3, s58
  v_pk_fma_f32 v[64:65], v[64:65], s[54:55], v[24:25]
  v_pk_fma_f32 v[66:67], v[66:67], s[54:55], v[26:27]
  v_pk_fma_f32 v[68:69], v[68:69], s[54:55], v[20:21]
  v_pk_fma_f32 v[70:71], v[70:71], s[54:55], v[22:23]
  v_pk_fma_f32 v[72:73], v[72:73], s[54:55], v[24:25]
  v_pk_fma_f32 v[74:75], v[74:75], s[54:55], v[26:27]
  v_pk_fma_f32 v[76:77], v[76:77], s[54:55], v[20:21]
  v_pk_fma_f32 v[78:79], v[78:79], s[54:55], v[22:23]
  v_max3_f32 v80, v64, v65, v66
  v_max3_f32 v84, v67, v68, v69
  v_max3_f32 v82, v72, v73, v74
  v_max3_f32 v85, v75, v76, v77
  v_max3_f32 v80, v80, v70, v71
  v_max3_f32 v82, v82, v78, v79
  v_max_f32 v80, v80, v84
  v_max_f32 v82, v82, v85
  s_nop 1
  v_permlane32_swap_b32 v80, v82
  v_max_f32 v80, v80, v82
  v_mov_b32 v82, v80
  s_nop 1
  v_permlane16_swap_b32 v80, v82
  v_max_f32 v80, v80, v82
  v_mov_b32 v82, v80
  s_nop 1
  v_permlane32_swap_b32 v80, v82
  v_pk_add_f32 v[64:65], v[64:65], v[80:81] op_sel_hi:[1,0] neg_lo:[0,1] neg_hi:[0,1]
  v_pk_add_f32 v[66:67], v[66:67], v[80:81] op_sel_hi:[1,0] neg_lo:[0,1] neg_hi:[0,1]
  v_pk_add_f32 v[68:69], v[68:69], v[80:81] op_sel_hi:[1,0] neg_lo:[0,1] neg_hi:[0,1]
  v_pk_add_f32 v[70:71], v[70:71], v[80:81] op_sel_hi:[1,0] neg_lo:[0,1] neg_hi:[0,1]
  v_pk_add_f32 v[72:73], v[72:73], v[82:83] op_sel_hi:[1,0] neg_lo:[0,1] neg_hi:[0,1]
  v_pk_add_f32 v[74:75], v[74:75], v[82:83] op_sel_hi:[1,0] neg_lo:[0,1] neg_hi:[0,1]
  v_pk_add_f32 v[76:77], v[76:77], v[82:83] op_sel_hi:[1,0] neg_lo:[0,1] neg_hi:[0,1]
  v_pk_add_f32 v[78:79], v[78:79], v[82:83] op_sel_hi:[1,0] neg_lo:[0,1] neg_hi:[0,1]
  v_exp_f32 v64, v64
  v_exp_f32 v65, v65
  v_exp_f32 v66, v66
  v_exp_f32 v67, v67
  v_exp_f32 v68, v68
  v_exp_f32 v69, v69
  v_exp_f32 v70, v70
  v_exp_f32 v71, v71
  v_exp_f32 v72, v72
  v_exp_f32 v73, v73
  v_exp_f32 v74, v74
  v_exp_f32 v75, v75
  v_exp_f32 v76, v76
  v_exp_f32 v77, v77
  v_exp_f32 v78, v78
  v_exp_f32 v79, v79
  v_cvt_pk_bf16_f32 v88, v64, v65
  v_cvt_pk_bf16_f32 v89, v66, v67
  v_cvt_pk_bf16_f32 v90, v68, v69
  v_cvt_pk_bf16_f32 v91, v70, v71
  v_cvt_pk_bf16_f32 v92, v72, v73
  v_cvt_pk_bf16_f32 v93, v74, v75
  v_cvt_pk_bf16_f32 v94, v76, v77
  v_cvt_pk_bf16_f32 v95, v78, v79
  v_mul_f32_dpp v108, v34, v108 row_newbcast:4 row_mask:0xf bank_mask:0xf
  v_mul_f32_dpp v109, v34, v109 row_newbcast:5 row_mask:0xf bank_mask:0xf
  v_mul_f32_dpp v110, v34, v110 row_newbcast:6 row_mask:0xf bank_mask:0xf
  v_mul_f32_dpp v111, v34, v111 row_newbcast:7 row_mask:0xf bank_mask:0xf
  v_mul_f32_dpp v116, v34, v116 row_newbcast:4 row_mask:0xf bank_mask:0xf
  v_mul_f32_dpp v117, v34, v117 row_newbcast:5 row_mask:0xf bank_mask:0xf
  v_mul_f32_dpp v118, v34, v118 row_newbcast:6 row_mask:0xf bank_mask:0xf
  v_mul_f32_dpp v119, v34, v119 row_newbcast:7 row_mask:0xf bank_mask:0xf
  v_mul_f32_dpp v124, v34, v124 row_newbcast:4 row_mask:0xf bank_mask:0xf
  v_mul_f32_dpp v125, v34, v125 row_newbcast:5 row_mask:0xf bank_mask:0xf
  v_mul_f32_dpp v126, v34, v126 row_newbcast:6 row_mask:0xf bank_mask:0xf
  v_mul_f32_dpp v127, v34, v127 row_newbcast:7 row_mask:0xf bank_mask:0xf
  v_mul_f32_dpp v104, v34, v104 row_newbcast:0 row_mask:0xf bank_mask:0xf
  v_mul_f32_dpp v105, v34, v105 row_newbcast:1 row_mask:0xf bank_mask:0xf
  v_mul_f32_dpp v106, v34, v106 row_newbcast:2 row_mask:0xf bank_mask:0xf
  v_mul_f32_dpp v107, v34, v107 row_newbcast:3 row_mask:0xf bank_mask:0xf
  v_mul_f32_dpp v112, v34, v112 row_newbcast:0 row_mask:0xf bank_mask:0xf
  v_mul_f32_dpp v113, v34, v113 row_newbcast:1 row_mask:0xf bank_mask:0xf
  v_mul_f32_dpp v114, v34, v114 row_newbcast:2 row_mask:0xf bank_mask:0xf
  v_mul_f32_dpp v115, v34, v115 row_newbcast:3 row_mask:0xf bank_mask:0xf
  v_mul_f32_dpp v120, v34, v120 row_newbcast:0 row_mask:0xf bank_mask:0xf
  v_mul_f32_dpp v121, v34, v121 row_newbcast:1 row_mask:0xf bank_mask:0xf
  v_mul_f32_dpp v122, v34, v122 row_newbcast:2 row_mask:0xf bank_mask:0xf
  v_mul_f32_dpp v123, v34, v123 row_newbcast:3 row_mask:0xf bank_mask:0xf
  v_cvt_pk_bf16_f32 v204, v108, v109
  v_cvt_pk_bf16_f32 v205, v110, v111
  v_cvt_pk_bf16_f32 v210, v116, v117
  v_cvt_pk_bf16_f32 v211, v118, v119
  v_cvt_pk_bf16_f32 v216, v124, v125
  v_cvt_pk_bf16_f32 v217, v126, v127
  v_cndmask_b32 v216, v216, v51, s[50:51]
  v_cndmask_b32 v217, v217, v51, s[50:51]
  ds_write_b64 v49, v[204:205] offset:1536
  ds_write_b64 v49, v[210:211] offset:2048
  ds_write_b64 v49, v[216:217] offset:2560
  v_cvt_pk_bf16_f32 v202, v104, v105
  v_cvt_pk_bf16_f32 v203, v106, v107
  v_cvt_pk_bf16_f32 v208, v112, v113
  v_cvt_pk_bf16_f32 v209, v114, v115
  v_cvt_pk_bf16_f32 v214, v120, v121
  v_cvt_pk_bf16_f32 v215, v122, v123
  v_cndmask_b32 v214, v214, v51, s[50:51]
  v_cndmask_b32 v215, v215, v51, s[50:51]
  s_waitcnt lgkmcnt(0)
  s_barrier
  ds_read_b64 v[200:201], v49 offset:0
  ds_read_b64 v[206:207], v49 offset:512
  ds_read_b64 v[212:213], v49 offset:1024
  v_mfma_f32_16x16x32_bf16 v[72:75], v[214:217], v[96:99], 0
  v_mfma_f32_16x16x32_bf16 v[76:79], v[214:217], v[100:103], 0
  v_mfma_f32_16x16x32_bf16 v[64:67], v[202:205], v[96:99], 0
  v_mfma_f32_16x16x32_bf16 v[68:71], v[208:211], v[100:103], 0
  s_waitcnt lgkmcnt(0)
  v_mfma_f32_16x16x32_bf16 v[124:127], v[212:215], v[88:91], 0
  v_mfma_f32_16x16x32_bf16 v[128:131], v[212:215], v[92:95], 0
  v_mfma_f32_16x16x32_bf16 v[116:119], v[200:203], v[88:91], 0
  v_mfma_f32_16x16x32_bf16 v[120:123], v[206:209], v[92:95], 0
  v_rcp_f32 v104, v72
  v_rcp_f32 v106, v76
  v_cndmask_b32 v74, v78, v74, s[48:49]
  v_cndmask_b32 v75, v79, v75, s[48:49]
  v_pk_mul_f32 v[64:65], v[64:65], v[104:105] op_sel_hi:[1,0]
  v_pk_mul_f32 v[66:67], v[66:67], v[104:105] op_sel_hi:[1,0]
  v_pk_mul_f32 v[68:69], v[68:69], v[106:107] op_sel_hi:[1,0]
  v_pk_mul_f32 v[70:71], v[70:71], v[106:107] op_sel_hi:[1,0]
  v_cndmask_b32 v104, v106, v104, s[48:49]
  v_cvt_pk_bf16_f32 v108, v64, v65
  v_cvt_pk_bf16_f32 v109, v66, v67
  v_cvt_pk_bf16_f32 v110, v68, v69
  v_cvt_pk_bf16_f32 v111, v70, v71
  v_pk_mul_f32 v[74:75], v[74:75], v[104:105] op_sel_hi:[1,0]
  buffer_store_dwordx4 v[108:111], v2, s[4:7], s45 offen sc1
  v_cvt_pk_bf16_f32 v112, v74, v75
  buffer_store_dword v112, v14, s[4:7], s47 offen sc1
  v_rcp_f32 v132, v124
  v_rcp_f32 v134, v128
  v_cndmask_b32 v126, v130, v126, s[48:49]
  v_cndmask_b32 v127, v131, v127, s[48:49]
  v_pk_mul_f32 v[116:117], v[116:117], v[132:133] op_sel_hi:[1,0]
  v_pk_mul_f32 v[118:119], v[118:119], v[132:133] op_sel_hi:[1,0]
  v_pk_mul_f32 v[120:121], v[120:121], v[134:135] op_sel_hi:[1,0]
  v_pk_mul_f32 v[122:123], v[122:123], v[134:135] op_sel_hi:[1,0]
  v_cndmask_b32 v132, v134, v132, s[48:49]
  v_cvt_pk_bf16_f32 v136, v116, v117
  v_cvt_pk_bf16_f32 v137, v118, v119
  v_cvt_pk_bf16_f32 v138, v120, v121
  v_cvt_pk_bf16_f32 v139, v122, v123
  v_pk_mul_f32 v[126:127], v[126:127], v[132:133] op_sel_hi:[1,0]
  buffer_store_dwordx4 v[136:139], v2, s[4:7], s44 offen sc1
  v_cvt_pk_bf16_f32 v140, v126, v127
  buffer_store_dword v140, v14, s[4:7], s46 offen sc1
  s_branch p_body
.p2align 6
qb_body:
  s_mul_i32 s26, s14, 164864
  s_add_u32 s27, s26, s20
  s_add_u32 s26, s26, s19
  s_cmp_eq_u32 s12, 0
  s_cbranch_scc1 w0_17
  s_sub_u32 s91, s12, 1
  s_mul_i32 s91, s91, 8192
  s_add_u32 s92, s91, s26
  s_add_u32 m0, s91, 98304
  s_add_u32 s90, s92, 98304
  buffer_load_dwordx4 v2, s[4:7], s90 offen offset:0 sc1 lds
  buffer_load_dwordx4 v2, s[4:7], s90 offen offset:1024 sc1 lds
  buffer_load_dwordx4 v2, s[4:7], s90 offen offset:2048 sc1 lds
  buffer_load_dwordx4 v2, s[4:7], s90 offen offset:3072 sc1 lds
  s_add_u32 m0, s91, 102400
  s_add_u32 s90, s92, 102400
  buffer_load_dwordx4 v2, s[4:7], s90 offen offset:0 sc1 lds
  buffer_load_dwordx4 v2, s[4:7], s90 offen offset:1024 sc1 lds
  buffer_load_dwordx4 v2, s[4:7], s90 offen offset:2048 sc1 lds
  buffer_load_dwordx4 v2, s[4:7], s90 offen offset:3072 sc1 lds
  s_waitcnt vmcnt(8)
  s_branch jn_18
w0_17:
  s_lshl_b32 s29, s13, 3
  s_lshl_b32 s30, s12, 1
  s_add_u32 s28, s30, s29
  s_mul_i32 s30, s28, 21504
  s_add_u32 s30, s30, s16
  v_add_u32 v5, 21504, v2
  v_mov_b32 v6, v2
  v_add_u32 v7, 107520, v2
  v_lshrrev_b32 v12, 2, v3
  v_lshlrev_b32 v12, 1, v12
  v_and_b32 v13, 1, v3
  v_add_u32 v12, v12, v13
  v_lshl_add_u32 v12, v4, 3, v12
  v_lshlrev_b32 v12, 4, v12
  v_add_u32 v8, 109568, v12
  s_lshl_b32 s37, s28, 10
  s_add_u32 s37, s37, s17
  v_lshrrev_b32 v12, 2, v3
  v_lshlrev_b32 v48, 10, v12
  v_lshl_add_u32 v48, v4, 6, v48
  v_and_b32 v13, 3, v3
  v_lshl_add_u32 v48, v13, 4, v48
  v_lshlrev_b32 v35, 6, v12
  v_lshl_add_u32 v35, v13, 2, v35
  v_add_u32 v49, 4096, v0
  s_lshl_b32 s38, s15, 4
  s_add_u32 s38, s38, s13
  s_lshl_b32 s38, s38, 12
  s_add_u32 s38, s38, 31977472
  v_and_b32 v48, 0x4f0, v48
  s_lshr_b32 s60, s14, 1
  s_mul_i32 s60, s60, 103424
  s_mul_i32 s61, s12, 25600
  s_add_u32 s61, s61, s60
  s_add_u32 s61, s61, s21
  v_add_u32 v50, 4096, v2
  v_mov_b32 v51, 1065369472
  s_mul_i32 s44, s28, 21504
  s_add_u32 s44, s44, s18
  s_lshr_b32 s46, s14, 2
  s_add_u32 s46, s46, 16
  s_lshl_b32 s46, s46, 10
  s_and_b32 s47, s14, 3
  s_lshl_b32 s47, s47, 8
  s_add_u32 s46, s46, s47
  s_add_u32 s46, s46, s44
  s_add_u32 s47, s46, 21504
  s_lshl_b32 s45, s14, 10
  s_add_u32 s44, s44, s45
  s_add_u32 s45, s44, 21504
  v_lshlrev_b32 v14, 4, v3
  v_lshl_add_u32 v14, v4, 2, v14
  s_mov_b32 s48, -1
  s_mov_b32 s49, 0
  s_mov_b32 s50, 0x33333333
  s_mov_b32 s51, 0x33333333
  s_lshl_b32 s42, s15, 4
  s_add_u32 s42, s42, s13
  s_lshl_b32 s42, s42, 12
  s_add_u32 s99, s42, 31719424
  v_accvgpr_read_b32 v16, a204
  v_accvgpr_read_b32 v17, a205
  v_accvgpr_read_b32 v18, a206
  v_accvgpr_read_b32 v19, a207
  v_accvgpr_read_b32 v20, a208
  v_accvgpr_read_b32 v21, a209
  v_accvgpr_read_b32 v22, a210
  v_accvgpr_read_b32 v23, a211
  v_subrev_u32 v8, 2048, v8
  v_add_u32 v9, 118272, v2
  s_lshl_b32 s55, s14, 4
  s_mul_i32 s55, s55, 3584
  s_add_u32 s55, s55, s22
  s_mul_i32 s52, s13, 3584
  s_add_u32 s52, s52, s55
  s_lshr_b32 s54, s15, 1
  s_lshl_b32 s54, s54, 4
  s_add_u32 s54, s54, s14
  s_lshl_b32 s54, s54, 12
  s_add_u32 s54, s54, 32243712
  s_cmp_eq_u32 s15, 3
  s_cselect_b32 s27, 1879048192, s27
  s_and_b32 s62, s14, 7
  s_lshl_b32 s62, s62, 8
  v_mov_b32 v12, s62
  v_mov_b32 v13, 1
  s_mov_b32 s62, 0
dr_19:
  s_waitcnt vmcnt(0)
jn_18:
  s_cmp_eq_u32 s12, 0
  s_waitcnt lgkmcnt(0)
  s_barrier
  s_cbranch_scc0 nosig_16
  s_mov_b64 exec, 1
  buffer_atomic_add v13, v12, s[4:7], s98 offen sc0 sc1
  s_waitcnt vmcnt(0)
  v_readfirstlane_b32 s63, v13
  s_mov_b64 exec, -1
  s_mov_b64 exec, -1
nosig_16:
  s_cmp_eq_u32 s12, 0
  s_cbranch_scc0 side_15
poll_13:
  buffer_load_dword v240, v49, s[4:7], s38 offen sc1
  s_add_u32 s62, s62, 1
  s_waitcnt vmcnt(0)
  v_cmp_gt_u32 vcc, 2, v240
  s_cmp_lt_u32 s62, 0x20000
  s_cselect_b64 vcc, vcc, 0
  s_nop 4
  s_cbranch_vccnz poll_13
  s_branch seen_14
side_15:
  s_lshl_b32 s29, s13, 3
  s_lshl_b32 s30, s12, 1
  s_add_u32 s28, s30, s29
  s_mul_i32 s30, s28, 21504
  s_add_u32 s30, s30, s16
  v_add_u32 v5, 21504, v2
  v_mov_b32 v6, v2
  v_add_u32 v7, 107520, v2
  v_lshrrev_b32 v12, 2, v3
  v_lshlrev_b32 v12, 1, v12
  v_and_b32 v13, 1, v3
  v_add_u32 v12, v12, v13
  v_lshl_add_u32 v12, v4, 3, v12
  v_lshlrev_b32 v12, 4, v12
  v_add_u32 v8, 109568, v12
  s_lshl_b32 s37, s28, 10
  s_add_u32 s37, s37, s17
  v_lshrrev_b32 v12, 2, v3
  v_lshlrev_b32 v48, 10, v12
  v_lshl_add_u32 v48, v4, 6, v48
  v_and_b32 v13, 3, v3
  v_lshl_add_u32 v48, v13, 4, v48
  v_lshlrev_b32 v35, 6, v12
  v_lshl_add_u32 v35, v13, 2, v35
  v_add_u32 v49, 4096, v0
  s_lshl_b32 s38, s15, 4
  s_add_u32 s38, s38, s13
  s_lshl_b32 s38, s38, 12
  s_add_u32 s38, s38, 31977472
  v_and_b32 v48, 0x4f0, v48
  s_lshr_b32 s60, s14, 1
  s_mul_i32 s60, s60, 103424
  s_mul_i32 s61, s12, 25600
  s_add_u32 s61, s61, s60
  s_add_u32 s61, s61, s21
  v_add_u32 v50, 4096, v2
  v_mov_b32 v51, 1065369472
  s_mul_i32 s44, s28, 21504
  s_add_u32 s44, s44, s18
  s_lshr_b32 s46, s14, 2
  s_add_u32 s46, s46, 16
  s_lshl_b32 s46, s46, 10
  s_and_b32 s47, s14, 3
  s_lshl_b32 s47, s47, 8
  s_add_u32 s46, s46, s47
  s_add_u32 s46, s46, s44
  s_add_u32 s47, s46, 21504
  s_lshl_b32 s45, s14, 10
  s_add_u32 s44, s44, s45
  s_add_u32 s45, s44, 21504
  v_lshlrev_b32 v14, 4, v3
  v_lshl_add_u32 v14, v4, 2, v14
  s_mov_b32 s48, -1
  s_mov_b32 s49, 0
  s_mov_b32 s50, 0x33333333
  s_mov_b32 s51, 0x33333333
  s_lshl_b32 s42, s15, 4
  s_add_u32 s42, s42, s13
  s_lshl_b32 s42, s42, 12
  s_add_u32 s99, s42, 31719424
  v_accvgpr_read_b32 v16, a204
  v_accvgpr_read_b32 v17, a205
  v_accvgpr_read_b32 v18, a206
  v_accvgpr_read_b32 v19, a207
  v_accvgpr_read_b32 v20, a208
  v_accvgpr_read_b32 v21, a209
  v_accvgpr_read_b32 v22, a210
  v_accvgpr_read_b32 v23, a211
  v_subrev_u32 v8, 2048, v8
  v_add_u32 v9, 118272, v2
  s_lshl_b32 s55, s14, 4
  s_mul_i32 s55, s55, 3584
  s_add_u32 s55, s55, s22
  s_mul_i32 s52, s13, 3584
  s_add_u32 s52, s52, s55
  s_lshr_b32 s54, s15, 1
  s_lshl_b32 s54, s54, 4
  s_add_u32 s54, s54, s14
  s_lshl_b32 s54, s54, 12
  s_add_u32 s54, s54, 32243712
  s_cmp_eq_u32 s15, 3
  s_cselect_b32 s27, 1879048192, s27
seen_14:
  s_barrier
  ds_read_b128 v[140:143], v6 offset:0
  ds_read_b128 v[144:147], v6 offset:1024
  ds_read_b128 v[148:151], v6 offset:2048
  ds_read_b128 v[152:155], v6 offset:3072
  ds_read_b128 v[156:159], v6 offset:4096
  ds_read_b128 v[160:163], v6 offset:5120
  ds_read_b128 v[164:167], v6 offset:6144
  ds_read_b128 v[168:171], v6 offset:7168
  ds_read_b128 v[172:175], v6 offset:8192
  ds_read_b128 v[176:179], v6 offset:9216
  s_add_u32 s34, s30, 0
  buffer_load_dwordx4 a[0:3], v2, s[4:7], s34 offen offset:0 sc1
  s_nop 11
  buffer_load_dwordx4 a[4:7], v5, s[4:7], s34 offen offset:0 sc1
  s_nop 11
  buffer_load_dwordx4 a[8:11], v2, s[4:7], s34 offen offset:1024 sc1
  s_nop 11
  buffer_load_dwordx4 a[12:15], v5, s[4:7], s34 offen offset:1024 sc1
  s_nop 11
  buffer_load_dwordx4 a[16:19], v2, s[4:7], s34 offen offset:2048 sc1
  s_nop 11
  buffer_load_dwordx4 a[20:23], v5, s[4:7], s34 offen offset:2048 sc1
  s_nop 11
  buffer_load_dwordx4 a[24:27], v2, s[4:7], s34 offen offset:3072 sc1
  s_nop 11
  buffer_load_dwordx4 a[28:31], v5, s[4:7], s34 offen offset:3072 sc1
  s_nop 11
  s_add_u32 s34, s30, 4096
  buffer_load_dwordx4 a[32:35], v2, s[4:7], s34 offen offset:0 sc1
  s_nop 11
  buffer_load_dwordx4 a[36:39], v5, s[4:7], s34 offen offset:0 sc1
  s_nop 11
  buffer_load_dwordx4 a[40:43], v2, s[4:7], s34 offen offset:1024 sc1
  s_nop 11
  buffer_load_dwordx4 a[44:47], v5, s[4:7], s34 offen offset:1024 sc1
  s_nop 11
  s_waitcnt vmcnt(10) lgkmcnt(5)
  v_mfma_f32_16x16x32_bf16 v[64:67], v[140:143], a[0:3], 0
  ds_read_b128 v[180:183], v6 offset:10240
  v_mfma_f32_16x16x32_bf16 v[68:71], v[140:143], a[4:7], 0
  ds_read_b128 v[184:187], v6 offset:11264
  v_mfma_f32_16x16x32_bf16 v[72:75], v[144:147], a[0:3], 0
  ds_read_b128 v[188:191], v6 offset:12288
  v_mfma_f32_16x16x32_bf16 v[76:79], v[144:147], a[4:7], 0
  ds_read_b128 v[192:195], v6 offset:13312
  v_mfma_f32_16x16x32_bf16 v[80:83], v[148:151], a[0:3], 0
  ds_read_b128 v[196:199], v6 offset:14336
  v_mfma_f32_16x16x32_bf16 v[84:87], v[148:151], a[4:7], 0
  buffer_load_dwordx4 a[48:51], v2, s[4:7], s34 offen offset:2048 sc1
  v_mfma_f32_16x16x32_bf16 v[104:107], a[0:3], v[152:155], 0
  buffer_load_dwordx4 a[52:55], v5, s[4:7], s34 offen offset:2048 sc1
  v_mfma_f32_16x16x32_bf16 v[108:111], a[4:7], v[152:155], 0
  buffer_load_dwordx4 v[224:227], v48, s[4:7], s37 offen offset:0 sc1
  v_mfma_f32_16x16x32_bf16 v[112:115], a[0:3], v[156:159], 0
  v_mfma_f32_16x16x32_bf16 v[116:119], a[4:7], v[156:159], 0
  s_waitcnt vmcnt(11) lgkmcnt(5)
  v_mfma_f32_16x16x32_bf16 v[64:67], v[160:163], a[8:11], v[64:67]
  ds_read_b128 v[140:143], v6 offset:15360
  v_mfma_f32_16x16x32_bf16 v[68:71], v[160:163], a[12:15], v[68:71]
  ds_read_b128 v[144:147], v6 offset:16384
  v_mfma_f32_16x16x32_bf16 v[72:75], v[164:167], a[8:11], v[72:75]
  ds_read_b128 v[148:151], v6 offset:17408
  v_mfma_f32_16x16x32_bf16 v[76:79], v[164:167], a[12:15], v[76:79]
  ds_read_b128 v[152:155], v6 offset:18432
  v_mfma_f32_16x16x32_bf16 v[80:83], v[168:171], a[8:11], v[80:83]
  ds_read_b128 v[156:159], v6 offset:19456
  v_mfma_f32_16x16x32_bf16 v[84:87], v[168:171], a[12:15], v[84:87]
  buffer_load_dwordx4 a[56:59], v2, s[4:7], s34 offen offset:3072 sc1
  v_mfma_f32_16x16x32_bf16 v[104:107], a[8:11], v[172:175], v[104:107]
  buffer_load_dwordx4 a[60:63], v5, s[4:7], s34 offen offset:3072 sc1
  v_mfma_f32_16x16x32_bf16 v[108:111], a[12:15], v[172:175], v[108:111]
  buffer_load_dwordx4 v[228:231], v48, s[4:7], s37 offen offset:256 sc1
  v_mfma_f32_16x16x32_bf16 v[112:115], a[8:11], v[176:179], v[112:115]
  v_mfma_f32_16x16x32_bf16 v[116:119], a[12:15], v[176:179], v[116:119]
  s_waitcnt vmcnt(12) lgkmcnt(5)
  v_mfma_f32_16x16x32_bf16 v[64:67], v[180:183], a[16:19], v[64:67]
  ds_read_b128 v[160:163], v6 offset:20480
  v_mfma_f32_16x16x32_bf16 v[68:71], v[180:183], a[20:23], v[68:71]
  ds_read_b128 v[164:167], v6 offset:21504
  v_mfma_f32_16x16x32_bf16 v[72:75], v[184:187], a[16:19], v[72:75]
  ds_read_b128 v[168:171], v6 offset:22528
  v_mfma_f32_16x16x32_bf16 v[76:79], v[184:187], a[20:23], v[76:79]
  ds_read_b128 v[172:175], v6 offset:23552
  v_mfma_f32_16x16x32_bf16 v[80:83], v[188:191], a[16:19], v[80:83]
  ds_read_b128 v[176:179], v6 offset:24576
  v_mfma_f32_16x16x32_bf16 v[84:87], v[188:191], a[20:23], v[84:87]
  s_add_u32 s34, s30, 8192
  buffer_load_dwordx4 a[64:67], v2, s[4:7], s34 offen offset:0 sc1
  v_mfma_f32_16x16x32_bf16 v[104:107], a[16:19], v[192:195], v[104:107]
  buffer_load_dwordx4 a[68:71], v5, s[4:7], s34 offen offset:0 sc1
  v_mfma_f32_16x16x32_bf16 v[108:111], a[20:23], v[192:195], v[108:111]
  buffer_load_dwordx4 v[232:235], v48, s[4:7], s37 offen offset:512 sc1
  v_mfma_f32_16x16x32_bf16 v[112:115], a[16:19], v[196:199], v[112:115]
  v_mfma_f32_16x16x32_bf16 v[116:119], a[20:23], v[196:199], v[116:119]
  s_waitcnt vmcnt(13) lgkmcnt(5)
  v_mfma_f32_16x16x32_bf16 v[64:67], v[140:143], a[24:27], v[64:67]
  ds_read_b128 v[180:183], v6 offset:25600
  v_mfma_f32_16x16x32_bf16 v[68:71], v[140:143], a[28:31], v[68:71]
  ds_read_b128 v[184:187], v6 offset:26624
  v_mfma_f32_16x16x32_bf16 v[72:75], v[144:147], a[24:27], v[72:75]
  ds_read_b128 v[188:191], v6 offset:27648
  v_mfma_f32_16x16x32_bf16 v[76:79], v[144:147], a[28:31], v[76:79]
  ds_read_b128 v[192:195], v6 offset:28672
  v_mfma_f32_16x16x32_bf16 v[80:83], v[148:151], a[24:27], v[80:83]
  ds_read_b128 v[196:199], v6 offset:29696
  v_mfma_f32_16x16x32_bf16 v[84:87], v[148:151], a[28:31], v[84:87]
  buffer_load_dwordx4 a[72:75], v2, s[4:7], s34 offen offset:1024 sc1
  v_mfma_f32_16x16x32_bf16 v[104:107], a[24:27], v[152:155], v[104:107]
  buffer_load_dwordx4 a[76:79], v5, s[4:7], s34 offen offset:1024 sc1
  v_mfma_f32_16x16x32_bf16 v[108:111], a[28:31], v[152:155], v[108:111]
  buffer_load_dwordx4 v[236:239], v48, s[4:7], s37 offen offset:768 sc1
  v_mfma_f32_16x16x32_bf16 v[112:115], a[24:27], v[156:159], v[112:115]
  v_mfma_f32_16x16x32_bf16 v[116:119], a[28:31], v[156:159], v[116:119]
  s_waitcnt vmcnt(14) lgkmcnt(5)
  v_mfma_f32_16x16x32_bf16 v[64:67], v[160:163], a[32:35], v[64:67]
  ds_read_b128 v[140:143], v6 offset:30720
  v_mfma_f32_16x16x32_bf16 v[68:71], v[160:163], a[36:39], v[68:71]
  ds_read_b128 v[144:147], v6 offset:31744
  v_mfma_f32_16x16x32_bf16 v[72:75], v[164:167], a[32:35], v[72:75]
  ds_read_b128 v[148:151], v6 offset:32768
  v_mfma_f32_16x16x32_bf16 v[76:79], v[164:167], a[36:39], v[76:79]
  ds_read_b128 v[152:155], v6 offset:33792
  v_mfma_f32_16x16x32_bf16 v[80:83], v[168:171], a[32:35], v[80:83]
  ds_read_b128 v[156:159], v6 offset:34816
  v_mfma_f32_16x16x32_bf16 v[84:87], v[168:171], a[36:39], v[84:87]
  buffer_load_dwordx4 a[80:83], v2, s[4:7], s34 offen offset:2048 sc1
  v_mfma_f32_16x16x32_bf16 v[104:107], a[32:35], v[172:175], v[104:107]
  buffer_load_dwordx4 a[84:87], v5, s[4:7], s34 offen offset:2048 sc1
  v_mfma_f32_16x16x32_bf16 v[108:111], a[36:39], v[172:175], v[108:111]
  v_mfma_f32_16x16x32_bf16 v[112:115], a[32:35], v[176:179], v[112:115]
  v_mfma_f32_16x16x32_bf16 v[116:119], a[36:39], v[176:179], v[116:119]
  s_waitcnt vmcnt(14) lgkmcnt(5)
  v_mfma_f32_16x16x32_bf16 v[64:67], v[180:183], a[40:43], v[64:67]
  ds_read_b128 v[160:163], v6 offset:35840
  v_mfma_f32_16x16x32_bf16 v[68:71], v[180:183], a[44:47], v[68:71]
  ds_read_b128 v[164:167], v6 offset:36864
  v_mfma_f32_16x16x32_bf16 v[72:75], v[184:187], a[40:43], v[72:75]
  ds_read_b128 v[168:171], v6 offset:37888
  v_mfma_f32_16x16x32_bf16 v[76:79], v[184:187], a[44:47], v[76:79]
  ds_read_b128 v[172:175], v6 offset:38912
  v_mfma_f32_16x16x32_bf16 v[80:83], v[188:191], a[40:43], v[80:83]
  ds_read_b128 v[176:179], v6 offset:39936
  v_mfma_f32_16x16x32_bf16 v[84:87], v[188:191], a[44:47], v[84:87]
  buffer_load_dwordx4 a[88:91], v2, s[4:7], s34 offen offset:3072 sc1
  v_mfma_f32_16x16x32_bf16 v[104:107], a[40:43], v[192:195], v[104:107]
  buffer_load_dwordx4 a[92:95], v5, s[4:7], s34 offen offset:3072 sc1
  v_mfma_f32_16x16x32_bf16 v[108:111], a[44:47], v[192:195], v[108:111]
  v_mfma_f32_16x16x32_bf16 v[112:115], a[40:43], v[196:199], v[112:115]
  v_mfma_f32_16x16x32_bf16 v[116:119], a[44:47], v[196:199], v[116:119]
  s_waitcnt vmcnt(14) lgkmcnt(5)
  v_mfma_f32_16x16x32_bf16 v[64:67], v[140:143], a[48:51], v[64:67]
  ds_read_b128 v[180:183], v6 offset:40960
  v_mfma_f32_16x16x32_bf16 v[68:71], v[140:143], a[52:55], v[68:71]
  ds_read_b128 v[184:187], v6 offset:41984
  v_mfma_f32_16x16x32_bf16 v[72:75], v[144:147], a[48:51], v[72:75]
  ds_read_b128 v[188:191], v6 offset:43008
  v_mfma_f32_16x16x32_bf16 v[76:79], v[144:147], a[52:55], v[76:79]
  ds_read_b128 v[192:195], v6 offset:44032
  v_mfma_f32_16x16x32_bf16 v[80:83], v[148:151], a[48:51], v[80:83]
  ds_read_b128 v[196:199], v6 offset:45056
  v_mfma_f32_16x16x32_bf16 v[84:87], v[148:151], a[52:55], v[84:87]
  s_add_u32 s34, s30, 12288
  buffer_load_dwordx4 a[96:99], v2, s[4:7], s34 offen offset:0 sc1
  v_mfma_f32_16x16x32_bf16 v[104:107], a[48:51], v[152:155], v[104:107]
  buffer_load_dwordx4 a[100:103], v5, s[4:7], s34 offen offset:0 sc1
  v_mfma_f32_16x16x32_bf16 v[108:111], a[52:55], v[152:155], v[108:111]
  v_mfma_f32_16x16x32_bf16 v[112:115], a[48:51], v[156:159], v[112:115]
  v_mfma_f32_16x16x32_bf16 v[116:119], a[52:55], v[156:159], v[116:119]
  s_waitcnt vmcnt(13) lgkmcnt(5)
  v_mfma_f32_16x16x32_bf16 v[64:67], v[160:163], a[56:59], v[64:67]
  ds_read_b128 v[140:143], v6 offset:46080
  v_mfma_f32_16x16x32_bf16 v[68:71], v[160:163], a[60:63], v[68:71]
  ds_read_b128 v[144:147], v6 offset:47104
  v_mfma_f32_16x16x32_bf16 v[72:75], v[164:167], a[56:59], v[72:75]
  ds_read_b128 v[148:151], v6 offset:48128
  v_mfma_f32_16x16x32_bf16 v[76:79], v[164:167], a[60:63], v[76:79]
  ds_read_b128 v[152:155], v6 offset:49152
  v_mfma_f32_16x16x32_bf16 v[80:83], v[168:171], a[56:59], v[80:83]
  ds_read_b128 v[156:159], v6 offset:50176
  v_mfma_f32_16x16x32_bf16 v[84:87], v[168:171], a[60:63], v[84:87]
  buffer_load_dwordx4 a[104:107], v2, s[4:7], s34 offen offset:1024 sc1
  v_mfma_f32_16x16x32_bf16 v[104:107], a[56:59], v[172:175], v[104:107]
  buffer_load_dwordx4 a[108:111], v5, s[4:7], s34 offen offset:1024 sc1
  v_mfma_f32_16x16x32_bf16 v[108:111], a[60:63], v[172:175], v[108:111]
  v_mfma_f32_16x16x32_bf16 v[112:115], a[56:59], v[176:179], v[112:115]
  v_mfma_f32_16x16x32_bf16 v[116:119], a[60:63], v[176:179], v[116:119]
  s_waitcnt vmcnt(12) lgkmcnt(5)
  v_mfma_f32_16x16x32_bf16 v[64:67], v[180:183], a[64:67], v[64:67]
  ds_read_b128 v[160:163], v6 offset:51200
  v_mfma_f32_16x16x32_bf16 v[68:71], v[180:183], a[68:71], v[68:71]
  ds_read_b128 v[164:167], v6 offset:52224
  v_mfma_f32_16x16x32_bf16 v[72:75], v[184:187], a[64:67], v[72:75]
  ds_read_b128 v[168:171], v6 offset:53248
  v_mfma_f32_16x16x32_bf16 v[76:79], v[184:187], a[68:71], v[76:79]
  ds_read_b128 v[172:175], v6 offset:54272
  v_mfma_f32_16x16x32_bf16 v[80:83], v[188:191], a[64:67], v[80:83]
  ds_read_b128 v[176:179], v6 offset:55296
  v_mfma_f32_16x16x32_bf16 v[84:87], v[188:191], a[68:71], v[84:87]
  buffer_load_dwordx4 a[112:115], v2, s[4:7], s34 offen offset:2048 sc1
  v_mfma_f32_16x16x32_bf16 v[104:107], a[64:67], v[192:195], v[104:107]
  buffer_load_dwordx4 a[116:119], v5, s[4:7], s34 offen offset:2048 sc1
  v_mfma_f32_16x16x32_bf16 v[108:111], a[68:71], v[192:195], v[108:111]
  v_mfma_f32_16x16x32_bf16 v[112:115], a[64:67], v[196:199], v[112:115]
  v_mfma_f32_16x16x32_bf16 v[116:119], a[68:71], v[196:199], v[116:119]
  s_waitcnt vmcnt(10)
  v_add_f32 v12, v224, v226
  v_add_f32 v13, v225, v227
  v_add_f32 v15, v228, v230
  s_waitcnt vmcnt(11) lgkmcnt(5)
  v_mfma_f32_16x16x32_bf16 v[64:67], v[140:143], a[72:75], v[64:67]
  v_add_f32 v34, v229, v231
  v_add_f32 v12, v12, v232
  ds_read_b128 v[180:183], v6 offset:56320
  v_mfma_f32_16x16x32_bf16 v[68:71], v[140:143], a[76:79], v[68:71]
  v_add_f32 v13, v13, v233
  ds_read_b128 v[184:187], v6 offset:57344
  v_mfma_f32_16x16x32_bf16 v[72:75], v[144:147], a[72:75], v[72:75]
  v_add_f32 v15, v15, v234
  ds_read_b128 v[188:191], v6 offset:58368
  v_mfma_f32_16x16x32_bf16 v[76:79], v[144:147], a[76:79], v[76:79]
  v_add_f32 v34, v34, v235
  ds_read_b128 v[192:195], v6 offset:59392
  v_mfma_f32_16x16x32_bf16 v[80:83], v[148:151], a[72:75], v[80:83]
  v_add_f32 v12, v12, v236
  ds_read_b128 v[196:199], v6 offset:60416
  v_mfma_f32_16x16x32_bf16 v[84:87], v[148:151], a[76:79], v[84:87]
  v_add_f32 v13, v13, v237
  buffer_load_dwordx4 a[120:123], v2, s[4:7], s34 offen offset:3072 sc1
  v_mfma_f32_16x16x32_bf16 v[104:107], a[72:75], v[152:155], v[104:107]
  v_add_f32 v15, v15, v238
  buffer_load_dwordx4 a[124:127], v5, s[4:7], s34 offen offset:3072 sc1
  v_mfma_f32_16x16x32_bf16 v[108:111], a[76:79], v[152:155], v[108:111]
  v_add_f32 v34, v34, v239
  v_mfma_f32_16x16x32_bf16 v[112:115], a[72:75], v[156:159], v[112:115]
  v_add_f32 v12, v12, v15
  v_add_f32 v13, v13, v34
  v_mfma_f32_16x16x32_bf16 v[116:119], a[76:79], v[156:159], v[116:119]
  v_mul_f32 v12, 986500301, v12
  v_mul_f32 v13, 986500301, v13
  s_waitcnt vmcnt(10) lgkmcnt(5)
  s_barrier
  v_mfma_f32_16x16x32_bf16 v[64:67], v[160:163], a[80:83], v[64:67]
  v_fma_f32 v13, -v12, v12, v13
  v_add_u32 v6, 61440, v6
  v_mfma_f32_16x16x32_bf16 v[68:71], v[160:163], a[84:87], v[68:71]
  v_cvt_pk_bf16_f32 v12, -v12, -v12
  ds_read_b128 v[140:143], v6 offset:0
  v_mfma_f32_16x16x32_bf16 v[72:75], v[164:167], a[80:83], v[72:75]
  v_max_f32 v13, 0, v13
  ds_read_b128 v[144:147], v6 offset:1024
  v_mfma_f32_16x16x32_bf16 v[76:79], v[164:167], a[84:87], v[76:79]
  ds_bpermute_b32 v36, v35, v12 offset:0
  ds_read_b128 v[148:151], v6 offset:2048
  v_mfma_f32_16x16x32_bf16 v[80:83], v[168:171], a[80:83], v[80:83]
  ds_bpermute_b32 v40, v35, v12 offset:16
  ds_read_b128 v[152:155], v6 offset:3072
  v_mfma_f32_16x16x32_bf16 v[84:87], v[168:171], a[84:87], v[84:87]
  v_cvt_pk_bf16_f32 v13, 0, v13
  ds_read_b128 v[156:159], v6 offset:4096
  v_mfma_f32_16x16x32_bf16 v[104:107], a[80:83], v[172:175], v[104:107]
  v_add_f32 v13, 925353388, v13
  s_add_u32 s34, s30, 16384
  buffer_load_dwordx4 a[128:131], v2, s[4:7], s34 offen offset:0 sc1
  v_mfma_f32_16x16x32_bf16 v[108:111], a[84:87], v[172:175], v[108:111]
  buffer_load_dwordx4 a[132:135], v5, s[4:7], s34 offen offset:0 sc1
  v_mfma_f32_16x16x32_bf16 v[112:115], a[80:83], v[176:179], v[112:115]
  v_cvt_pk_bf16_f32 v13, 0, v13
  v_mfma_f32_16x16x32_bf16 v[116:119], a[84:87], v[176:179], v[116:119]
  v_sqrt_f32 v13, v13
  s_waitcnt vmcnt(10) lgkmcnt(7)
  v_mfma_f32_16x16x32_bf16 v[64:67], v[180:183], a[88:91], v[64:67]
  v_cvt_pk_bf16_f32 v13, 0, v13
  v_rcp_f32 v34, v13
  ds_read_b128 v[160:163], v6 offset:5120
  v_mfma_f32_16x16x32_bf16 v[68:71], v[180:183], a[92:95], v[68:71]
  ds_read_b128 v[164:167], v6 offset:6144
  v_mfma_f32_16x16x32_bf16 v[72:75], v[184:187], a[88:91], v[72:75]
  ds_bpermute_b32 v28, v35, v34 offset:0
  ds_read_b128 v[168:171], v6 offset:7168
  v_mfma_f32_16x16x32_bf16 v[76:79], v[184:187], a[92:95], v[76:79]
  ds_bpermute_b32 v30, v35, v34 offset:16
  ds_read_b128 v[172:175], v6 offset:8192
  v_mfma_f32_16x16x32_bf16 v[80:83], v[188:191], a[88:91], v[80:83]
  ds_read_b128 v[176:179], v6 offset:9216
  v_mfma_f32_16x16x32_bf16 v[84:87], v[188:191], a[92:95], v[84:87]
  buffer_load_dwordx4 a[136:139], v2, s[4:7], s34 offen offset:1024 sc1
  v_mfma_f32_16x16x32_bf16 v[104:107], a[88:91], v[192:195], v[104:107]
  buffer_load_dwordx4 a[140:143], v5, s[4:7], s34 offen offset:1024 sc1
  v_mfma_f32_16x16x32_bf16 v[108:111], a[92:95], v[192:195], v[108:111]
  v_mfma_f32_16x16x32_bf16 v[112:115], a[88:91], v[196:199], v[112:115]
  v_mfma_f32_16x16x32_bf16 v[116:119], a[92:95], v[196:199], v[116:119]
  s_waitcnt lgkmcnt(2)
  v_mov_b32 v37, v36
  v_mov_b32 v41, v40
  v_mov_b64 v[38:39], v[36:37]
  s_waitcnt vmcnt(10) lgkmcnt(7)
  v_mfma_f32_16x16x32_bf16 v[64:67], v[140:143], a[96:99], v[64:67]
  v_mov_b64 v[42:43], v[40:41]
  ds_read_b128 v[180:183], v6 offset:10240
  v_mfma_f32_16x16x32_bf16 v[68:71], v[140:143], a[100:103], v[68:71]
  ds_read_b128 v[184:187], v6 offset:11264
  v_mfma_f32_16x16x32_bf16 v[72:75], v[144:147], a[96:99], v[72:75]
  ds_read_b128 v[188:191], v6 offset:12288
  v_mfma_f32_16x16x32_bf16 v[76:79], v[144:147], a[100:103], v[76:79]
  ds_read_b128 v[192:195], v6 offset:13312
  v_mfma_f32_16x16x32_bf16 v[80:83], v[148:151], a[96:99], v[80:83]
  ds_read_b128 v[196:199], v6 offset:14336
  v_mfma_f32_16x16x32_bf16 v[84:87], v[148:151], a[100:103], v[84:87]
  buffer_load_dwordx4 a[144:147], v2, s[4:7], s34 offen offset:2048 sc1
  v_mfma_f32_16x16x32_bf16 v[104:107], a[96:99], v[152:155], v[104:107]
  buffer_load_dwordx4 a[148:151], v5, s[4:7], s34 offen offset:2048 sc1
  v_mfma_f32_16x16x32_bf16 v[108:111], a[100:103], v[152:155], v[108:111]
  v_mfma_f32_16x16x32_bf16 v[112:115], a[96:99], v[156:159], v[112:115]
  v_mfma_f32_16x16x32_bf16 v[116:119], a[100:103], v[156:159], v[116:119]
  s_waitcnt vmcnt(10) lgkmcnt(5)
  v_mfma_f32_16x16x32_bf16 v[64:67], v[160:163], a[104:107], v[64:67]
  ds_read_b128 v[140:143], v6 offset:15360
  v_mfma_f32_16x16x32_bf16 v[68:71], v[160:163], a[108:111], v[68:71]
  ds_read_b128 v[144:147], v6 offset:16384
  v_mfma_f32_16x16x32_bf16 v[72:75], v[164:167], a[104:107], v[72:75]
  ds_read_b128 v[148:151], v6 offset:17408
  v_mfma_f32_16x16x32_bf16 v[76:79], v[164:167], a[108:111], v[76:79]
  ds_read_b128 v[152:155], v6 offset:18432
  v_mfma_f32_16x16x32_bf16 v[80:83], v[168:171], a[104:107], v[80:83]
  ds_read_b128 v[156:159], v6 offset:19456
  v_mfma_f32_16x16x32_bf16 v[84:87], v[168:171], a[108:111], v[84:87]
  buffer_load_dwordx4 a[152:155], v2, s[4:7], s34 offen offset:3072 sc1
  v_mfma_f32_16x16x32_bf16 v[104:107], a[104:107], v[172:175], v[104:107]
  buffer_load_dwordx4 a[156:159], v5, s[4:7], s34 offen offset:3072 sc1
  v_mfma_f32_16x16x32_bf16 v[108:111], a[108:111], v[172:175], v[108:111]
  v_mfma_f32_16x16x32_bf16 v[112:115], a[104:107], v[176:179], v[112:115]
  v_mfma_f32_16x16x32_bf16 v[116:119], a[108:111], v[176:179], v[116:119]
  s_waitcnt vmcnt(10) lgkmcnt(5)
  v_mfma_f32_16x16x32_bf16 v[64:67], v[180:183], a[112:115], v[64:67]
  ds_read_b128 v[160:163], v6 offset:20480
  v_mfma_f32_16x16x32_bf16 v[68:71], v[180:183], a[116:119], v[68:71]
  ds_read_b128 v[164:167], v6 offset:21504
  v_mfma_f32_16x16x32_bf16 v[72:75], v[184:187], a[112:115], v[72:75]
  ds_read_b128 v[168:171], v6 offset:22528
  v_mfma_f32_16x16x32_bf16 v[76:79], v[184:187], a[116:119], v[76:79]
  ds_read_b128 v[172:175], v6 offset:23552
  v_mfma_f32_16x16x32_bf16 v[80:83], v[188:191], a[112:115], v[80:83]
  ds_read_b128 v[176:179], v6 offset:24576
  v_mfma_f32_16x16x32_bf16 v[84:87], v[188:191], a[116:119], v[84:87]
  v_mfma_f32_16x16x32_bf16 v[104:107], a[112:115], v[192:195], v[104:107]
  v_mfma_f32_16x16x32_bf16 v[108:111], a[116:119], v[192:195], v[108:111]
  v_mfma_f32_16x16x32_bf16 v[112:115], a[112:115], v[196:199], v[112:115]
  v_mfma_f32_16x16x32_bf16 v[116:119], a[116:119], v[196:199], v[116:119]
  s_waitcnt vmcnt(8) lgkmcnt(5)
  v_mfma_f32_16x16x32_bf16 v[64:67], v[140:143], a[120:123], v[64:67]
  ds_read_b128 v[180:183], v6 offset:25600
  v_mfma_f32_16x16x32_bf16 v[68:71], v[140:143], a[124:127], v[68:71]
  ds_read_b128 v[184:187], v6 offset:26624
  v_mfma_f32_16x16x32_bf16 v[72:75], v[144:147], a[120:123], v[72:75]
  ds_read_b128 v[188:191], v6 offset:27648
  v_mfma_f32_16x16x32_bf16 v[76:79], v[144:147], a[124:127], v[76:79]
  ds_read_b128 v[192:195], v6 offset:28672
  v_mfma_f32_16x16x32_bf16 v[80:83], v[148:151], a[120:123], v[80:83]
  ds_read_b128 v[196:199], v6 offset:29696
  v_mfma_f32_16x16x32_bf16 v[84:87], v[148:151], a[124:127], v[84:87]
  v_mfma_f32_16x16x32_bf16 v[104:107], a[120:123], v[152:155], v[104:107]
  v_mfma_f32_16x16x32_bf16 v[108:111], a[124:127], v[152:155], v[108:111]
  v_mfma_f32_16x16x32_bf16 v[112:115], a[120:123], v[156:159], v[112:115]
  v_mfma_f32_16x16x32_bf16 v[116:119], a[124:127], v[156:159], v[116:119]
  s_waitcnt vmcnt(6) lgkmcnt(5)
  v_mfma_f32_16x16x32_bf16 v[64:67], v[160:163], a[128:131], v[64:67]
  ds_read_b128 v[140:143], v6 offset:30720
  v_mfma_f32_16x16x32_bf16 v[68:71], v[160:163], a[132:135], v[68:71]
  ds_read_b128 v[144:147], v6 offset:31744
  v_mfma_f32_16x16x32_bf16 v[72:75], v[164:167], a[128:131], v[72:75]
  ds_read_b128 v[148:151], v6 offset:32768
  v_mfma_f32_16x16x32_bf16 v[76:79], v[164:167], a[132:135], v[76:79]
  ds_read_b128 v[152:155], v6 offset:33792
  v_mfma_f32_16x16x32_bf16 v[80:83], v[168:171], a[128:131], v[80:83]
  ds_read_b128 v[156:159], v6 offset:34816
  v_mfma_f32_16x16x32_bf16 v[84:87], v[168:171], a[132:135], v[84:87]
  v_mfma_f32_16x16x32_bf16 v[104:107], a[128:131], v[172:175], v[104:107]
  v_mfma_f32_16x16x32_bf16 v[108:111], a[132:135], v[172:175], v[108:111]
  v_mfma_f32_16x16x32_bf16 v[112:115], a[128:131], v[176:179], v[112:115]
  v_mfma_f32_16x16x32_bf16 v[116:119], a[132:135], v[176:179], v[116:119]
  s_waitcnt vmcnt(4) lgkmcnt(5)
  v_mfma_f32_16x16x32_bf16 v[64:67], v[180:183], a[136:139], v[64:67]
  ds_read_b128 v[160:163], v6 offset:35840
  v_mfma_f32_16x16x32_bf16 v[68:71], v[180:183], a[140:143], v[68:71]
  ds_read_b128 v[164:167], v6 offset:36864
  v_mfma_f32_16x16x32_bf16 v[72:75], v[184:187], a[136:139], v[72:75]
  ds_read_b128 v[168:171], v6 offset:37888
  v_mfma_f32_16x16x32_bf16 v[76:79], v[184:187], a[140:143], v[76:79]
  ds_read_b128 v[172:175], v6 offset:38912
  v_mfma_f32_16x16x32_bf16 v[80:83], v[188:191], a[136:139], v[80:83]
  ds_read_b128 v[176:179], v6 offset:39936
  v_mfma_f32_16x16x32_bf16 v[84:87], v[188:191], a[140:143], v[84:87]
  v_mfma_f32_16x16x32_bf16 v[104:107], a[136:139], v[192:195], v[104:107]
  v_mfma_f32_16x16x32_bf16 v[108:111], a[140:143], v[192:195], v[108:111]
  v_mfma_f32_16x16x32_bf16 v[112:115], a[136:139], v[196:199], v[112:115]
  v_mfma_f32_16x16x32_bf16 v[116:119], a[140:143], v[196:199], v[116:119]
  s_waitcnt vmcnt(2) lgkmcnt(5)
  v_mfma_f32_16x16x32_bf16 v[64:67], v[140:143], a[144:147], v[64:67]
  ds_read_b128 v[180:183], v6 offset:40960
  v_mfma_f32_16x16x32_bf16 v[68:71], v[140:143], a[148:151], v[68:71]
  ds_read_b128 v[184:187], v6 offset:41984
  v_mfma_f32_16x16x32_bf16 v[72:75], v[144:147], a[144:147], v[72:75]
  ds_read_b128 v[188:191], v6 offset:43008
  v_mfma_f32_16x16x32_bf16 v[76:79], v[144:147], a[148:151], v[76:79]
  ds_read_b128 v[192:195], v6 offset:44032
  v_mfma_f32_16x16x32_bf16 v[80:83], v[148:151], a[144:147], v[80:83]
  ds_read_b128 v[196:199], v6 offset:45056
  v_mfma_f32_16x16x32_bf16 v[84:87], v[148:151], a[148:151], v[84:87]
  v_mfma_f32_16x16x32_bf16 v[104:107], a[144:147], v[152:155], v[104:107]
  v_mfma_f32_16x16x32_bf16 v[108:111], a[148:151], v[152:155], v[108:111]
  v_mfma_f32_16x16x32_bf16 v[112:115], a[144:147], v[156:159], v[112:115]
  v_mfma_f32_16x16x32_bf16 v[116:119], a[148:151], v[156:159], v[116:119]
  s_waitcnt vmcnt(0) lgkmcnt(5)
  v_mfma_f32_16x16x32_bf16 v[64:67], v[160:163], a[152:155], v[64:67]
  v_mfma_f32_16x16x32_bf16 v[68:71], v[160:163], a[156:159], v[68:71]
  v_mfma_f32_16x16x32_bf16 v[72:75], v[164:167], a[152:155], v[72:75]
  v_mfma_f32_16x16x32_bf16 v[76:79], v[164:167], a[156:159], v[76:79]
  v_mfma_f32_16x16x32_bf16 v[80:83], v[168:171], a[152:155], v[80:83]
  v_mfma_f32_16x16x32_bf16 v[84:87], v[168:171], a[156:159], v[84:87]
  v_mfma_f32_16x16x32_bf16 v[104:107], a[152:155], v[172:175], v[104:107]
  v_mfma_f32_16x16x32_bf16 v[108:111], a[156:159], v[172:175], v[108:111]
  v_mfma_f32_16x16x32_bf16 v[112:115], a[152:155], v[176:179], v[112:115]
  v_mfma_f32_16x16x32_bf16 v[116:119], a[156:159], v[176:179], v[116:119]
  s_waitcnt lgkmcnt(0)
  v_mfma_f32_16x16x32_bf16 v[64:67], v[180:183], v[36:39], v[64:67]
  ds_read_b128 v[208:211], v8 offset:0
  v_mfma_f32_16x16x32_bf16 v[68:71], v[180:183], v[40:43], v[68:71]
  ds_read_b128 v[212:215], v8 offset:512
  v_mfma_f32_16x16x32_bf16 v[72:75], v[184:187], v[36:39], v[72:75]
  ds_read_b128 v[216:219], v8 offset:1024
  v_mfma_f32_16x16x32_bf16 v[76:79], v[184:187], v[40:43], v[76:79]
  ds_read_b128 v[220:223], v8 offset:1536
  v_mfma_f32_16x16x32_bf16 v[80:83], v[188:191], v[36:39], v[80:83]
  ds_read_b128 v[224:227], v8 offset:2048
  v_mfma_f32_16x16x32_bf16 v[84:87], v[188:191], v[40:43], v[84:87]
  ds_read_b128 v[228:231], v8 offset:2560
  v_mfma_f32_16x16x32_bf16 v[104:107], v[36:39], v[192:195], v[104:107]
  v_mfma_f32_16x16x32_bf16 v[108:111], v[40:43], v[192:195], v[108:111]
  v_mfma_f32_16x16x32_bf16 v[112:115], v[36:39], v[196:199], v[112:115]
  v_mfma_f32_16x16x32_bf16 v[116:119], v[40:43], v[196:199], v[116:119]
  s_waitcnt lgkmcnt(4)
  v_mfma_f32_16x16x32_bf16 v[120:123], a[0:3], v[208:211], 0
  v_mul_f32 v52, 1069066811, v28
  v_mul_f32 v54, 1069066811, v30
  v_max3_f32 v56, v64, v65, v66
  v_max3_f32 v60, -v64, -v65, -v66
  v_max3_f32 v58, v68, v69, v70
  v_max3_f32 v62, -v68, -v69, -v70
  ds_read_b128 v[232:235], v8 offset:3072
  v_mfma_f32_16x16x32_bf16 v[124:127], a[4:7], v[208:211], 0
  v_max3_f32 v56, v56, v67, v72
  v_max3_f32 v60, v60, -v67, -v72
  v_max3_f32 v58, v58, v71, v76
  v_max3_f32 v62, v62, -v71, -v76
  v_max3_f32 v56, v56, v73, v74
  v_mfma_f32_16x16x32_bf16 v[120:123], a[8:11], v[212:215], v[120:123]
  v_max3_f32 v60, v60, -v73, -v74
  v_max3_f32 v58, v58, v77, v78
  v_max3_f32 v62, v62, -v77, -v78
  v_max3_f32 v56, v56, v75, v80
  v_max3_f32 v60, v60, -v75, -v80
  v_max3_f32 v58, v58, v79, v84
  ds_read_b128 v[236:239], v8 offset:3584
  v_mfma_f32_16x16x32_bf16 v[124:127], a[12:15], v[212:215], v[124:127]
  v_max3_f32 v62, v62, -v79, -v84
  v_max_f32 v56, v56, v81
  v_max_f32_e64 v60, v60, -v81
  v_max_f32 v58, v58, v85
  v_max_f32_e64 v62, v62, -v85
  s_mul_i32 s91, s12, 10240
  s_add_u32 s92, s91, s26
  s_add_u32 m0, s91, 122880
  s_add_u32 s90, s92, 122880
  buffer_load_dwordx4 v2, s[4:7], s90 offen offset:0 sc1 lds
  s_waitcnt lgkmcnt(4)
  v_mfma_f32_16x16x32_bf16 v[120:123], a[16:19], v[216:219], v[120:123]
  v_permlane16_swap_b32 v56, v60
  ds_read_b128 v[208:211], v8 offset:4096
  v_mfma_f32_16x16x32_bf16 v[124:127], a[20:23], v[216:219], v[124:127]
  v_permlane16_swap_b32 v58, v62
  v_max_f32 v56, v56, v60
  v_max_f32 v58, v58, v62
  v_mov_b32 v60, v56
  v_mov_b32 v62, v58
  v_mfma_f32_16x16x32_bf16 v[120:123], a[24:27], v[220:223], v[120:123]
  v_permlane16_swap_b32 v56, v60
  v_permlane16_swap_b32 v58, v62
  v_mul_f32 v56, v56, v52
  v_mul_f32 v60, v60, v52
  v_mul_f32 v58, v58, v54
  v_mul_f32 v62, v62, v54
  ds_read_b128 v[212:215], v8 offset:4608
  v_mfma_f32_16x16x32_bf16 v[124:127], a[28:31], v[220:223], v[124:127]
  v_pk_fma_f32 v[140:141], v[64:65], v[52:53], v[60:61] op_sel_hi:[1,0,0] neg_lo:[0,1,1] neg_hi:[0,1,1]
  v_pk_fma_f32 v[64:65], v[64:65], v[52:53], v[56:57] op_sel_hi:[1,0,0] neg_lo:[0,0,1] neg_hi:[0,0,1]
  v_pk_fma_f32 v[142:143], v[66:67], v[52:53], v[60:61] op_sel_hi:[1,0,0] neg_lo:[0,1,1] neg_hi:[0,1,1]
  v_pk_fma_f32 v[66:67], v[66:67], v[52:53], v[56:57] op_sel_hi:[1,0,0] neg_lo:[0,0,1] neg_hi:[0,0,1]
  v_pk_fma_f32 v[144:145], v[72:73], v[52:53], v[60:61] op_sel_hi:[1,0,0] neg_lo:[0,1,1] neg_hi:[0,1,1]
  v_pk_fma_f32 v[72:73], v[72:73], v[52:53], v[56:57] op_sel_hi:[1,0,0] neg_lo:[0,0,1] neg_hi:[0,0,1]
  v_pk_fma_f32 v[146:147], v[74:75], v[52:53], v[60:61] op_sel_hi:[1,0,0] neg_lo:[0,1,1] neg_hi:[0,1,1]
  v_pk_fma_f32 v[74:75], v[74:75], v[52:53], v[56:57] op_sel_hi:[1,0,0] neg_lo:[0,0,1] neg_hi:[0,0,1]
  v_pk_fma_f32 v[148:149], v[80:81], v[52:53], v[60:61] op_sel_hi:[1,0,0] neg_lo:[0,1,1] neg_hi:[0,1,1]
  v_pk_fma_f32 v[80:81], v[80:81], v[52:53], v[56:57] op_sel_hi:[1,0,0] neg_lo:[0,0,1] neg_hi:[0,0,1]
  buffer_load_dwordx4 v2, s[4:7], s90 offen offset:1024 sc1 lds
  s_waitcnt lgkmcnt(4)
  v_mfma_f32_16x16x32_bf16 v[120:123], a[32:35], v[224:227], v[120:123]
  ds_read_b128 v[216:219], v8 offset:5120
  v_mfma_f32_16x16x32_bf16 v[124:127], a[36:39], v[224:227], v[124:127]
  v_exp_f32 v64, v64
  v_exp_f32 v65, v65
  v_exp_f32 v66, v66
  v_mfma_f32_16x16x32_bf16 v[120:123], a[40:43], v[228:231], v[120:123]
  v_exp_f32 v67, v67
  v_exp_f32 v72, v72
  v_exp_f32 v73, v73
  ds_read_b128 v[220:223], v8 offset:5632
  v_mfma_f32_16x16x32_bf16 v[124:127], a[44:47], v[228:231], v[124:127]
  v_exp_f32 v74, v74
  v_exp_f32 v75, v75
  buffer_load_dwordx4 v2, s[4:7], s90 offen offset:2048 sc1 lds
  s_waitcnt lgkmcnt(4)
  v_mfma_f32_16x16x32_bf16 v[120:123], a[48:51], v[232:235], v[120:123]
  v_exp_f32 v80, v80
  v_exp_f32 v81, v81
  v_exp_f32 v140, v140
  ds_read_b128 v[224:227], v8 offset:6144
  v_mfma_f32_16x16x32_bf16 v[124:127], a[52:55], v[232:235], v[124:127]
  v_exp_f32 v141, v141
  v_exp_f32 v142, v142
  v_mfma_f32_16x16x32_bf16 v[120:123], a[56:59], v[236:239], v[120:123]
  v_exp_f32 v143, v143
  v_exp_f32 v144, v144
  v_exp_f32 v145, v145
  ds_read_b128 v[228:231], v8 offset:6656
  v_mfma_f32_16x16x32_bf16 v[124:127], a[60:63], v[236:239], v[124:127]
  v_exp_f32 v146, v146
  v_exp_f32 v147, v147
  v_exp_f32 v148, v148
  buffer_load_dwordx4 v2, s[4:7], s90 offen offset:3072 sc1 lds
  s_waitcnt lgkmcnt(4)
  v_mfma_f32_16x16x32_bf16 v[120:123], a[64:67], v[208:211], v[120:123]
  v_exp_f32 v149, v149
  v_pk_fma_f32 v[152:153], v[68:69], v[54:55], v[62:63] op_sel_hi:[1,0,0] neg_lo:[0,1,1] neg_hi:[0,1,1]
  v_pk_fma_f32 v[68:69], v[68:69], v[54:55], v[58:59] op_sel_hi:[1,0,0] neg_lo:[0,0,1] neg_hi:[0,0,1]
  v_pk_fma_f32 v[154:155], v[70:71], v[54:55], v[62:63] op_sel_hi:[1,0,0] neg_lo:[0,1,1] neg_hi:[0,1,1]
  v_pk_fma_f32 v[70:71], v[70:71], v[54:55], v[58:59] op_sel_hi:[1,0,0] neg_lo:[0,0,1] neg_hi:[0,0,1]
  v_pk_fma_f32 v[156:157], v[76:77], v[54:55], v[62:63] op_sel_hi:[1,0,0] neg_lo:[0,1,1] neg_hi:[0,1,1]
  v_pk_fma_f32 v[76:77], v[76:77], v[54:55], v[58:59] op_sel_hi:[1,0,0] neg_lo:[0,0,1] neg_hi:[0,0,1]
  v_pk_fma_f32 v[158:159], v[78:79], v[54:55], v[62:63] op_sel_hi:[1,0,0] neg_lo:[0,1,1] neg_hi:[0,1,1]
  v_pk_fma_f32 v[78:79], v[78:79], v[54:55], v[58:59] op_sel_hi:[1,0,0] neg_lo:[0,0,1] neg_hi:[0,0,1]
  v_pk_fma_f32 v[160:161], v[84:85], v[54:55], v[62:63] op_sel_hi:[1,0,0] neg_lo:[0,1,1] neg_hi:[0,1,1]
  v_pk_fma_f32 v[84:85], v[84:85], v[54:55], v[58:59] op_sel_hi:[1,0,0] neg_lo:[0,0,1] neg_hi:[0,0,1]
  ds_read_b128 v[232:235], v8 offset:7168
  v_mfma_f32_16x16x32_bf16 v[124:127], a[68:71], v[208:211], v[124:127]
  v_mfma_f32_16x16x32_bf16 v[120:123], a[72:75], v[212:215], v[120:123]
  v_exp_f32 v68, v68
  v_exp_f32 v69, v69
  ds_read_b128 v[236:239], v8 offset:7680
  v_mfma_f32_16x16x32_bf16 v[124:127], a[76:79], v[212:215], v[124:127]
  v_exp_f32 v70, v70
  v_exp_f32 v71, v71
  s_add_u32 m0, s91, 126976
  s_add_u32 s90, s92, 126976
  buffer_load_dwordx4 v2, s[4:7], s90 offen offset:0 sc1 lds
  s_waitcnt lgkmcnt(4)
  v_mfma_f32_16x16x32_bf16 v[120:123], a[80:83], v[216:219], v[120:123]
  v_exp_f32 v76, v76
  v_exp_f32 v77, v77
  ds_read_b128 v[208:211], v8 offset:8192
  v_mfma_f32_16x16x32_bf16 v[124:127], a[84:87], v[216:219], v[124:127]
  v_exp_f32 v78, v78
  v_exp_f32 v79, v79
  v_mfma_f32_16x16x32_bf16 v[120:123], a[88:91], v[220:223], v[120:123]
  v_exp_f32 v84, v84
  v_exp_f32 v85, v85
  v_exp_f32 v152, v152
  ds_read_b128 v[212:215], v8 offset:8704
  v_mfma_f32_16x16x32_bf16 v[124:127], a[92:95], v[220:223], v[124:127]
  v_exp_f32 v153, v153
  v_exp_f32 v154, v154
  v_exp_f32 v155, v155
  buffer_load_dwordx4 v2, s[4:7], s90 offen offset:1024 sc1 lds
  s_waitcnt lgkmcnt(4)
  v_mfma_f32_16x16x32_bf16 v[120:123], a[96:99], v[224:227], v[120:123]
  v_exp_f32 v156, v156
  v_exp_f32 v157, v157
  ds_read_b128 v[216:219], v8 offset:9216
  v_mfma_f32_16x16x32_bf16 v[124:127], a[100:103], v[224:227], v[124:127]
  v_exp_f32 v158, v158
  v_exp_f32 v159, v159
  v_exp_f32 v160, v160
  v_mfma_f32_16x16x32_bf16 v[120:123], a[104:107], v[228:231], v[120:123]
  v_exp_f32 v161, v161
  v_pk_add_f32 v[24:25], v[64:65], v[66:67]
  v_pk_add_f32 v[26:27], v[140:141], v[142:143]
  v_pk_add_f32 v[56:57], v[68:69], v[70:71]
  v_pk_add_f32 v[60:61], v[152:153], v[154:155]
  v_pk_add_f32 v[24:25], v[24:25], v[72:73]
  v_pk_add_f32 v[26:27], v[26:27], v[144:145]
  v_pk_add_f32 v[56:57], v[56:57], v[76:77]
  v_pk_add_f32 v[60:61], v[60:61], v[156:157]
  v_pk_add_f32 v[24:25], v[24:25], v[74:75]
  v_pk_add_f32 v[26:27], v[26:27], v[146:147]
  v_pk_add_f32 v[56:57], v[56:57], v[78:79]
  v_pk_add_f32 v[60:61], v[60:61], v[158:159]
  v_pk_add_f32 v[24:25], v[24:25], v[80:81]
  v_pk_add_f32 v[26:27], v[26:27], v[148:149]
  v_pk_add_f32 v[56:57], v[56:57], v[84:85]
  v_pk_add_f32 v[60:61], v[60:61], v[160:161]
  ds_read_b128 v[220:223], v8 offset:9728
  v_mfma_f32_16x16x32_bf16 v[124:127], a[108:111], v[228:231], v[124:127]
  buffer_load_dwordx4 v2, s[4:7], s90 offen offset:2048 sc1 lds
  s_waitcnt lgkmcnt(4)
  v_mfma_f32_16x16x32_bf16 v[120:123], a[112:115], v[232:235], v[120:123]
  ds_read_b128 v[224:227], v8 offset:10240
  v_mfma_f32_16x16x32_bf16 v[124:127], a[116:119], v[232:235], v[124:127]
  v_add_f32 v24, v24, v25
  v_add_f32 v26, v26, v27
  v_mfma_f32_16x16x32_bf16 v[120:123], a[120:123], v[236:239], v[120:123]
  v_add_f32 v56, v56, v57
  v_add_f32 v60, v60, v61
  v_permlane16_swap_b32 v24, v26
  buffer_load_dwordx4 v2, s[4:7], s90 offen offset:3072 sc1 lds
  v_mfma_f32_16x16x32_bf16 v[124:127], a[124:127], v[236:239], v[124:127]
  v_permlane16_swap_b32 v56, v60
  v_add_f32 v24, v24, v26
  v_add_f32 v56, v56, v60
  v_mov_b32 v26, v24
  v_mov_b32 v60, v56
  s_waitcnt lgkmcnt(3)
  v_mfma_f32_16x16x32_bf16 v[120:123], a[128:131], v[208:211], v[120:123]
  v_permlane16_swap_b32 v24, v26
  v_permlane16_swap_b32 v56, v60
  v_rcp_f32 v24, v24
  v_rcp_f32 v26, v26
  v_rcp_f32 v56, v56
  v_rcp_f32 v60, v60
  v_mfma_f32_16x16x32_bf16 v[124:127], a[132:135], v[208:211], v[124:127]
  v_mov_b32 v174, 0
  v_mov_b32 v175, 0
  v_mov_b32 v186, 0
  v_mov_b32 v187, 0
  v_pk_mul_f32 v[64:65], v[64:65], v[24:25] op_sel_hi:[1,0]
  v_pk_mul_f32 v[66:67], v[66:67], v[24:25] op_sel_hi:[1,0]
  v_pk_mul_f32 v[72:73], v[72:73], v[24:25] op_sel_hi:[1,0]
  v_pk_mul_f32 v[74:75], v[74:75], v[24:25] op_sel_hi:[1,0]
  v_pk_mul_f32 v[80:81], v[80:81], v[24:25] op_sel_hi:[1,0]
  v_pk_mul_f32 v[140:141], v[140:141], v[26:27] op_sel_hi:[1,0]
  v_pk_mul_f32 v[142:143], v[142:143], v[26:27] op_sel_hi:[1,0]
  v_pk_mul_f32 v[144:145], v[144:145], v[26:27] op_sel_hi:[1,0]
  v_pk_mul_f32 v[146:147], v[146:147], v[26:27] op_sel_hi:[1,0]
  v_pk_mul_f32 v[148:149], v[148:149], v[26:27] op_sel_hi:[1,0]
  v_mfma_f32_16x16x32_bf16 v[120:123], a[136:139], v[212:215], v[120:123]
  s_add_u32 m0, s91, 131072
  s_add_u32 s90, s92, 131072
  buffer_load_dwordx4 v2, s[4:7], s90 offen offset:0 sc1 lds
  v_mfma_f32_16x16x32_bf16 v[124:127], a[140:143], v[212:215], v[124:127]
  s_waitcnt lgkmcnt(1)
  v_mfma_f32_16x16x32_bf16 v[120:123], a[144:147], v[216:219], v[120:123]
  v_cvt_pk_bf16_f32 v164, v64, v65
  v_cvt_pk_bf16_f32 v165, v66, v67
  v_cvt_pk_bf16_f32 v166, v72, v73
  v_cvt_pk_bf16_f32 v167, v74, v75
  v_cvt_pk_bf16_f32 v168, v80, v81
  v_cvt_pk_bf16_f32 v169, v140, v141
  v_mfma_f32_16x16x32_bf16 v[124:127], a[148:151], v[216:219], v[124:127]
  v_cvt_pk_bf16_f32 v170, v142, v143
  v_cvt_pk_bf16_f32 v171, v144, v145
  v_cvt_pk_bf16_f32 v172, v146, v147
  v_cvt_pk_bf16_f32 v173, v148, v149
  v_mfma_f32_16x16x32_bf16 v[64:67], v[164:167], a[192:195], 0
  v_mfma_f32_16x16x32_bf16 v[72:75], v[164:167], a[196:199], 0
  v_mfma_f32_16x16x32_bf16 v[120:123], a[152:155], v[220:223], v[120:123]
  v_mfma_f32_16x16x32_bf16 v[88:91], v[168:171], a[192:195], 0
  v_mfma_f32_16x16x32_bf16 v[96:99], v[168:171], a[196:199], 0
  v_mfma_f32_16x16x32_bf16 v[140:143], v[172:175], a[200:203], 0
  v_pk_mul_f32 v[68:69], v[68:69], v[56:57] op_sel_hi:[1,0]
  v_pk_mul_f32 v[70:71], v[70:71], v[56:57] op_sel_hi:[1,0]
  v_pk_mul_f32 v[76:77], v[76:77], v[56:57] op_sel_hi:[1,0]
  v_pk_mul_f32 v[78:79], v[78:79], v[56:57] op_sel_hi:[1,0]
  v_pk_mul_f32 v[84:85], v[84:85], v[56:57] op_sel_hi:[1,0]
  v_pk_mul_f32 v[152:153], v[152:153], v[60:61] op_sel_hi:[1,0]
  v_pk_mul_f32 v[154:155], v[154:155], v[60:61] op_sel_hi:[1,0]
  v_pk_mul_f32 v[156:157], v[156:157], v[60:61] op_sel_hi:[1,0]
  v_pk_mul_f32 v[158:159], v[158:159], v[60:61] op_sel_hi:[1,0]
  v_pk_mul_f32 v[160:161], v[160:161], v[60:61] op_sel_hi:[1,0]
  buffer_load_dwordx4 v2, s[4:7], s90 offen offset:1024 sc1 lds
  v_mfma_f32_16x16x32_bf16 v[124:127], a[156:159], v[220:223], v[124:127]
  s_waitcnt lgkmcnt(0)
  v_mfma_f32_16x16x32_bf16 v[120:123], v[36:39], v[224:227], v[120:123]
  v_cvt_pk_bf16_f32 v176, v68, v69
  v_cvt_pk_bf16_f32 v177, v70, v71
  v_cvt_pk_bf16_f32 v178, v76, v77
  v_cvt_pk_bf16_f32 v179, v78, v79
  v_mfma_f32_16x16x32_bf16 v[124:127], v[40:43], v[224:227], v[124:127]
  v_cvt_pk_bf16_f32 v180, v84, v85
  v_cvt_pk_bf16_f32 v181, v152, v153
  v_cvt_pk_bf16_f32 v182, v154, v155
  v_cvt_pk_bf16_f32 v183, v156, v157
  v_cvt_pk_bf16_f32 v184, v158, v159
  v_cvt_pk_bf16_f32 v185, v160, v161
  v_mfma_f32_16x16x32_bf16 v[68:71], v[176:179], a[192:195], 0
  v_mfma_f32_16x16x32_bf16 v[76:79], v[176:179], a[196:199], 0
  v_mfma_f32_16x16x32_bf16 v[92:95], v[180:183], a[192:195], 0
  v_mfma_f32_16x16x32_bf16 v[100:103], v[180:183], a[196:199], 0
  v_mfma_f32_16x16x32_bf16 v[152:155], v[184:187], a[200:203], 0
  v_mul_f32_dpp v104, v34, v104 row_newbcast:0 row_mask:0xf bank_mask:0xf
  v_mul_f32_dpp v105, v34, v105 row_newbcast:1 row_mask:0xf bank_mask:0xf
  v_mul_f32_dpp v106, v34, v106 row_newbcast:2 row_mask:0xf bank_mask:0xf
  v_mul_f32_dpp v107, v34, v107 row_newbcast:3 row_mask:0xf bank_mask:0xf
  v_mul_f32_dpp v108, v34, v108 row_newbcast:4 row_mask:0xf bank_mask:0xf
  v_mul_f32_dpp v109, v34, v109 row_newbcast:5 row_mask:0xf bank_mask:0xf
  v_mul_f32_dpp v110, v34, v110 row_newbcast:6 row_mask:0xf bank_mask:0xf
  v_mul_f32_dpp v111, v34, v111 row_newbcast:7 row_mask:0xf bank_mask:0xf
  v_mul_f32_dpp v112, v34, v112 row_newbcast:0 row_mask:0xf bank_mask:0xf
  v_mul_f32_dpp v113, v34, v113 row_newbcast:1 row_mask:0xf bank_mask:0xf
  v_mul_f32_dpp v114, v34, v114 row_newbcast:2 row_mask:0xf bank_mask:0xf
  v_mul_f32_dpp v115, v34, v115 row_newbcast:3 row_mask:0xf bank_mask:0xf
  v_mul_f32_dpp v116, v34, v116 row_newbcast:4 row_mask:0xf bank_mask:0xf
  v_mul_f32_dpp v117, v34, v117 row_newbcast:5 row_mask:0xf bank_mask:0xf
  v_mul_f32_dpp v118, v34, v118 row_newbcast:6 row_mask:0xf bank_mask:0xf
  v_mul_f32_dpp v119, v34, v119 row_newbcast:7 row_mask:0xf bank_mask:0xf
  v_cvt_pk_bf16_f32 v240, v104, v105
  v_cvt_pk_bf16_f32 v241, v106, v107
  v_cvt_pk_bf16_f32 v242, v108, v109
  v_cvt_pk_bf16_f32 v243, v110, v111
  v_cvt_pk_bf16_f32 v144, v112, v113
  v_cvt_pk_bf16_f32 v145, v114, v115
  v_cvt_pk_bf16_f32 v146, v116, v117
  v_cvt_pk_bf16_f32 v147, v118, v119
  s_mul_i32 s58, s12, 10240
  s_add_u32 s58, s58, 45056
  v_add_u32 v48, s58, v2
  v_cvt_pk_bf16_f32 v188, v64, v65
  v_cvt_pk_bf16_f32 v189, v66, v67
  v_cvt_pk_bf16_f32 v192, v72, v73
  v_cvt_pk_bf16_f32 v193, v74, v75
  v_cvt_pk_bf16_f32 v196, v88, v89
  v_cvt_pk_bf16_f32 v197, v90, v91
  v_cvt_pk_bf16_f32 v200, v96, v97
  v_cvt_pk_bf16_f32 v201, v98, v99
  v_cvt_pk_bf16_f32 v204, v140, v141
  v_cvt_pk_bf16_f32 v205, v142, v143
  v_cvt_pk_bf16_f32 v190, v68, v69
  v_cvt_pk_bf16_f32 v191, v70, v71
  v_cvt_pk_bf16_f32 v194, v76, v77
  v_cvt_pk_bf16_f32 v195, v78, v79
  v_cvt_pk_bf16_f32 v198, v92, v93
  v_cvt_pk_bf16_f32 v199, v94, v95
  v_cvt_pk_bf16_f32 v202, v100, v101
  v_cvt_pk_bf16_f32 v203, v102, v103
  v_cvt_pk_bf16_f32 v206, v152, v153
  v_cvt_pk_bf16_f32 v207, v154, v155
  v_mfma_f32_16x16x32_bf16 v[64:67], v[188:191], v[240:243], 0
  v_mfma_f32_16x16x32_bf16 v[68:71], v[192:195], v[144:147], 0
  v_mfma_f32_16x16x32_bf16 v[72:75], v[196:199], v[240:243], 0
  v_mfma_f32_16x16x32_bf16 v[76:79], v[200:203], v[144:147], 0
  v_mfma_f32_16x16x32_bf16 v[88:91], v[204:207], v[240:243], 0
  v_mfma_f32_16x16x32_bf16 v[92:95], v[204:207], v[144:147], 0
  v_mul_f32_dpp v120, v34, v120 row_newbcast:0 row_mask:0xf bank_mask:0xf
  v_mul_f32_dpp v121, v34, v121 row_newbcast:1 row_mask:0xf bank_mask:0xf
  v_mul_f32_dpp v122, v34, v122 row_newbcast:2 row_mask:0xf bank_mask:0xf
  v_mul_f32_dpp v123, v34, v123 row_newbcast:3 row_mask:0xf bank_mask:0xf
  v_mul_f32_dpp v124, v34, v124 row_newbcast:4 row_mask:0xf bank_mask:0xf
  v_mul_f32_dpp v125, v34, v125 row_newbcast:5 row_mask:0xf bank_mask:0xf
  v_mul_f32_dpp v126, v34, v126 row_newbcast:6 row_mask:0xf bank_mask:0xf
  v_mul_f32_dpp v127, v34, v127 row_newbcast:7 row_mask:0xf bank_mask:0xf
  v_cvt_pk_bf16_f32 v156, v120, v121
  v_cvt_pk_bf16_f32 v157, v122, v123
  v_cvt_pk_bf16_f32 v158, v124, v125
  v_cvt_pk_bf16_f32 v159, v126, v127
  v_cndmask_b32 v156, v156, v51, s[50:51]
  v_cndmask_b32 v157, v157, v51, s[50:51]
  v_cndmask_b32 v158, v158, v51, s[50:51]
  v_cndmask_b32 v159, v159, v51, s[50:51]
  ds_write_b128 v48, v[64:67] offset:0
  ds_write_b128 v48, v[68:71] offset:1024
  ds_write_b128 v48, v[72:75] offset:2048
  ds_write_b128 v48, v[76:79] offset:3072
  v_mfma_f32_16x16x32_bf16 v[164:167], v[188:191], v[156:159], 0
  v_mfma_f32_16x16x32_bf16 v[168:171], v[192:195], v[156:159], 0
  v_mfma_f32_16x16x32_bf16 v[172:175], v[196:199], v[156:159], 0
  v_mfma_f32_16x16x32_bf16 v[176:179], v[200:203], v[156:159], 0
  v_mfma_f32_16x16x32_bf16 v[180:183], v[204:207], v[156:159], 0
  v_cndmask_b32 v88, v92, v88, s[48:49]
  v_cndmask_b32 v89, v93, v89, s[48:49]
  v_cndmask_b32 v90, v94, v90, s[48:49]
  v_cndmask_b32 v91, v95, v91, s[48:49]
  ds_write_b128 v48, v[88:91] offset:4096
  ds_write_b128 v48, v[164:167] offset:5120
  ds_write_b128 v48, v[168:171] offset:6144
  ds_write_b128 v48, v[172:175] offset:7168
  ds_write_b128 v48, v[176:179] offset:8192
  ds_write_b128 v48, v[180:183] offset:9216
  s_waitcnt vmcnt(0) lgkmcnt(0)
  s_barrier
  ds_read_b128 v[140:143], v16 offset:0
  ds_read_b128 v[144:147], v16 offset:10240
  ds_read_b128 v[148:151], v16 offset:20480
  ds_read_b128 v[152:155], v16 offset:30720
  ds_read_b128 v[156:159], v17 offset:0
  ds_read_b128 v[160:163], v17 offset:10240
  ds_read_b128 v[164:167], v17 offset:20480
  ds_read_b128 v[168:171], v17 offset:30720
  ds_read_b128 v[208:211], v9 offset:0
  ds_read_b128 v[212:215], v9 offset:1024
  ds_read_b128 v[216:219], v9 offset:2048
  ds_read_b128 v[220:223], v9 offset:3072
  ds_read_b128 v[224:227], v9 offset:4096
  ds_read_b128 v[228:231], v9 offset:5120
  s_waitcnt lgkmcnt(10)
  v_pk_add_f32 v[140:141], v[140:141], v[144:145]
  v_pk_add_f32 v[148:149], v[148:149], v[152:153]
  v_pk_add_f32 v[142:143], v[142:143], v[146:147]
  v_pk_add_f32 v[150:151], v[150:151], v[154:155]
  v_pk_add_f32 v[140:141], v[140:141], v[148:149]
  v_pk_add_f32 v[142:143], v[142:143], v[150:151]
  v_cvt_pk_bf16_f32 v52, v140, v141
  v_cvt_pk_bf16_f32 v53, v142, v143
  s_waitcnt lgkmcnt(6)
  v_pk_add_f32 v[156:157], v[156:157], v[160:161]
  v_pk_add_f32 v[164:165], v[164:165], v[168:169]
  v_pk_add_f32 v[158:159], v[158:159], v[162:163]
  v_pk_add_f32 v[166:167], v[166:167], v[170:171]
  v_pk_add_f32 v[156:157], v[156:157], v[164:165]
  v_pk_add_f32 v[158:159], v[158:159], v[166:167]
  v_cvt_pk_bf16_f32 v54, v156, v157
  v_cvt_pk_bf16_f32 v55, v158, v159
  buffer_store_dwordx4 v[52:55], v20, s[4:7], s52 offen sc1
  s_and_b32 s62, s13, 7
  s_lshl_b32 s62, s62, 8
  v_mov_b32 v12, s62
  v_mov_b32 v13, 1
  s_waitcnt lgkmcnt(4)
  v_mfma_f32_16x16x32_bf16 v[88:91], v[208:211], a[0:3], 0
  ds_read_b128 v[232:235], v9 offset:6144
  v_mfma_f32_16x16x32_bf16 v[92:95], v[208:211], a[4:7], 0
  ds_read_b128 v[236:239], v9 offset:7168
  v_mfma_f32_16x16x32_bf16 v[96:99], v[212:215], a[0:3], 0
  s_mul_i32 s91, s12, 11264
  s_add_u32 s92, s91, s27
  s_add_u32 m0, s91, 0
  s_add_u32 s90, s92, 0
  buffer_load_dwordx4 v2, s[4:7], s90 offen offset:0 sc1 lds
  v_mfma_f32_16x16x32_bf16 v[100:103], v[212:215], a[4:7], 0
  s_waitcnt lgkmcnt(4)
  v_mfma_f32_16x16x32_bf16 v[88:91], v[216:219], a[8:11], v[88:91]
  ds_read_b128 v[208:211], v9 offset:8192
  v_mfma_f32_16x16x32_bf16 v[92:95], v[216:219], a[12:15], v[92:95]
  ds_read_b128 v[212:215], v9 offset:9216
  v_mfma_f32_16x16x32_bf16 v[96:99], v[220:223], a[8:11], v[96:99]
  buffer_load_dwordx4 v2, s[4:7], s90 offen offset:1024 sc1 lds
  v_mfma_f32_16x16x32_bf16 v[100:103], v[220:223], a[12:15], v[100:103]
  s_waitcnt lgkmcnt(4)
  v_mfma_f32_16x16x32_bf16 v[88:91], v[224:227], a[16:19], v[88:91]
  ds_read_b128 v[216:219], v9 offset:10240
  v_mfma_f32_16x16x32_bf16 v[92:95], v[224:227], a[20:23], v[92:95]
  ds_read_b128 v[220:223], v9 offset:11264
  v_mfma_f32_16x16x32_bf16 v[96:99], v[228:231], a[16:19], v[96:99]
  buffer_load_dwordx4 v2, s[4:7], s90 offen offset:2048 sc1 lds
  v_mfma_f32_16x16x32_bf16 v[100:103], v[228:231], a[20:23], v[100:103]
  s_waitcnt lgkmcnt(4)
  v_mfma_f32_16x16x32_bf16 v[88:91], v[232:235], a[24:27], v[88:91]
  ds_read_b128 v[224:227], v9 offset:12288
  v_mfma_f32_16x16x32_bf16 v[92:95], v[232:235], a[28:31], v[92:95]
  ds_read_b128 v[228:231], v9 offset:13312
  v_mfma_f32_16x16x32_bf16 v[96:99], v[236:239], a[24:27], v[96:99]
  buffer_load_dwordx4 v2, s[4:7], s90 offen offset:3072 sc1 lds
  v_mfma_f32_16x16x32_bf16 v[100:103], v[236:239], a[28:31], v[100:103]
  s_waitcnt lgkmcnt(4)
  v_mfma_f32_16x16x32_bf16 v[88:91], v[208:211], a[32:35], v[88:91]
  ds_read_b128 v[232:235], v9 offset:14336
  v_mfma_f32_16x16x32_bf16 v[92:95], v[208:211], a[36:39], v[92:95]
  ds_read_b128 v[236:239], v9 offset:15360
  v_mfma_f32_16x16x32_bf16 v[96:99], v[212:215], a[32:35], v[96:99]
  s_add_u32 m0, s91, 4096
  s_add_u32 s90, s92, 4096
  buffer_load_dwordx4 v2, s[4:7], s90 offen offset:0 sc1 lds
  v_mfma_f32_16x16x32_bf16 v[100:103], v[212:215], a[36:39], v[100:103]
  s_waitcnt lgkmcnt(4)
  v_mfma_f32_16x16x32_bf16 v[88:91], v[216:219], a[40:43], v[88:91]
  ds_read_b128 v[208:211], v9 offset:16384
  v_mfma_f32_16x16x32_bf16 v[92:95], v[216:219], a[44:47], v[92:95]
  ds_read_b128 v[212:215], v9 offset:17408
  v_mfma_f32_16x16x32_bf16 v[96:99], v[220:223], a[40:43], v[96:99]
  buffer_load_dwordx4 v2, s[4:7], s90 offen offset:1024 sc1 lds
  v_mfma_f32_16x16x32_bf16 v[100:103], v[220:223], a[44:47], v[100:103]
  s_waitcnt lgkmcnt(4)
  v_mfma_f32_16x16x32_bf16 v[88:91], v[224:227], a[48:51], v[88:91]
  ds_read_b128 v[216:219], v9 offset:18432
  v_mfma_f32_16x16x32_bf16 v[92:95], v[224:227], a[52:55], v[92:95]
  ds_read_b128 v[220:223], v9 offset:19456
  v_mfma_f32_16x16x32_bf16 v[96:99], v[228:231], a[48:51], v[96:99]
  buffer_load_dwordx4 v2, s[4:7], s90 offen offset:2048 sc1 lds
  v_mfma_f32_16x16x32_bf16 v[100:103], v[228:231], a[52:55], v[100:103]
  s_waitcnt lgkmcnt(4)
  v_mfma_f32_16x16x32_bf16 v[88:91], v[232:235], a[56:59], v[88:91]
  ds_read_b128 v[224:227], v9 offset:20480
  v_mfma_f32_16x16x32_bf16 v[92:95], v[232:235], a[60:63], v[92:95]
  ds_read_b128 v[228:231], v9 offset:21504
  v_mfma_f32_16x16x32_bf16 v[96:99], v[236:239], a[56:59], v[96:99]
  buffer_load_dwordx4 v2, s[4:7], s90 offen offset:3072 sc1 lds
  v_mfma_f32_16x16x32_bf16 v[100:103], v[236:239], a[60:63], v[100:103]
  s_waitcnt lgkmcnt(4)
  s_cmp_eq_u32 s12, 0
  s_waitcnt vmcnt(8)
  s_barrier
  s_cbranch_scc0 nosig_20
  s_mov_b64 exec, 1
  buffer_atomic_add v13, v12, s[4:7], s54 offen sc1
  s_mov_b64 exec, -1
nosig_20:
  v_mfma_f32_16x16x32_bf16 v[88:91], v[208:211], a[64:67], v[88:91]
  ds_read_b128 v[232:235], v9 offset:22528
  v_mfma_f32_16x16x32_bf16 v[92:95], v[208:211], a[68:71], v[92:95]
  ds_read_b128 v[236:239], v9 offset:23552
  v_mfma_f32_16x16x32_bf16 v[96:99], v[212:215], a[64:67], v[96:99]
  s_add_u32 s36, s61, 0
  buffer_load_dwordx4 a[0:3], v2, s[4:7], s36 offen offset:0 sc1
  v_mfma_f32_16x16x32_bf16 v[100:103], v[212:215], a[68:71], v[100:103]
  s_waitcnt lgkmcnt(4)
  v_mfma_f32_16x16x32_bf16 v[88:91], v[216:219], a[72:75], v[88:91]
  ds_read_b128 v[208:211], v9 offset:24576
  v_mfma_f32_16x16x32_bf16 v[92:95], v[216:219], a[76:79], v[92:95]
  ds_read_b128 v[212:215], v9 offset:25600
  v_mfma_f32_16x16x32_bf16 v[96:99], v[220:223], a[72:75], v[96:99]
  buffer_load_dwordx4 a[4:7], v2, s[4:7], s36 offen offset:1024 sc1
  v_mfma_f32_16x16x32_bf16 v[100:103], v[220:223], a[76:79], v[100:103]
  s_waitcnt lgkmcnt(4)
  v_mfma_f32_16x16x32_bf16 v[88:91], v[224:227], a[80:83], v[88:91]
  ds_read_b128 v[216:219], v9 offset:26624
  v_mfma_f32_16x16x32_bf16 v[92:95], v[224:227], a[84:87], v[92:95]
  ds_read_b128 v[220:223], v9 offset:27648
  v_mfma_f32_16x16x32_bf16 v[96:99], v[228:231], a[80:83], v[96:99]
  buffer_load_dwordx4 a[8:11], v2, s[4:7], s36 offen offset:2048 sc1
  v_mfma_f32_16x16x32_bf16 v[100:103], v[228:231], a[84:87], v[100:103]
  s_waitcnt lgkmcnt(4)
  v_mfma_f32_16x16x32_bf16 v[88:91], v[232:235], a[88:91], v[88:91]
  ds_read_b128 v[224:227], v9 offset:28672
  v_mfma_f32_16x16x32_bf16 v[92:95], v[232:235], a[92:95], v[92:95]
  ds_read_b128 v[228:231], v9 offset:29696
  v_mfma_f32_16x16x32_bf16 v[96:99], v[236:239], a[88:91], v[96:99]
  buffer_load_dwordx4 a[12:15], v2, s[4:7], s36 offen offset:3072 sc1
  v_mfma_f32_16x16x32_bf16 v[100:103], v[236:239], a[92:95], v[100:103]
  s_waitcnt lgkmcnt(4)
  v_mfma_f32_16x16x32_bf16 v[88:91], v[208:211], a[96:99], v[88:91]
  ds_read_b128 v[232:235], v9 offset:30720
  v_mfma_f32_16x16x32_bf16 v[92:95], v[208:211], a[100:103], v[92:95]
  ds_read_b128 v[236:239], v9 offset:31744
  v_mfma_f32_16x16x32_bf16 v[96:99], v[212:215], a[96:99], v[96:99]
  buffer_load_dwordx4 a[16:19], v50, s[4:7], s36 offen sc1
  v_mfma_f32_16x16x32_bf16 v[100:103], v[212:215], a[100:103], v[100:103]
  s_waitcnt lgkmcnt(4)
  v_mfma_f32_16x16x32_bf16 v[88:91], v[216:219], a[104:107], v[88:91]
  ds_read_b128 v[208:211], v9 offset:32768
  v_mfma_f32_16x16x32_bf16 v[92:95], v[216:219], a[108:111], v[92:95]
  ds_read_b128 v[212:215], v9 offset:33792
  v_mfma_f32_16x16x32_bf16 v[96:99], v[220:223], a[104:107], v[96:99]
  s_add_u32 s36, s61, 5120
  buffer_load_dwordx4 a[20:23], v2, s[4:7], s36 offen offset:0 sc1
  v_mfma_f32_16x16x32_bf16 v[100:103], v[220:223], a[108:111], v[100:103]
  s_waitcnt lgkmcnt(4)
  v_mfma_f32_16x16x32_bf16 v[88:91], v[224:227], a[112:115], v[88:91]
  ds_read_b128 v[216:219], v9 offset:34816
  v_mfma_f32_16x16x32_bf16 v[92:95], v[224:227], a[116:119], v[92:95]
  ds_read_b128 v[220:223], v9 offset:35840
  v_mfma_f32_16x16x32_bf16 v[96:99], v[228:231], a[112:115], v[96:99]
  buffer_load_dwordx4 a[24:27], v2, s[4:7], s36 offen offset:1024 sc1
  v_mfma_f32_16x16x32_bf16 v[100:103], v[228:231], a[116:119], v[100:103]
  s_waitcnt lgkmcnt(4)
  v_mfma_f32_16x16x32_bf16 v[88:91], v[232:235], a[120:123], v[88:91]
  ds_read_b128 v[224:227], v9 offset:36864
  v_mfma_f32_16x16x32_bf16 v[92:95], v[232:235], a[124:127], v[92:95]
  ds_read_b128 v[228:231], v9 offset:37888
  v_mfma_f32_16x16x32_bf16 v[96:99], v[236:239], a[120:123], v[96:99]
  buffer_load_dwordx4 a[28:31], v2, s[4:7], s36 offen offset:2048 sc1
  v_mfma_f32_16x16x32_bf16 v[100:103], v[236:239], a[124:127], v[100:103]
  s_waitcnt lgkmcnt(4)
  v_mfma_f32_16x16x32_bf16 v[88:91], v[208:211], a[128:131], v[88:91]
  ds_read_b128 v[232:235], v9 offset:38912
  v_mfma_f32_16x16x32_bf16 v[92:95], v[208:211], a[132:135], v[92:95]
  ds_read_b128 v[236:239], v9 offset:39936
  v_mfma_f32_16x16x32_bf16 v[96:99], v[212:215], a[128:131], v[96:99]
  buffer_load_dwordx4 a[32:35], v2, s[4:7], s36 offen offset:3072 sc1
  v_mfma_f32_16x16x32_bf16 v[100:103], v[212:215], a[132:135], v[100:103]
  s_waitcnt lgkmcnt(4)
  v_mfma_f32_16x16x32_bf16 v[88:91], v[216:219], a[136:139], v[88:91]
  ds_read_b128 v[208:211], v9 offset:40960
  v_mfma_f32_16x16x32_bf16 v[92:95], v[216:219], a[140:143], v[92:95]
  ds_read_b128 v[212:215], v9 offset:41984
  v_mfma_f32_16x16x32_bf16 v[96:99], v[220:223], a[136:139], v[96:99]
  buffer_load_dwordx4 a[36:39], v50, s[4:7], s36 offen sc1
  v_mfma_f32_16x16x32_bf16 v[100:103], v[220:223], a[140:143], v[100:103]
  s_waitcnt lgkmcnt(4)
  v_mfma_f32_16x16x32_bf16 v[88:91], v[224:227], a[144:147], v[88:91]
  s_add_u32 s36, s61, 10240
  buffer_load_dwordx4 a[40:43], v2, s[4:7], s36 offen offset:0 sc1
  v_mfma_f32_16x16x32_bf16 v[92:95], v[224:227], a[148:151], v[92:95]
  v_mfma_f32_16x16x32_bf16 v[96:99], v[228:231], a[144:147], v[96:99]
  v_mfma_f32_16x16x32_bf16 v[100:103], v[228:231], a[148:151], v[100:103]
  s_waitcnt lgkmcnt(2)
  v_mfma_f32_16x16x32_bf16 v[88:91], v[232:235], a[152:155], v[88:91]
  buffer_load_dwordx4 a[44:47], v2, s[4:7], s36 offen offset:1024 sc1
  v_mfma_f32_16x16x32_bf16 v[92:95], v[232:235], a[156:159], v[92:95]
  v_mfma_f32_16x16x32_bf16 v[96:99], v[236:239], a[152:155], v[96:99]
  v_mfma_f32_16x16x32_bf16 v[100:103], v[236:239], a[156:159], v[100:103]
  s_waitcnt lgkmcnt(0)
  v_mfma_f32_16x16x32_bf16 v[88:91], v[208:211], v[36:39], v[88:91]
  buffer_load_dwordx4 a[48:51], v2, s[4:7], s36 offen offset:2048 sc1
  v_mfma_f32_16x16x32_bf16 v[92:95], v[208:211], v[40:43], v[92:95]
  v_mfma_f32_16x16x32_bf16 v[96:99], v[212:215], v[36:39], v[96:99]
  v_mfma_f32_16x16x32_bf16 v[100:103], v[212:215], v[40:43], v[100:103]
  s_cmp_eq_u32 s12, 0
  s_cbranch_scc0 nopoll_21
  buffer_load_dword v15, v0, s[4:7], s54 offen sc1
nopoll_21:
  v_mul_f32 v52, 1069066811, v28
  v_mul_f32 v54, 1069066811, v30
  v_max3_f32 v56, v88, v89, v90
  v_max3_f32 v60, -v88, -v89, -v90
  v_max3_f32 v58, v92, v93, v94
  v_max3_f32 v62, -v92, -v93, -v94
  v_max3_f32 v56, v56, v91, v96
  v_max3_f32 v60, v60, -v91, -v96
  buffer_load_dwordx4 a[52:55], v2, s[4:7], s36 offen offset:3072 sc1
  v_max3_f32 v58, v58, v95, v100
  v_max3_f32 v62, v62, -v95, -v100
  v_max3_f32 v56, v56, v97, v98
  v_max3_f32 v60, v60, -v97, -v98
  v_max3_f32 v58, v58, v101, v102
  v_max3_f32 v62, v62, -v101, -v102
  v_max3_f32 v56, v56, v99, v82
  v_max3_f32 v60, v60, -v99, -v82
  buffer_load_dwordx4 a[56:59], v50, s[4:7], s36 offen sc1
  v_max3_f32 v58, v58, v103, v86
  v_max3_f32 v62, v62, -v103, -v86
  v_max_f32 v56, v56, v83
  v_max_f32_e64 v60, v60, -v83
  v_max_f32 v58, v58, v87
  v_max_f32_e64 v62, v62, -v87
  v_permlane16_swap_b32 v56, v60
  s_nop 0
  v_permlane16_swap_b32 v58, v62
  s_add_u32 s36, s61, 15360
  buffer_load_dwordx4 a[60:63], v2, s[4:7], s36 offen offset:0 sc1
  v_max_f32 v56, v56, v60
  v_max_f32 v58, v58, v62
  v_mov_b32 v60, v56
  v_mov_b32 v62, v58
  s_nop 0
  v_permlane16_swap_b32 v56, v60
  v_permlane16_swap_b32 v58, v62
  v_mul_f32 v56, v56, v52
  v_mul_f32 v60, v60, v52
  buffer_load_dwordx4 a[64:67], v2, s[4:7], s36 offen offset:1024 sc1
  v_mul_f32 v58, v58, v54
  v_mul_f32 v62, v62, v54
  v_pk_fma_f32 v[140:141], v[88:89], v[52:53], v[60:61] op_sel_hi:[1,0,0] neg_lo:[0,1,1] neg_hi:[0,1,1]
  v_pk_fma_f32 v[88:89], v[88:89], v[52:53], v[56:57] op_sel_hi:[1,0,0] neg_lo:[0,0,1] neg_hi:[0,0,1]
  v_pk_fma_f32 v[142:143], v[90:91], v[52:53], v[60:61] op_sel_hi:[1,0,0] neg_lo:[0,1,1] neg_hi:[0,1,1]
  v_pk_fma_f32 v[90:91], v[90:91], v[52:53], v[56:57] op_sel_hi:[1,0,0] neg_lo:[0,0,1] neg_hi:[0,0,1]
  v_pk_fma_f32 v[144:145], v[96:97], v[52:53], v[60:61] op_sel_hi:[1,0,0] neg_lo:[0,1,1] neg_hi:[0,1,1]
  v_pk_fma_f32 v[96:97], v[96:97], v[52:53], v[56:57] op_sel_hi:[1,0,0] neg_lo:[0,0,1] neg_hi:[0,0,1]
  buffer_load_dwordx4 a[68:71], v2, s[4:7], s36 offen offset:2048 sc1
  v_pk_fma_f32 v[146:147], v[98:99], v[52:53], v[60:61] op_sel_hi:[1,0,0] neg_lo:[0,1,1] neg_hi:[0,1,1]
  v_pk_fma_f32 v[98:99], v[98:99], v[52:53], v[56:57] op_sel_hi:[1,0,0] neg_lo:[0,0,1] neg_hi:[0,0,1]
  v_pk_fma_f32 v[148:149], v[82:83], v[52:53], v[60:61] op_sel_hi:[1,0,0] neg_lo:[0,1,1] neg_hi:[0,1,1]
  v_pk_fma_f32 v[82:83], v[82:83], v[52:53], v[56:57] op_sel_hi:[1,0,0] neg_lo:[0,0,1] neg_hi:[0,0,1]
  v_exp_f32 v88, v88
  v_exp_f32 v89, v89
  v_exp_f32 v90, v90
  v_exp_f32 v91, v91
  buffer_load_dwordx4 a[72:75], v2, s[4:7], s36 offen offset:3072 sc1
  v_exp_f32 v96, v96
  v_exp_f32 v97, v97
  v_exp_f32 v98, v98
  v_exp_f32 v99, v99
  v_exp_f32 v82, v82
  v_exp_f32 v83, v83
  v_exp_f32 v140, v140
  v_exp_f32 v141, v141
  buffer_load_dwordx4 a[76:79], v50, s[4:7], s36 offen sc1
  v_exp_f32 v142, v142
  v_exp_f32 v143, v143
  v_exp_f32 v144, v144
  v_exp_f32 v145, v145
  v_exp_f32 v146, v146
  v_exp_f32 v147, v147
  v_exp_f32 v148, v148
  v_exp_f32 v149, v149
  s_add_u32 s36, s61, 20480
  buffer_load_dwordx4 a[80:83], v2, s[4:7], s36 offen offset:0 sc1
  v_pk_fma_f32 v[152:153], v[92:93], v[54:55], v[62:63] op_sel_hi:[1,0,0] neg_lo:[0,1,1] neg_hi:[0,1,1]
  v_pk_fma_f32 v[92:93], v[92:93], v[54:55], v[58:59] op_sel_hi:[1,0,0] neg_lo:[0,0,1] neg_hi:[0,0,1]
  v_pk_fma_f32 v[154:155], v[94:95], v[54:55], v[62:63] op_sel_hi:[1,0,0] neg_lo:[0,1,1] neg_hi:[0,1,1]
  v_pk_fma_f32 v[94:95], v[94:95], v[54:55], v[58:59] op_sel_hi:[1,0,0] neg_lo:[0,0,1] neg_hi:[0,0,1]
  v_pk_fma_f32 v[156:157], v[100:101], v[54:55], v[62:63] op_sel_hi:[1,0,0] neg_lo:[0,1,1] neg_hi:[0,1,1]
  v_pk_fma_f32 v[100:101], v[100:101], v[54:55], v[58:59] op_sel_hi:[1,0,0] neg_lo:[0,0,1] neg_hi:[0,0,1]
  v_pk_fma_f32 v[158:159], v[102:103], v[54:55], v[62:63] op_sel_hi:[1,0,0] neg_lo:[0,1,1] neg_hi:[0,1,1]
  v_pk_fma_f32 v[102:103], v[102:103], v[54:55], v[58:59] op_sel_hi:[1,0,0] neg_lo:[0,0,1] neg_hi:[0,0,1]
  buffer_load_dwordx4 a[84:87], v2, s[4:7], s36 offen offset:1024 sc1
  v_pk_fma_f32 v[160:161], v[86:87], v[54:55], v[62:63] op_sel_hi:[1,0,0] neg_lo:[0,1,1] neg_hi:[0,1,1]
  v_pk_fma_f32 v[86:87], v[86:87], v[54:55], v[58:59] op_sel_hi:[1,0,0] neg_lo:[0,0,1] neg_hi:[0,0,1]
  v_exp_f32 v92, v92
  v_exp_f32 v93, v93
  v_exp_f32 v94, v94
  v_exp_f32 v95, v95
  v_exp_f32 v100, v100
  v_exp_f32 v101, v101
  buffer_load_dwordx4 a[88:91], v2, s[4:7], s36 offen offset:2048 sc1
  v_exp_f32 v102, v102
  v_exp_f32 v103, v103
  v_exp_f32 v86, v86
  v_exp_f32 v87, v87
  v_exp_f32 v152, v152
  v_exp_f32 v153, v153
  v_exp_f32 v154, v154
  v_exp_f32 v155, v155
  buffer_load_dwordx4 a[92:95], v2, s[4:7], s36 offen offset:3072 sc1
  v_exp_f32 v156, v156
  v_exp_f32 v157, v157
  v_exp_f32 v158, v158
  v_exp_f32 v159, v159
  v_exp_f32 v160, v160
  v_exp_f32 v161, v161
  v_pk_add_f32 v[24:25], v[88:89], v[90:91]
  v_pk_add_f32 v[26:27], v[140:141], v[142:143]
  buffer_load_dwordx4 a[96:99], v50, s[4:7], s36 offen sc1
  v_pk_add_f32 v[56:57], v[92:93], v[94:95]
  v_pk_add_f32 v[60:61], v[152:153], v[154:155]
  v_pk_add_f32 v[24:25], v[24:25], v[96:97]
  v_pk_add_f32 v[26:27], v[26:27], v[144:145]
  v_pk_add_f32 v[56:57], v[56:57], v[100:101]
  v_pk_add_f32 v[60:61], v[60:61], v[156:157]
  v_pk_add_f32 v[24:25], v[24:25], v[98:99]
  v_pk_add_f32 v[26:27], v[26:27], v[146:147]
  s_add_u32 m0, s91, 8192
  s_add_u32 s90, s92, 8192
  buffer_load_dwordx4 v2, s[4:7], s90 offen offset:0 sc1 lds
  v_pk_add_f32 v[56:57], v[56:57], v[102:103]
  v_pk_add_f32 v[60:61], v[60:61], v[158:159]
  v_pk_add_f32 v[24:25], v[24:25], v[82:83]
  v_pk_add_f32 v[26:27], v[26:27], v[148:149]
  v_pk_add_f32 v[56:57], v[56:57], v[86:87]
  v_pk_add_f32 v[60:61], v[60:61], v[160:161]
  v_add_f32 v24, v24, v25
  v_add_f32 v26, v26, v27
  buffer_load_dwordx4 v2, s[4:7], s90 offen offset:1024 sc1 lds
  v_add_f32 v56, v56, v57
  v_add_f32 v60, v60, v61
  v_permlane16_swap_b32 v24, v26
  s_nop 0
  v_permlane16_swap_b32 v56, v60
  v_add_f32 v24, v24, v26
  v_add_f32 v56, v56, v60
  v_mov_b32 v26, v24
  v_mov_b32 v60, v56
  s_mov_b32 s62, 0
  s_cmp_eq_u32 s12, 0
  s_cbranch_scc0 seen_23
  s_waitcnt vmcnt(14)
  v_cmp_gt_u32 vcc, 2, v15
  s_nop 4
  s_cbranch_vccz seen_23
poll_22:
  buffer_load_dword v15, v0, s[4:7], s54 offen sc1
  s_add_u32 s62, s62, 1
  s_waitcnt vmcnt(0)
  v_cmp_gt_u32 vcc, 2, v15
  s_cmp_lt_u32 s62, 0x20000
  s_cselect_b64 vcc, vcc, 0
  s_nop 4
  s_cbranch_vccnz poll_22
seen_23:
  s_barrier
  buffer_load_dwordx4 v[188:191], v20, s[4:7], s55 offen sc1
  s_add_u32 s55, s55, 3584
  buffer_load_dwordx4 v[192:195], v20, s[4:7], s55 offen sc1
  s_add_u32 s55, s55, 3584
  buffer_load_dwordx4 v[196:199], v20, s[4:7], s55 offen sc1
  s_add_u32 s55, s55, 3584
  buffer_load_dwordx4 v[200:203], v20, s[4:7], s55 offen sc1
  s_add_u32 s55, s55, 3584
  buffer_load_dwordx4 v[204:207], v20, s[4:7], s55 offen sc1
  s_add_u32 s55, s55, 3584
  buffer_load_dwordx4 v[208:211], v20, s[4:7], s55 offen sc1
  s_add_u32 s55, s55, 3584
  buffer_load_dwordx4 v[212:215], v20, s[4:7], s55 offen sc1
  s_add_u32 s55, s55, 3584
  buffer_load_dwordx4 v[216:219], v20, s[4:7], s55 offen sc1
  v_permlane16_swap_b32 v24, v26
  v_permlane16_swap_b32 v56, v60
  v_rcp_f32 v24, v24
  v_rcp_f32 v26, v26
  v_rcp_f32 v56, v56
  v_rcp_f32 v60, v60
  s_add_u32 s55, s55, 3584
  buffer_load_dwordx4 v[220:223], v20, s[4:7], s55 offen sc1
  v_mov_b32 v174, 0
  v_mov_b32 v175, 0
  v_mov_b32 v186, 0
  v_mov_b32 v187, 0
  v_pk_mul_f32 v[88:89], v[88:89], v[24:25] op_sel_hi:[1,0]
  v_pk_mul_f32 v[90:91], v[90:91], v[24:25] op_sel_hi:[1,0]
  s_add_u32 s55, s55, 3584
  buffer_load_dwordx4 v[224:227], v20, s[4:7], s55 offen sc1
  v_pk_mul_f32 v[96:97], v[96:97], v[24:25] op_sel_hi:[1,0]
  v_pk_mul_f32 v[98:99], v[98:99], v[24:25] op_sel_hi:[1,0]
  v_pk_mul_f32 v[82:83], v[82:83], v[24:25] op_sel_hi:[1,0]
  v_pk_mul_f32 v[140:141], v[140:141], v[26:27] op_sel_hi:[1,0]
  v_pk_mul_f32 v[142:143], v[142:143], v[26:27] op_sel_hi:[1,0]
  v_pk_mul_f32 v[144:145], v[144:145], v[26:27] op_sel_hi:[1,0]
  s_add_u32 s55, s55, 3584
  buffer_load_dwordx4 v[228:231], v20, s[4:7], s55 offen sc1
  v_pk_mul_f32 v[146:147], v[146:147], v[26:27] op_sel_hi:[1,0]
  v_pk_mul_f32 v[148:149], v[148:149], v[26:27] op_sel_hi:[1,0]
  v_cvt_pk_bf16_f32 v164, v88, v89
  v_cvt_pk_bf16_f32 v165, v90, v91
  v_cvt_pk_bf16_f32 v166, v96, v97
  v_cvt_pk_bf16_f32 v167, v98, v99
  s_add_u32 s55, s55, 3584
  buffer_load_dwordx4 v[232:235], v20, s[4:7], s55 offen sc1
  v_cvt_pk_bf16_f32 v168, v82, v83
  v_cvt_pk_bf16_f32 v169, v140, v141
  v_cvt_pk_bf16_f32 v170, v142, v143
  v_cvt_pk_bf16_f32 v171, v144, v145
  v_cvt_pk_bf16_f32 v172, v146, v147
  v_cvt_pk_bf16_f32 v173, v148, v149
  s_add_u32 s55, s55, 3584
  buffer_load_dwordx4 v[236:239], v20, s[4:7], s55 offen sc1
  v_pk_mul_f32 v[92:93], v[92:93], v[56:57] op_sel_hi:[1,0]
  v_pk_mul_f32 v[94:95], v[94:95], v[56:57] op_sel_hi:[1,0]
  v_pk_mul_f32 v[100:101], v[100:101], v[56:57] op_sel_hi:[1,0]
  v_pk_mul_f32 v[102:103], v[102:103], v[56:57] op_sel_hi:[1,0]
  v_pk_mul_f32 v[86:87], v[86:87], v[56:57] op_sel_hi:[1,0]
  v_pk_mul_f32 v[152:153], v[152:153], v[60:61] op_sel_hi:[1,0]
  s_add_u32 s55, s55, 3584
  buffer_load_dwordx4 v[104:107], v20, s[4:7], s55 offen sc1
  v_pk_mul_f32 v[154:155], v[154:155], v[60:61] op_sel_hi:[1,0]
  v_pk_mul_f32 v[156:157], v[156:157], v[60:61] op_sel_hi:[1,0]
  v_pk_mul_f32 v[158:159], v[158:159], v[60:61] op_sel_hi:[1,0]
  v_pk_mul_f32 v[160:161], v[160:161], v[60:61] op_sel_hi:[1,0]
  v_cvt_pk_bf16_f32 v176, v92, v93
  v_cvt_pk_bf16_f32 v177, v94, v95
  s_add_u32 s55, s55, 3584
  buffer_load_dwordx4 v[108:111], v20, s[4:7], s55 offen sc1
  v_cvt_pk_bf16_f32 v178, v100, v101
  v_cvt_pk_bf16_f32 v179, v102, v103
  v_cvt_pk_bf16_f32 v180, v86, v87
  v_cvt_pk_bf16_f32 v181, v152, v153
  v_cvt_pk_bf16_f32 v182, v154, v155
  v_cvt_pk_bf16_f32 v183, v156, v157
  s_add_u32 s55, s55, 3584
  buffer_load_dwordx4 v[112:115], v20, s[4:7], s55 offen sc1
  v_cvt_pk_bf16_f32 v184, v158, v159
  v_cvt_pk_bf16_f32 v185, v160, v161
  v_lshlrev_b32 v48, 2, v1
  v_min_u32 v48, 92, v48
  v_add_u32 v48, 126240, v48
  ds_write_b32 v48, v174
  s_waitcnt vmcnt(15)
  v_mfma_f32_16x16x32_bf16 v[64:67], a[192:195], v[188:191], 0
  buffer_load_dwordx4 v2, s[4:7], s90 offen offset:2048 sc1 lds
  v_mfma_f32_16x16x32_bf16 v[68:71], a[196:199], v[188:191], 0
  s_waitcnt vmcnt(15)
  v_mfma_f32_16x16x32_bf16 v[64:67], a[192:195], v[192:195], v[64:67]
  s_mul_i32 s85, s12, 8192
  s_add_u32 s86, s85, s27
  s_add_u32 m0, s85, 45056
  s_add_u32 s84, s86, 45056
  buffer_load_dwordx4 v2, s[4:7], s84 offen offset:0 sc1 lds
  v_mfma_f32_16x16x32_bf16 v[68:71], a[196:199], v[192:195], v[68:71]
  s_waitcnt vmcnt(15)
  v_mfma_f32_16x16x32_bf16 v[64:67], a[192:195], v[196:199], v[64:67]
  buffer_load_dwordx4 v2, s[4:7], s84 offen offset:1024 sc1 lds
  v_mfma_f32_16x16x32_bf16 v[68:71], a[196:199], v[196:199], v[68:71]
  s_waitcnt vmcnt(15)
  v_mfma_f32_16x16x32_bf16 v[64:67], a[192:195], v[200:203], v[64:67]
  buffer_load_dwordx4 v2, s[4:7], s84 offen offset:2048 sc1 lds
  v_mfma_f32_16x16x32_bf16 v[68:71], a[196:199], v[200:203], v[68:71]
  s_waitcnt vmcnt(15)
  v_mfma_f32_16x16x32_bf16 v[64:67], a[192:195], v[204:207], v[64:67]
  buffer_load_dwordx4 v2, s[4:7], s84 offen offset:3072 sc1 lds
  v_mfma_f32_16x16x32_bf16 v[68:71], a[196:199], v[204:207], v[68:71]
  s_waitcnt vmcnt(15)
  v_mfma_f32_16x16x32_bf16 v[64:67], a[192:195], v[208:211], v[64:67]
  s_add_u32 m0, s85, 49152
  s_add_u32 s84, s86, 49152
  buffer_load_dwordx4 v2, s[4:7], s84 offen offset:0 sc1 lds
  v_mfma_f32_16x16x32_bf16 v[68:71], a[196:199], v[208:211], v[68:71]
  s_waitcnt vmcnt(15)
  v_mfma_f32_16x16x32_bf16 v[64:67], a[192:195], v[212:215], v[64:67]
  buffer_load_dwordx4 v2, s[4:7], s84 offen offset:1024 sc1 lds
  v_mfma_f32_16x16x32_bf16 v[68:71], a[196:199], v[212:215], v[68:71]
  s_waitcnt vmcnt(15)
  v_mfma_f32_16x16x32_bf16 v[64:67], a[192:195], v[216:219], v[64:67]
  buffer_load_dwordx4 v2, s[4:7], s84 offen offset:2048 sc1 lds
  v_mfma_f32_16x16x32_bf16 v[68:71], a[196:199], v[216:219], v[68:71]
  s_waitcnt vmcnt(15)
  v_mfma_f32_16x16x32_bf16 v[64:67], a[192:195], v[220:223], v[64:67]
  buffer_load_dwordx4 v2, s[4:7], s84 offen offset:3072 sc1 lds
  v_mfma_f32_16x16x32_bf16 v[68:71], a[196:199], v[220:223], v[68:71]
  s_waitcnt vmcnt(15)
  v_mfma_f32_16x16x32_bf16 v[64:67], a[192:195], v[224:227], v[64:67]
  v_mfma_f32_16x16x32_bf16 v[68:71], a[196:199], v[224:227], v[68:71]
  s_waitcnt vmcnt(14)
  v_mfma_f32_16x16x32_bf16 v[64:67], a[192:195], v[228:231], v[64:67]
  v_mfma_f32_16x16x32_bf16 v[68:71], a[196:199], v[228:231], v[68:71]
  s_waitcnt vmcnt(13)
  v_mfma_f32_16x16x32_bf16 v[64:67], a[192:195], v[232:235], v[64:67]
  v_mfma_f32_16x16x32_bf16 v[68:71], a[196:199], v[232:235], v[68:71]
  s_waitcnt vmcnt(12)
  v_mfma_f32_16x16x32_bf16 v[64:67], a[192:195], v[236:239], v[64:67]
  v_mfma_f32_16x16x32_bf16 v[68:71], a[196:199], v[236:239], v[68:71]
  s_waitcnt vmcnt(11)
  v_mfma_f32_16x16x32_bf16 v[64:67], a[192:195], v[104:107], v[64:67]
  v_mfma_f32_16x16x32_bf16 v[68:71], a[196:199], v[104:107], v[68:71]
  s_waitcnt vmcnt(10)
  v_mfma_f32_16x16x32_bf16 v[64:67], a[192:195], v[108:111], v[64:67]
  v_mfma_f32_16x16x32_bf16 v[68:71], a[196:199], v[108:111], v[68:71]
  s_waitcnt vmcnt(9)
  v_mfma_f32_16x16x32_bf16 v[64:67], a[192:195], v[112:115], v[64:67]
  v_mfma_f32_16x16x32_bf16 v[68:71], a[196:199], v[112:115], v[68:71]
  v_mov_b32 v198, 0
  v_mov_b32 v199, 0
  v_mov_b32 v210, 0
  v_mov_b32 v211, 0
  v_mov_b32 v222, 0
  v_mov_b32 v223, 0
  s_nop 0
  v_cvt_pk_bf16_f32 v52, v64, v65
  v_cvt_pk_bf16_f32 v53, v66, v67
  ds_write_b64 v18, v[52:53]
  v_cvt_pk_bf16_f32 v54, v68, v69
  v_cvt_pk_bf16_f32 v55, v70, v71
  ds_write_b64 v19, v[54:55]
  v_and_b32 v12, 1, v4
  v_lshlrev_b32 v12, 3, v12
  v_sub_u32 v24, v21, v12
  v_sub_u32 v25, v22, v12
  v_sub_u32 v26, v23, v12
  s_waitcnt lgkmcnt(0)
  s_barrier
  ds_read_b128 v[212:215], v23 offset:0
  ds_read_b128 v[188:191], v21 offset:0
  ds_read_b128 v[200:203], v22 offset:0
  ds_read_b128 v[216:219], v23 offset:32
  ds_read_b128 v[192:195], v21 offset:32
  ds_read_b128 v[204:207], v22 offset:32
  ds_read_b64 v[220:221], v26 offset:64
  ds_read_b64 v[196:197], v24 offset:64
  ds_read_b64 v[208:209], v25 offset:64
  s_waitcnt lgkmcnt(6)
  v_mfma_f32_16x16x32_bf16 v[72:75], v[212:215], v[164:167], 0
  v_mfma_f32_16x16x32_bf16 v[64:67], v[188:191], v[164:167], 0
  v_mfma_f32_16x16x32_bf16 v[68:71], v[200:203], v[164:167], 0
  v_mfma_f32_16x16x32_bf16 v[84:87], v[212:215], v[176:179], 0
  v_mfma_f32_16x16x32_bf16 v[76:79], v[188:191], v[176:179], 0
  v_mfma_f32_16x16x32_bf16 v[80:83], v[200:203], v[176:179], 0
  s_waitcnt lgkmcnt(3)
  v_mfma_f32_16x16x32_bf16 v[72:75], v[216:219], v[168:171], v[72:75]
  v_mfma_f32_16x16x32_bf16 v[64:67], v[192:195], v[168:171], v[64:67]
  v_mfma_f32_16x16x32_bf16 v[68:71], v[204:207], v[168:171], v[68:71]
  v_mfma_f32_16x16x32_bf16 v[84:87], v[216:219], v[180:183], v[84:87]
  v_mfma_f32_16x16x32_bf16 v[76:79], v[192:195], v[180:183], v[76:79]
  v_mfma_f32_16x16x32_bf16 v[80:83], v[204:207], v[180:183], v[80:83]
  s_waitcnt lgkmcnt(0)
  v_mfma_f32_16x16x32_bf16 v[72:75], v[220:223], v[172:175], v[72:75]
  v_mfma_f32_16x16x32_bf16 v[64:67], v[196:199], v[172:175], v[64:67]
  v_mfma_f32_16x16x32_bf16 v[68:71], v[208:211], v[172:175], v[68:71]
  v_mfma_f32_16x16x32_bf16 v[84:87], v[220:223], v[184:187], v[84:87]
  v_mfma_f32_16x16x32_bf16 v[76:79], v[196:199], v[184:187], v[76:79]
  v_mfma_f32_16x16x32_bf16 v[80:83], v[208:211], v[184:187], v[80:83]
  s_nop 2
  v_add_f32 v72, 897988541, v72
  v_add_f32 v73, 897988541, v73
  v_rcp_f32 v104, v72
  v_rcp_f32 v106, v73
  v_pk_mul_f32 v[64:65], v[64:65], v[104:105] op_sel_hi:[1,0]
  v_pk_mul_f32 v[66:67], v[66:67], v[104:105] op_sel_hi:[1,0]
  v_pk_mul_f32 v[68:69], v[68:69], v[106:107] op_sel_hi:[1,0]
  v_pk_mul_f32 v[70:71], v[70:71], v[106:107] op_sel_hi:[1,0]
  v_cndmask_b32 v104, v106, v104, s[48:49]
  v_cvt_pk_bf16_f32 v108, v64, v65
  v_cvt_pk_bf16_f32 v109, v66, v67
  v_cvt_pk_bf16_f32 v110, v68, v69
  v_cvt_pk_bf16_f32 v111, v70, v71
  v_pk_mul_f32 v[74:75], v[74:75], v[104:105] op_sel_hi:[1,0]
  buffer_store_dwordx4 v[108:111], v2, s[4:7], s44 offen sc1
  v_cvt_pk_bf16_f32 v112, v74, v75
  buffer_store_dword v112, v14, s[4:7], s46 offen sc1
  v_add_f32 v84, 897988541, v84
  v_add_f32 v85, 897988541, v85
  v_rcp_f32 v116, v84
  v_rcp_f32 v118, v85
  v_pk_mul_f32 v[76:77], v[76:77], v[116:117] op_sel_hi:[1,0]
  v_pk_mul_f32 v[78:79], v[78:79], v[116:117] op_sel_hi:[1,0]
  v_pk_mul_f32 v[80:81], v[80:81], v[118:119] op_sel_hi:[1,0]
  v_pk_mul_f32 v[82:83], v[82:83], v[118:119] op_sel_hi:[1,0]
  v_cndmask_b32 v116, v118, v116, s[48:49]
  v_cvt_pk_bf16_f32 v120, v76, v77
  v_cvt_pk_bf16_f32 v121, v78, v79
  v_cvt_pk_bf16_f32 v122, v80, v81
  v_cvt_pk_bf16_f32 v123, v82, v83
  v_pk_mul_f32 v[86:87], v[86:87], v[116:117] op_sel_hi:[1,0]
  buffer_store_dwordx4 v[120:123], v2, s[4:7], s45 offen sc1
  v_cvt_pk_bf16_f32 v124, v86, v87
  buffer_store_dword v124, v14, s[4:7], s47 offen sc1
p_body:
  s_cmp_eq_u32 s15, 3
  s_cselect_b32 s27, 1879048192, s27
  s_and_b32 s94, s15, 1
  s_mul_i32 s94, s94, 24576
  s_cmp_eq_u32 s12, 0
  s_cbranch_scc1 w0_28
  s_cmp_eq_u32 s15, 3
  s_cbranch_scc1 dr_30
  s_sub_u32 s91, s12, 1
  s_mul_i32 s91, s91, 12288
  s_add_u32 s91, s91, s94
  s_add_u32 s92, s91, s27
  s_add_u32 m0, s91, 53248
  s_add_u32 s90, s92, 53248
  buffer_load_dwordx4 v2, s[4:7], s90 offen offset:0 sc1 lds
  buffer_load_dwordx4 v2, s[4:7], s90 offen offset:1024 sc1 lds
  buffer_load_dwordx4 v2, s[4:7], s90 offen offset:2048 sc1 lds
  buffer_load_dwordx4 v2, s[4:7], s90 offen offset:3072 sc1 lds
  s_add_u32 m0, s91, 57344
  s_add_u32 s90, s92, 57344
  buffer_load_dwordx4 v2, s[4:7], s90 offen offset:0 sc1 lds
  buffer_load_dwordx4 v2, s[4:7], s90 offen offset:1024 sc1 lds
  buffer_load_dwordx4 v2, s[4:7], s90 offen offset:2048 sc1 lds
  buffer_load_dwordx4 v2, s[4:7], s90 offen offset:3072 sc1 lds
  s_add_u32 m0, s91, 61440
  s_add_u32 s90, s92, 61440
  buffer_load_dwordx4 v2, s[4:7], s90 offen offset:0 sc1 lds
  buffer_load_dwordx4 v2, s[4:7], s90 offen offset:1024 sc1 lds
  buffer_load_dwordx4 v2, s[4:7], s90 offen offset:2048 sc1 lds
  buffer_load_dwordx4 v2, s[4:7], s90 offen offset:3072 sc1 lds
  s_waitcnt vmcnt(12)
  s_branch jn_29
w0_28:
  s_nop 1
  s_and_b32 s26, s14, 1
  s_lshr_b32 s63, s14, 1
  s_lshl_b32 s28, s13, 1
  s_add_u32 s28, s28, s26
  s_lshl_b32 s28, s28, 2
  s_lshr_b32 s35, s63, 1
  s_mul_i32 s35, s35, 5
  s_and_b32 s36, s63, 1
  s_mul_i32 s37, s36, 3
  s_add_u32 s37, s37, s35
  s_add_u32 s35, s35, 2
  s_add_u32 s38, s28, s12
  s_mul_i32 s39, s38, 21504
  s_lshl_b32 s40, s37, 10
  s_add_u32 s40, s40, s39
  s_lshl_b32 s41, s35, 10
  s_add_u32 s41, s41, s39
  s_lshl_b32 s42, s36, 9
  s_add_u32 s41, s41, s42
  v_lshrrev_b32 v16, 1, v4
  v_lshlrev_b32 v16, 8, v16
  v_lshl_add_u32 v16, v3, 4, v16
  v_and_b32 v17, 1, v4
  v_lshl_add_u32 v16, v17, 3, v16
  s_mul_i32 s29, s28, 21504
  s_mul_i32 s30, s12, 5120
  s_add_u32 s31, s29, s30
  s_add_u32 s31, s31, s18
  s_add_u32 s32, s31, 4096
  s_add_u32 s33, s12, 0
  s_and_b32 s33, s33, 3
  s_mul_i32 s34, s33, 21504
  v_add_u32 v20, s34, v2
  s_mul_i32 s34, s33, 10240
  s_add_u32 s34, s34, 122880
  v_add_u32 v24, s34, v2
  s_add_u32 s33, s12, 1
  s_and_b32 s33, s33, 3
  s_mul_i32 s34, s33, 21504
  v_add_u32 v21, s34, v2
  s_mul_i32 s34, s33, 10240
  s_add_u32 s34, s34, 122880
  v_add_u32 v25, s34, v2
  s_add_u32 s33, s12, 2
  s_and_b32 s33, s33, 3
  s_mul_i32 s34, s33, 21504
  v_add_u32 v22, s34, v2
  s_mul_i32 s34, s33, 10240
  s_add_u32 s34, s34, 122880
  v_add_u32 v26, s34, v2
  s_add_u32 s33, s12, 3
  s_and_b32 s33, s33, 3
  s_mul_i32 s34, s33, 21504
  v_add_u32 v23, s34, v2
  s_mul_i32 s34, s33, 10240
  s_add_u32 s34, s34, 122880
  v_add_u32 v27, s34, v2
  v_lshlrev_b32 v32, 16, v246
  v_and_b32 v33, 0xffff0000, v246
  v_lshlrev_b32 v34, 16, v247
  v_and_b32 v35, 0xffff0000, v247
  v_lshlrev_b32 v36, 16, v248
  v_and_b32 v37, 0xffff0000, v248
  v_lshlrev_b32 v38, 16, v249
  v_and_b32 v39, 0xffff0000, v249
  v_lshlrev_b32 v40, 16, v250
  v_and_b32 v41, 0xffff0000, v250
  v_lshlrev_b32 v42, 16, v251
  v_and_b32 v43, 0xffff0000, v251
  v_lshlrev_b32 v44, 16, v252
  v_and_b32 v45, 0xffff0000, v252
  v_lshlrev_b32 v46, 16, v253
  v_and_b32 v47, 0xffff0000, v253
  v_lshlrev_b32 v48, 16, v254
  v_and_b32 v49, 0xffff0000, v254
  v_lshlrev_b32 v50, 16, v255
  v_and_b32 v51, 0xffff0000, v255
  s_add_u32 s44, s40, s16
  s_add_u32 s44, s44, 2752512
  s_add_u32 s45, s41, s16
  s_add_u32 s45, s45, 2752512
  s_lshl_b32 s46, s38, 10
  s_lshr_b32 s47, s63, 1
  s_lshl_b32 s47, s47, 8
  s_add_u32 s46, s46, s47
  s_lshl_b32 s47, s36, 3
  s_add_u32 s46, s46, s47
  s_add_u32 s46, s46, s17
  s_add_u32 s46, s46, 131072
  s_add_u32 s98, s99, 327680
  v_lshlrev_b32 v17, 4, v3
  v_lshl_add_u32 v17, v4, 1, v17
  v_mov_b32 v19, 1879048192
  v_and_b32 v28, 1, v4
  v_cmp_eq_u32 vcc, 0, v28
  s_nop 1
  v_cndmask_b32 v17, v19, v17, vcc
  s_mov_b32 s56, 1065369472
  s_and_b32 s62, s14, 7
  s_lshl_b32 s62, s62, 8
  v_mov_b32 v12, s62
  v_mov_b32 v13, 1
  s_mov_b32 s62, 0
dr_30:
  s_waitcnt vmcnt(0)
jn_29:
  s_cmp_eq_u32 s12, 0
  s_waitcnt lgkmcnt(0)
  s_barrier
  s_cbranch_scc0 nosig_27
  s_mov_b64 exec, 1
  buffer_atomic_add v13, v12, s[4:7], s99 offen sc0 sc1
  s_waitcnt vmcnt(0)
  v_readfirstlane_b32 s63, v13
  s_mov_b64 exec, -1
  s_mov_b64 exec, -1
nosig_27:
  s_cmp_eq_u32 s12, 0
  s_cbranch_scc0 side_26
poll_24:
  buffer_load_dword v240, v0, s[4:7], s99 offen sc1
  s_add_u32 s62, s62, 1
  s_waitcnt vmcnt(0)
  v_cmp_gt_u32 vcc, 2, v240
  s_cmp_lt_u32 s62, 0x20000
  s_cselect_b64 vcc, vcc, 0
  s_nop 4
  s_cbranch_vccnz poll_24
  s_branch seen_25
side_26:
  s_nop 1
  s_and_b32 s26, s14, 1
  s_lshr_b32 s63, s14, 1
  s_lshl_b32 s28, s13, 1
  s_add_u32 s28, s28, s26
  s_lshl_b32 s28, s28, 2
  s_lshr_b32 s35, s63, 1
  s_mul_i32 s35, s35, 5
  s_and_b32 s36, s63, 1
  s_mul_i32 s37, s36, 3
  s_add_u32 s37, s37, s35
  s_add_u32 s35, s35, 2
  s_add_u32 s38, s28, s12
  s_mul_i32 s39, s38, 21504
  s_lshl_b32 s40, s37, 10
  s_add_u32 s40, s40, s39
  s_lshl_b32 s41, s35, 10
  s_add_u32 s41, s41, s39
  s_lshl_b32 s42, s36, 9
  s_add_u32 s41, s41, s42
  v_lshrrev_b32 v16, 1, v4
  v_lshlrev_b32 v16, 8, v16
  v_lshl_add_u32 v16, v3, 4, v16
  v_and_b32 v17, 1, v4
  v_lshl_add_u32 v16, v17, 3, v16
  s_mul_i32 s29, s28, 21504
  s_mul_i32 s30, s12, 5120
  s_add_u32 s31, s29, s30
  s_add_u32 s31, s31, s18
  s_add_u32 s32, s31, 4096
  s_add_u32 s33, s12, 0
  s_and_b32 s33, s33, 3
  s_mul_i32 s34, s33, 21504
  v_add_u32 v20, s34, v2
  s_mul_i32 s34, s33, 10240
  s_add_u32 s34, s34, 122880
  v_add_u32 v24, s34, v2
  s_add_u32 s33, s12, 1
  s_and_b32 s33, s33, 3
  s_mul_i32 s34, s33, 21504
  v_add_u32 v21, s34, v2
  s_mul_i32 s34, s33, 10240
  s_add_u32 s34, s34, 122880
  v_add_u32 v25, s34, v2
  s_add_u32 s33, s12, 2
  s_and_b32 s33, s33, 3
  s_mul_i32 s34, s33, 21504
  v_add_u32 v22, s34, v2
  s_mul_i32 s34, s33, 10240
  s_add_u32 s34, s34, 122880
  v_add_u32 v26, s34, v2
  s_add_u32 s33, s12, 3
  s_and_b32 s33, s33, 3
  s_mul_i32 s34, s33, 21504
  v_add_u32 v23, s34, v2
  s_mul_i32 s34, s33, 10240
  s_add_u32 s34, s34, 122880
  v_add_u32 v27, s34, v2
  v_lshlrev_b32 v32, 16, v246
  v_and_b32 v33, 0xffff0000, v246
  v_lshlrev_b32 v34, 16, v247
  v_and_b32 v35, 0xffff0000, v247
  v_lshlrev_b32 v36, 16, v248
  v_and_b32 v37, 0xffff0000, v248
  v_lshlrev_b32 v38, 16, v249
  v_and_b32 v39, 0xffff0000, v249
  v_lshlrev_b32 v40, 16, v250
  v_and_b32 v41, 0xffff0000, v250
  v_lshlrev_b32 v42, 16, v251
  v_and_b32 v43, 0xffff0000, v251
  v_lshlrev_b32 v44, 16, v252
  v_and_b32 v45, 0xffff0000, v252
  v_lshlrev_b32 v46, 16, v253
  v_and_b32 v47, 0xffff0000, v253
  v_lshlrev_b32 v48, 16, v254
  v_and_b32 v49, 0xffff0000, v254
  v_lshlrev_b32 v50, 16, v255
  v_and_b32 v51, 0xffff0000, v255
  s_add_u32 s44, s40, s16
  s_add_u32 s44, s44, 2752512
  s_add_u32 s45, s41, s16
  s_add_u32 s45, s45, 2752512
  s_lshl_b32 s46, s38, 10
  s_lshr_b32 s47, s63, 1
  s_lshl_b32 s47, s47, 8
  s_add_u32 s46, s46, s47
  s_lshl_b32 s47, s36, 3
  s_add_u32 s46, s46, s47
  s_add_u32 s46, s46, s17
  s_add_u32 s46, s46, 131072
  s_add_u32 s98, s99, 327680
  v_lshlrev_b32 v17, 4, v3
  v_lshl_add_u32 v17, v4, 1, v17
  v_mov_b32 v19, 1879048192
  v_and_b32 v28, 1, v4
  v_cmp_eq_u32 vcc, 0, v28
  s_nop 1
  v_cndmask_b32 v17, v19, v17, vcc
  s_mov_b32 s56, 1065369472
seen_25:
  s_barrier
  buffer_load_dwordx4 a[104:107], v21, s[4:7], s31 offen offset:0 sc1
  s_nop 11
  buffer_load_dwordx4 a[120:123], v21, s[4:7], s31 offen offset:1024 sc1
  s_nop 11
  buffer_load_dwordx4 a[136:139], v21, s[4:7], s31 offen offset:2048 sc1
  s_nop 11
  buffer_load_dwordx4 a[152:155], v21, s[4:7], s31 offen offset:3072 sc1
  s_nop 11
  buffer_load_dwordx4 a[168:171], v21, s[4:7], s32 offen sc1
  s_nop 11
  buffer_load_dwordx4 a[108:111], v22, s[4:7], s31 offen offset:0 sc1
  s_nop 11
  buffer_load_dwordx4 a[124:127], v22, s[4:7], s31 offen offset:1024 sc1
  s_nop 11
  buffer_load_dwordx4 a[140:143], v22, s[4:7], s31 offen offset:2048 sc1
  s_nop 11
  buffer_load_dwordx4 a[156:159], v22, s[4:7], s31 offen offset:3072 sc1
  s_nop 11
  buffer_load_dwordx4 a[172:175], v22, s[4:7], s32 offen sc1
  s_nop 11
  buffer_load_dwordx4 a[112:115], v23, s[4:7], s31 offen offset:0 sc1
  s_nop 11
  buffer_load_dwordx4 a[128:131], v23, s[4:7], s31 offen offset:1024 sc1
  s_nop 11
  s_waitcnt vmcnt(11)
  v_mfma_f32_16x16x32_bf16 v[84:87], a[0:3], a[104:107], 0
  buffer_load_dwordx4 a[144:147], v23, s[4:7], s31 offen offset:2048 sc1
  v_mfma_f32_16x16x32_bf16 v[88:91], a[4:7], a[104:107], 0
  v_mfma_f32_16x16x32_bf16 v[92:95], a[8:11], a[104:107], 0
  v_mfma_f32_16x16x32_bf16 v[96:99], a[12:15], a[104:107], 0
  v_mfma_f32_16x16x32_bf16 v[100:103], a[16:19], a[104:107], 0
  s_waitcnt vmcnt(11)
  v_mfma_f32_16x16x32_bf16 v[84:87], a[20:23], a[120:123], v[84:87]
  buffer_load_dwordx4 a[160:163], v23, s[4:7], s31 offen offset:3072 sc1
  v_mfma_f32_16x16x32_bf16 v[88:91], a[24:27], a[120:123], v[88:91]
  v_mfma_f32_16x16x32_bf16 v[92:95], a[28:31], a[120:123], v[92:95]
  v_mfma_f32_16x16x32_bf16 v[96:99], a[32:35], a[120:123], v[96:99]
  v_mfma_f32_16x16x32_bf16 v[100:103], a[36:39], a[120:123], v[100:103]
  s_waitcnt vmcnt(11)
  v_mfma_f32_16x16x32_bf16 v[84:87], a[40:43], a[136:139], v[84:87]
  buffer_load_dwordx4 a[176:179], v23, s[4:7], s32 offen sc1
  v_mfma_f32_16x16x32_bf16 v[88:91], a[44:47], a[136:139], v[88:91]
  v_mfma_f32_16x16x32_bf16 v[92:95], a[48:51], a[136:139], v[92:95]
  v_mfma_f32_16x16x32_bf16 v[96:99], a[52:55], a[136:139], v[96:99]
  v_mfma_f32_16x16x32_bf16 v[100:103], a[56:59], a[136:139], v[100:103]
  s_waitcnt vmcnt(11)
  v_mfma_f32_16x16x32_bf16 v[84:87], a[60:63], a[152:155], v[84:87]
  buffer_load_dwordx4 a[100:103], v20, s[4:7], s31 offen offset:0 sc1
  v_mfma_f32_16x16x32_bf16 v[88:91], a[64:67], a[152:155], v[88:91]
  v_mfma_f32_16x16x32_bf16 v[92:95], a[68:71], a[152:155], v[92:95]
  v_mfma_f32_16x16x32_bf16 v[96:99], a[72:75], a[152:155], v[96:99]
  v_mfma_f32_16x16x32_bf16 v[100:103], a[76:79], a[152:155], v[100:103]
  s_waitcnt vmcnt(11)
  v_mfma_f32_16x16x32_bf16 v[84:87], a[80:83], a[168:171], v[84:87]
  buffer_load_dwordx4 a[116:119], v20, s[4:7], s31 offen offset:1024 sc1
  v_mfma_f32_16x16x32_bf16 v[88:91], a[84:87], a[168:171], v[88:91]
  v_mfma_f32_16x16x32_bf16 v[92:95], a[88:91], a[168:171], v[92:95]
  v_mfma_f32_16x16x32_bf16 v[96:99], a[92:95], a[168:171], v[96:99]
  v_mfma_f32_16x16x32_bf16 v[100:103], a[96:99], a[168:171], v[100:103]
  s_waitcnt vmcnt(11)
  v_mfma_f32_16x16x32_bf16 v[104:107], a[0:3], a[108:111], 0
  buffer_load_dwordx4 a[132:135], v20, s[4:7], s31 offen offset:2048 sc1
  v_mfma_f32_16x16x32_bf16 v[108:111], a[4:7], a[108:111], 0
  ds_write_b128 v25, v[84:87] offset:0
  v_mfma_f32_16x16x32_bf16 v[112:115], a[8:11], a[108:111], 0
  v_mfma_f32_16x16x32_bf16 v[116:119], a[12:15], a[108:111], 0
  ds_write_b128 v25, v[88:91] offset:1024
  v_mfma_f32_16x16x32_bf16 v[120:123], a[16:19], a[108:111], 0
  s_waitcnt vmcnt(11)
  v_mfma_f32_16x16x32_bf16 v[104:107], a[20:23], a[124:127], v[104:107]
  ds_write_b128 v25, v[92:95] offset:2048
  buffer_load_dwordx4 a[148:151], v20, s[4:7], s31 offen offset:3072 sc1
  v_mfma_f32_16x16x32_bf16 v[108:111], a[24:27], a[124:127], v[108:111]
  v_mfma_f32_16x16x32_bf16 v[112:115], a[28:31], a[124:127], v[112:115]
  ds_write_b128 v25, v[96:99] offset:3072
  v_mfma_f32_16x16x32_bf16 v[116:119], a[32:35], a[124:127], v[116:119]
  v_mfma_f32_16x16x32_bf16 v[120:123], a[36:39], a[124:127], v[120:123]
  ds_write_b128 v25, v[100:103] offset:4096
  s_waitcnt vmcnt(11)
  v_mfma_f32_16x16x32_bf16 v[104:107], a[40:43], a[140:143], v[104:107]
  buffer_load_dwordx4 a[164:167], v20, s[4:7], s32 offen sc1
  v_mfma_f32_16x16x32_bf16 v[108:111], a[44:47], a[140:143], v[108:111]
  v_mfma_f32_16x16x32_bf16 v[112:115], a[48:51], a[140:143], v[112:115]
  v_mfma_f32_16x16x32_bf16 v[116:119], a[52:55], a[140:143], v[116:119]
  v_mfma_f32_16x16x32_bf16 v[120:123], a[56:59], a[140:143], v[120:123]
  s_waitcnt lgkmcnt(0)
  s_barrier
  s_waitcnt vmcnt(11)
  v_mfma_f32_16x16x32_bf16 v[104:107], a[60:63], a[156:159], v[104:107]
  ds_read_b128 v[144:147], v27 offset:0
  s_mul_i32 s91, s12, 2048
  s_add_u32 s91, s91, s94
  s_add_u32 s92, s91, s27
  s_add_u32 m0, s91, 90112
  s_add_u32 s90, s92, 90112
  buffer_load_dwordx4 v2, s[4:7], s90 offen offset:0 sc1 lds
  v_mfma_f32_16x16x32_bf16 v[108:111], a[64:67], a[156:159], v[108:111]
  ds_read_b128 v[148:151], v27 offset:1024
  v_mfma_f32_16x16x32_bf16 v[112:115], a[68:71], a[156:159], v[112:115]
  ds_read_b128 v[152:155], v27 offset:2048
  v_mfma_f32_16x16x32_bf16 v[116:119], a[72:75], a[156:159], v[116:119]
  ds_read_b128 v[156:159], v27 offset:3072
  v_mfma_f32_16x16x32_bf16 v[120:123], a[76:79], a[156:159], v[120:123]
  ds_read_b128 v[160:163], v27 offset:4096
  s_waitcnt vmcnt(11)
  v_mfma_f32_16x16x32_bf16 v[104:107], a[80:83], a[172:175], v[104:107]
  buffer_load_dwordx4 v2, s[4:7], s90 offen offset:1024 sc1 lds
  v_mfma_f32_16x16x32_bf16 v[108:111], a[84:87], a[172:175], v[108:111]
  v_mfma_f32_16x16x32_bf16 v[112:115], a[88:91], a[172:175], v[112:115]
  v_mfma_f32_16x16x32_bf16 v[116:119], a[92:95], a[172:175], v[116:119]
  v_mfma_f32_16x16x32_bf16 v[120:123], a[96:99], a[172:175], v[120:123]
  s_waitcnt vmcnt(11) lgkmcnt(0)
  v_mfma_f32_16x16x32_bf16 v[124:127], a[0:3], a[112:115], v[144:147]
  v_mfma_f32_16x16x32_bf16 v[128:131], a[4:7], a[112:115], v[148:151]
  ds_write_b128 v26, v[104:107] offset:5120
  v_mfma_f32_16x16x32_bf16 v[132:135], a[8:11], a[112:115], v[152:155]
  v_mfma_f32_16x16x32_bf16 v[136:139], a[12:15], a[112:115], v[156:159]
  ds_write_b128 v26, v[108:111] offset:6144
  v_mfma_f32_16x16x32_bf16 v[140:143], a[16:19], a[112:115], v[160:163]
  s_waitcnt vmcnt(10)
  v_mfma_f32_16x16x32_bf16 v[124:127], a[20:23], a[128:131], v[124:127]
  ds_write_b128 v26, v[112:115] offset:7168
  v_mfma_f32_16x16x32_bf16 v[128:131], a[24:27], a[128:131], v[128:131]
  v_mfma_f32_16x16x32_bf16 v[132:135], a[28:31], a[128:131], v[132:135]
  ds_write_b128 v26, v[116:119] offset:8192
  v_mfma_f32_16x16x32_bf16 v[136:139], a[32:35], a[128:131], v[136:139]
  v_mfma_f32_16x16x32_bf16 v[140:143], a[36:39], a[128:131], v[140:143]
  ds_write_b128 v26, v[120:123] offset:9216
  s_waitcnt vmcnt(9)
  v_mfma_f32_16x16x32_bf16 v[124:127], a[40:43], a[144:147], v[124:127]
  v_mfma_f32_16x16x32_bf16 v[128:131], a[44:47], a[144:147], v[128:131]
  v_mfma_f32_16x16x32_bf16 v[132:135], a[48:51], a[144:147], v[132:135]
  v_mfma_f32_16x16x32_bf16 v[136:139], a[52:55], a[144:147], v[136:139]
  v_mfma_f32_16x16x32_bf16 v[140:143], a[56:59], a[144:147], v[140:143]
  s_waitcnt lgkmcnt(0)
  s_barrier
  s_waitcnt vmcnt(8)
  v_mfma_f32_16x16x32_bf16 v[124:127], a[60:63], a[160:163], v[124:127]
  ds_read_b128 v[164:167], v24 offset:5120
  v_mfma_f32_16x16x32_bf16 v[128:131], a[64:67], a[160:163], v[128:131]
  ds_read_b128 v[168:171], v24 offset:6144
  v_mfma_f32_16x16x32_bf16 v[132:135], a[68:71], a[160:163], v[132:135]
  ds_read_b128 v[172:175], v24 offset:7168
  v_mfma_f32_16x16x32_bf16 v[136:139], a[72:75], a[160:163], v[136:139]
  ds_read_b128 v[176:179], v24 offset:8192
  v_mfma_f32_16x16x32_bf16 v[140:143], a[76:79], a[160:163], v[140:143]
  ds_read_b128 v[180:183], v24 offset:9216
  s_waitcnt vmcnt(7)
  v_mfma_f32_16x16x32_bf16 v[124:127], a[80:83], a[176:179], v[124:127]
  v_mfma_f32_16x16x32_bf16 v[128:131], a[84:87], a[176:179], v[128:131]
  v_mfma_f32_16x16x32_bf16 v[132:135], a[88:91], a[176:179], v[132:135]
  v_mfma_f32_16x16x32_bf16 v[136:139], a[92:95], a[176:179], v[136:139]
  v_mfma_f32_16x16x32_bf16 v[140:143], a[96:99], a[176:179], v[140:143]
  s_waitcnt vmcnt(6) lgkmcnt(0)
  v_mfma_f32_16x16x32_bf16 v[64:67], a[0:3], a[100:103], v[164:167]
  v_mfma_f32_16x16x32_bf16 v[68:71], a[4:7], a[100:103], v[168:171]
  s_nop 0
  ds_write_b128 v27, v[124:127] offset:0
  v_mfma_f32_16x16x32_bf16 v[72:75], a[8:11], a[100:103], v[172:175]
  v_mfma_f32_16x16x32_bf16 v[76:79], a[12:15], a[100:103], v[176:179]
  ds_write_b128 v27, v[128:131] offset:1024
  v_mfma_f32_16x16x32_bf16 v[80:83], a[16:19], a[100:103], v[180:183]
  s_waitcnt vmcnt(5)
  v_mfma_f32_16x16x32_bf16 v[64:67], a[20:23], a[116:119], v[64:67]
  ds_write_b128 v27, v[132:135] offset:2048
  v_mfma_f32_16x16x32_bf16 v[68:71], a[24:27], a[116:119], v[68:71]
  v_mfma_f32_16x16x32_bf16 v[72:75], a[28:31], a[116:119], v[72:75]
  ds_write_b128 v27, v[136:139] offset:3072
  v_mfma_f32_16x16x32_bf16 v[76:79], a[32:35], a[116:119], v[76:79]
  v_mfma_f32_16x16x32_bf16 v[80:83], a[36:39], a[116:119], v[80:83]
  ds_write_b128 v27, v[140:143] offset:4096
  s_waitcnt vmcnt(4)
  v_mfma_f32_16x16x32_bf16 v[64:67], a[40:43], a[132:135], v[64:67]
  v_mfma_f32_16x16x32_bf16 v[68:71], a[44:47], a[132:135], v[68:71]
  v_mfma_f32_16x16x32_bf16 v[72:75], a[48:51], a[132:135], v[72:75]
  v_mfma_f32_16x16x32_bf16 v[76:79], a[52:55], a[132:135], v[76:79]
  v_mfma_f32_16x16x32_bf16 v[80:83], a[56:59], a[132:135], v[80:83]
  s_waitcnt lgkmcnt(0)
  s_barrier
  s_waitcnt vmcnt(3)
  v_mfma_f32_16x16x32_bf16 v[64:67], a[60:63], a[148:151], v[64:67]
  ds_read_b128 v[184:187], v24 offset:0
  v_mfma_f32_16x16x32_bf16 v[68:71], a[64:67], a[148:151], v[68:71]
  ds_read_b128 v[188:191], v24 offset:1024
  v_mfma_f32_16x16x32_bf16 v[72:75], a[68:71], a[148:151], v[72:75]
  ds_read_b128 v[192:195], v24 offset:2048
  v_mfma_f32_16x16x32_bf16 v[76:79], a[72:75], a[148:151], v[76:79]
  ds_read_b128 v[196:199], v24 offset:3072
  v_mfma_f32_16x16x32_bf16 v[80:83], a[76:79], a[148:151], v[80:83]
  ds_read_b128 v[200:203], v24 offset:4096
  s_waitcnt vmcnt(2)
  v_mfma_f32_16x16x32_bf16 v[64:67], a[80:83], a[164:167], v[64:67]
  v_mfma_f32_16x16x32_bf16 v[68:71], a[84:87], a[164:167], v[68:71]
  v_mfma_f32_16x16x32_bf16 v[72:75], a[88:91], a[164:167], v[72:75]
  v_mfma_f32_16x16x32_bf16 v[76:79], a[92:95], a[164:167], v[76:79]
  v_mfma_f32_16x16x32_bf16 v[80:83], a[96:99], a[164:167], v[80:83]
  s_waitcnt lgkmcnt(0)
  s_barrier
  s_nop 1
  v_pk_add_f32 v[64:65], v[64:65], v[184:185]
  v_pk_add_f32 v[66:67], v[66:67], v[186:187]
  v_pk_add_f32 v[68:69], v[68:69], v[188:189]
  v_pk_add_f32 v[70:71], v[70:71], v[190:191]
  v_pk_add_f32 v[72:73], v[72:73], v[192:193]
  v_pk_add_f32 v[74:75], v[74:75], v[194:195]
  v_pk_add_f32 v[76:77], v[76:77], v[196:197]
  v_pk_add_f32 v[78:79], v[78:79], v[198:199]
  v_pk_add_f32 v[80:81], v[80:81], v[200:201]
  v_pk_add_f32 v[82:83], v[82:83], v[202:203]
  v_cvt_pk_bf16_f32 v64, 0, v64
  v_cvt_pk_bf16_f32 v65, 0, v65
  v_cvt_pk_bf16_f32 v66, 0, v66
  v_cvt_pk_bf16_f32 v67, 0, v67
  v_cvt_pk_bf16_f32 v68, 0, v68
  v_cvt_pk_bf16_f32 v69, 0, v69
  v_cvt_pk_bf16_f32 v70, 0, v70
  v_cvt_pk_bf16_f32 v71, 0, v71
  v_cvt_pk_bf16_f32 v72, 0, v72
  v_cvt_pk_bf16_f32 v73, 0, v73
  v_cvt_pk_bf16_f32 v74, 0, v74
  v_cvt_pk_bf16_f32 v75, 0, v75
  v_cvt_pk_bf16_f32 v76, 0, v76
  v_cvt_pk_bf16_f32 v77, 0, v77
  v_cvt_pk_bf16_f32 v78, 0, v78
  v_cvt_pk_bf16_f32 v79, 0, v79
  v_cvt_pk_bf16_f32 v80, 0, v80
  v_cvt_pk_bf16_f32 v81, 0, v81
  v_cvt_pk_bf16_f32 v82, 0, v82
  v_cvt_pk_bf16_f32 v83, 0, v83
  v_pk_add_f32 v[64:65], v[64:65], v[32:33]
  v_pk_add_f32 v[66:67], v[66:67], v[34:35]
  v_pk_add_f32 v[68:69], v[68:69], v[36:37]
  v_pk_add_f32 v[70:71], v[70:71], v[38:39]
  v_pk_add_f32 v[72:73], v[72:73], v[40:41]
  v_pk_add_f32 v[74:75], v[74:75], v[42:43]
  v_pk_add_f32 v[76:77], v[76:77], v[44:45]
  v_pk_add_f32 v[78:79], v[78:79], v[46:47]
  v_pk_add_f32 v[80:81], v[80:81], v[48:49]
  v_pk_add_f32 v[82:83], v[82:83], v[50:51]
  v_cvt_pk_bf16_f32 v246, v64, v65
  v_cvt_pk_bf16_f32 v247, v66, v67
  v_cvt_pk_bf16_f32 v248, v68, v69
  v_cvt_pk_bf16_f32 v249, v70, v71
  v_cvt_pk_bf16_f32 v250, v72, v73
  v_cvt_pk_bf16_f32 v251, v74, v75
  v_cvt_pk_bf16_f32 v252, v76, v77
  v_cvt_pk_bf16_f32 v253, v78, v79
  v_cvt_pk_bf16_f32 v254, v80, v81
  v_cvt_pk_bf16_f32 v255, v82, v83
  s_cmp_eq_u32 s15, 3
  s_cbranch_scc1 p_final
  buffer_store_dwordx4 v[246:249], v2, s[4:7], s44 offen sc1
  buffer_store_dwordx4 v[250:253], v2, s[4:7], s44 offen offset:1024 sc1
  buffer_store_dwordx2 v[254:255], v16, s[4:7], s45 offen sc1
  v_dot2_f32_bf16 v108, v246, s56, 0
  v_dot2_f32_bf16 v109, v246, v246, 0
  v_dot2_f32_bf16 v110, v247, s56, 0
  v_dot2_f32_bf16 v111, v247, v247, 0
  v_dot2_f32_bf16 v108, v248, s56, v108
  v_dot2_f32_bf16 v109, v248, v248, v109
  v_dot2_f32_bf16 v110, v249, s56, v110
  v_dot2_f32_bf16 v111, v249, v249, v111
  v_dot2_f32_bf16 v108, v250, s56, v108
  v_dot2_f32_bf16 v109, v250, v250, v109
  v_dot2_f32_bf16 v110, v251, s56, v110
  v_dot2_f32_bf16 v111, v251, v251, v111
  v_dot2_f32_bf16 v108, v252, s56, v108
  v_dot2_f32_bf16 v109, v252, v252, v109
  v_dot2_f32_bf16 v110, v253, s56, v110
  v_dot2_f32_bf16 v111, v253, v253, v111
  v_dot2_f32_bf16 v108, v254, s56, v108
  v_dot2_f32_bf16 v109, v254, v254, v109
  v_dot2_f32_bf16 v110, v255, s56, v110
  v_dot2_f32_bf16 v111, v255, v255, v111
  s_nop 2
  v_pk_add_f32 v[108:109], v[108:109], v[110:111]
  s_nop 1
  v_permlane32_swap_b32 v108, v109
  v_add_f32 v108, v108, v109
  v_mov_b32 v109, v108
  s_nop 1
  v_permlane16_swap_b32 v108, v109
  v_add_f32 v108, v108, v109
  buffer_store_dword v108, v17, s[4:7], s46 offen sc1
  s_add_u32 s15, s15, 1
  s_add_u32 s16, s16, 2752512
  s_add_u32 s17, s17, 131072
  s_add_u32 s18, s18, 2752512
  s_mov_b32 s33, s19
  s_mov_b32 s19, s20
  s_mov_b32 s20, s33
  s_xor_b32 s21, s21, 892928
  s_cmp_eq_u32 s15, 2
  s_cbranch_scc1 qa_steady
  s_lshr_b32 s33, s15, 1
  s_mul_i32 s33, s33, 917504
  s_add_u32 s22, s33, 29884416
  s_branch qb_body
p_final:
  s_mul_i32 s39, s38, 20480
  v_mul_u32_u24 v17, 1280, v3
  v_lshl_add_u32 v18, v4, 4, v17
  v_lshl_add_u32 v19, v4, 3, v17
  s_lshl_b32 s42, s37, 6
  s_add_u32 s42, s42, s39
  s_lshl_b32 s43, s35, 6
  s_add_u32 s43, s43, s39
  s_lshl_b32 s36, s36, 5
  s_add_u32 s43, s43, s36
  buffer_store_dwordx4 v[246:249], v18, s[8:11], s42 offen sc1
  buffer_store_dwordx4 v[250:253], v18, s[8:11], s42 offen offset:64 sc1
  buffer_store_dwordx2 v[254:255], v19, s[8:11], s43 offen sc1
  s_waitcnt vmcnt(0)
  s_endpgm
main_exit:
  s_endpgm
.section .rodata,"a"
.p2align 6
.amdhsa_kernel main_kernel
  .amdhsa_next_free_vgpr 512
  .amdhsa_next_free_sgpr 102
  .amdhsa_accum_offset 256
  .amdhsa_group_segment_fixed_size 0
  .amdhsa_kernarg_size 80
  .amdhsa_user_sgpr_count 2
  .amdhsa_user_sgpr_kernarg_segment_ptr 1
  .amdhsa_system_sgpr_workgroup_id_x 1
.end_amdhsa_kernel
```
